```python
import torch

def _softmax(x, axis=-1):
    return torch.softmax(x, dim=axis)
def _gelu(x):
    return torch.nn.functional.gelu(x, approximate="tanh")
def _silu(x):
    return torch.nn.functional.silu(x)
def _sigmoid(x):
    return torch.sigmoid(x)
def _layernorm(x, axis=-1, eps=1e-5):
    m = x.mean(dim=axis, keepdim=True)
    v = x.var(dim=axis, keepdim=True, unbiased=False)
    return (x - m) / torch.sqrt(v + eps)
def _scatter_add(tgt, idx, src, axis=0):
    return tgt.clone().index_add_(axis, idx, src)
def _segment_sum(src, seg, n):
    out = torch.zeros((n,) + src.shape[1:], dtype=src.dtype)
    return out.index_add_(0, seg, src)
def _pad(x, pw):
    flat = tuple(v for pair in reversed(pw) for v in pair)
    return torch.nn.functional.pad(x, flat)

kernel_name = 'recurrent_scan__sliding_block_cached__moe_arch_mod__prompt'

def setup_inputs():

    _w = (lambda a: (lambda t: t.to(torch.bfloat16) if t.is_floating_point() else t)(torch.as_tensor(a)))
    def _A_setup():
        B, Sq, D = 1, 2048, 512
        Hq, Hkv, Sk, Dh = 32, 32, 2048, 128
        assert Hq % Hkv == 0, (Hq, Hkv)
        return {
            "x": _w((lambda *s: torch.randn(*s, dtype=torch.bfloat16) * 0.05)(B, Sq, D)),
            "k_cache": _w((lambda *s: torch.randn(*s, dtype=torch.bfloat16) * 0.8)(B, Hkv, Sk, Dh)),
            "v_cache": _w((lambda *s: torch.randn(*s, dtype=torch.bfloat16) * 0.2)(B, Hkv, Sk, Dh)),
            "wq": _w((lambda *s: torch.randn(*s, dtype=torch.bfloat16) * 0.8)(D, Hq * Dh) * (D ** -0.5)),
            "wo": _w((lambda *s: torch.randn(*s, dtype=torch.bfloat16) * 0.2)(Hq * Dh, D) * ((Hq * Dh) ** -0.5)),
        }
    _A_in = _A_setup()

    def _B_setup():
        B, S, D, F, C = 1, 2048, 512, 1376, 2
        return {
            "x": _w((lambda *s: torch.randn(*s, dtype=torch.bfloat16) * 0.05)(B, S, D)),
            "w_r": _w((lambda *s: torch.randn(*s, dtype=torch.bfloat16) * 0.2)(D)),
            "w_gate": _w((lambda *s: torch.randn(*s, dtype=torch.bfloat16) * 0.1)(D, F)),
            "w_up": _w((lambda *s: torch.randn(*s, dtype=torch.bfloat16) * 0.1)(D, F)),
            "w_down": _w((lambda *s: torch.randn(*s, dtype=torch.bfloat16) * 0.1)(F, D)),
        }
    _B_in = _B_setup()

    return {
        "A_x": _A_in["x"],
        "A_k_cache": _A_in["k_cache"],
        "A_v_cache": _A_in["v_cache"],
        "A_wq": _A_in["wq"],
        "A_wo": _A_in["wo"],
        "B_x": _B_in["x"],
        "B_w_r": _B_in["w_r"],
        "B_w_gate": _B_in["w_gate"],
        "B_w_up": _B_in["w_up"],
        "B_w_down": _B_in["w_down"],
    }

def reference(A_x, A_k_cache, A_v_cache, A_wq, A_wo, B_x, B_w_r, B_w_gate, B_w_up, B_w_down):
    def _A_ref(x, k_cache, v_cache, wq, wo):
        B, Sq, D = x.shape
        Hq, Dh = 32, 128
        Hkv, Sk = k_cache.shape[1], k_cache.shape[2]
        W = min(4096, max(256, Sk // 4))
        rep = Hq // Hkv
        q = (lambda x, *d: x.permute(*d))((x @ wq).reshape(B, Sq, Hq, Dh), 0, 2, 1, 3)
        k = (lambda x, n, axis: torch.repeat_interleave(x, n, dim=axis))(k_cache[:, :, Sk - W:, :], rep, axis=1)
        v = (lambda x, n, axis: torch.repeat_interleave(x, n, dim=axis))(v_cache[:, :, Sk - W:, :], rep, axis=1)
        scores = torch.einsum("bhqd,bhkd->bhqk", q, k) * (Dh ** -0.5)
        p = _softmax(scores, axis=-1)
        o = torch.einsum("bhqk,bhkd->bhqd", p, v)
        return (lambda x, *d: x.permute(*d))(o, 0, 2, 1, 3).reshape(B, Sq, Hq * Dh) @ wo

    def _B_ref(x, w_r, w_gate, w_up, w_down):
        B, S, D = x.shape
        C = 2
        r = x @ w_r
        idx = torch.argsort(-r, axis=-1)[:, :C]
        idx_e = (lambda x, n, axis: torch.repeat_interleave(x, n, dim=axis))(idx.reshape(B, C, 1), D, axis=2)
        x_sel = (lambda x, i, axis: torch.take_along_dim(x, i, dim=axis))(x, idx_e, axis=1)
        g = _silu(x_sel @ w_gate)
        u = x_sel @ w_up
        y = (g * u) @ w_down
        r_sel = _sigmoid((lambda x, i, axis: torch.take_along_dim(x, i, dim=axis))(r, idx, axis=1))
        y = y * r_sel.reshape(B, C, 1)
        b_off = (torch.arange(B) * S).reshape(B, 1)
        flat_idx = (idx + b_off).reshape(B * C)
        zero = (x * 0.0).reshape(B * S, D)
        upd = _scatter_add(zero, flat_idx, y.reshape(B * C, D), axis=0)
        return x + upd.reshape(B, S, D)

    x = A_x
    xn = _layernorm(x, axis=-1)
    s = _A_ref(xn, A_k_cache, A_v_cache, A_wq, A_wo)
    g = _silu(_B_ref(xn, B_w_r, B_w_gate, B_w_up, B_w_down))
    return x + s * g
```

```asm
; @launch grid=(256,1,1) block=(256,1,1) lds=163840
.amdgcn_target "amdgcn-amd-amdhsa--gfx950"
.text
.globl recurrent_scan__sliding_block_cached__moe_arch_mod__prompt_kernel
.p2align 8
.type recurrent_scan__sliding_block_cached__moe_arch_mod__prompt_kernel,@function
recurrent_scan__sliding_block_cached__moe_arch_mod__prompt_kernel:
    s_getpc_b64 s[98:99]
L_pc:
    v_lshrrev_b32 v29, 3, v0
    v_lshlrev_b32 v29, 7, v29
    global_load_dword v57, v29, s[98:99]
    s_load_dwordx16 s[64:79], s[0:1], 0
    s_load_dwordx8 s[80:87], s[0:1], 64
    s_load_dwordx2 s[88:89], s[0:1], 96
    s_cmp_ge_u32 s2, 256
    s_cbranch_scc1 L_end
    s_mov_b32 s49, 0
L_restart:
    s_lshr_b32 s37, s2, 3
    v_lshrrev_b32 v59, 4, v0
    v_lshlrev_b32 v59, 7, v59
    v_lshl_add_u32 v59, s37, 11, v59
    v_min_u32 v59, L_code_end-L_pc-4, v59
    global_load_dword v58, v59, s[98:99]
    v_lshrrev_b32 v20, 6, v0
    v_and_b32 v21, 63, v0
    v_readfirstlane_b32 s3, v20
    s_and_b32 s36, s2, 7
    s_lshr_b32 s38, s36, 1
    s_lshl_b32 s26, s38, 3
    s_and_b32 s39, s37, 7
    s_add_u32 s26, s26, s39
    s_and_b32 s39, s36, 1
    s_lshl_b32 s27, s39, 2
    s_lshr_b32 s54, s37, 3
    s_add_u32 s27, s27, s54
    s_mul_i32 s50, s39, 3
    s_add_u32 s50, s50, s36
    s_add_u32 s51, s26, s27
    s_and_b32 s51, s51, 1
    v_and_b32 v22, 15, v21
    v_lshrrev_b32 v23, 4, v21
    v_lshlrev_b32 v1, 14, v23
    v_bfe_u32 v29, v21, 3, 1
    v_lshl_add_u32 v1, v29, 10, v1
    v_and_b32 v29, 7, v21
    v_lshl_add_u32 v1, v29, 4, v1
    v_lshlrev_b32 v2, 15, v23
    v_lshl_add_u32 v2, v22, 4, v2
    s_mul_i32 s40, s3, 8320
    s_mul_i32 s41, s3, 4224
    s_add_u32 s41, s41, 33280
    s_lshl_b32 s42, s3, 16
    s_lshl_b32 s43, s3, 17
    s_lshl_b32 s36, s26, 3
    s_lshl_b32 s37, s3, 1
    s_add_u32 s39, s36, s37
    s_lshl_b32 s36, s39, 10
    v_lshlrev_b32 v30, 5, v21
    v_and_b32 v31, 0x3ff, v30
    s_lshl_b32 s37, s27, 18
    s_lshl_b32 s38, s26, 8
    s_mov_b32 s6, 0x40000
    s_mov_b32 s7, 0x20000
    s_mov_b32 s10, 4186368
    s_mov_b32 s11, 0x20000
    s_add_u32 s32, s50, 0
    s_and_b32 s32, s32, 7
    s_lshl_b32 s29, s32, 19
    s_add_u32 s29, s29, s43
    s_lshl_b32 s28, s32, 7
    s_add_u32 s28, s28, s42
    s_waitcnt lgkmcnt(0)
    s_add_u32 s4, s64, s37
    s_addc_u32 s5, s65, 0
    s_add_u32 s8, s70, s38
    s_addc_u32 s9, s71, 0
    buffer_load_dwordx4 v[96:99], v30, s[4:7], s36 offen
    buffer_load_dwordx4 v[100:103], v30, s[4:7], s36 offen offset:16
    s_add_u32 m0, s41, 50432
    s_nop 0
    buffer_load_dwordx4 v2, s[8:11], s29 offen lds
    s_add_u32 s29, s29, 8192
    s_add_u32 m0, s41, 51488
    s_nop 0
    buffer_load_dwordx4 v2, s[8:11], s29 offen lds
    s_add_u32 s29, s29, 8192
    s_add_u32 m0, s41, 52544
    s_nop 0
    buffer_load_dwordx4 v2, s[8:11], s29 offen lds
    s_add_u32 s29, s29, 8192
    s_add_u32 m0, s41, 53600
    s_nop 0
    buffer_load_dwordx4 v2, s[8:11], s29 offen lds
    s_add_u32 m0, s40, 50432
    s_nop 0
    buffer_load_dwordx4 v1, s[4:7], s28 offen offset:0 lds
    s_add_u32 m0, s40, 50464
    s_nop 0
    buffer_load_dwordx4 v1, s[4:7], s28 offen offset:2048 lds
    s_add_u32 s28, s28, 4096
    s_add_u32 m0, s40, 51472
    s_nop 0
    buffer_load_dwordx4 v1, s[4:7], s28 offen offset:0 lds
    s_add_u32 m0, s40, 51504
    s_nop 0
    buffer_load_dwordx4 v1, s[4:7], s28 offen offset:2048 lds
    s_add_u32 s28, s28, 4096
    s_add_u32 m0, s40, 55632
    s_nop 0
    buffer_load_dwordx4 v1, s[4:7], s28 offen offset:0 lds
    s_add_u32 m0, s40, 55664
    s_nop 0
    buffer_load_dwordx4 v1, s[4:7], s28 offen offset:2048 lds
    s_add_u32 s28, s28, 4096
    s_add_u32 m0, s40, 54592
    s_nop 0
    buffer_load_dwordx4 v1, s[4:7], s28 offen offset:0 lds
    s_add_u32 m0, s40, 54624
    s_nop 0
    buffer_load_dwordx4 v1, s[4:7], s28 offen offset:2048 lds
    s_mov_b32 s55, 17268736
    s_load_dword s47, s[88:89], s55
    global_load_dwordx4 v[104:107], v31, s[76:77]
    global_load_dwordx4 v[108:111], v31, s[76:77] offset:16
    s_and_b32 s36, s2, 7
    s_lshr_b32 s37, s2, 3
    s_and_b32 s38, s36, 1
    s_lshl_b32 s46, s38, 16
    s_sub_u32 s46, s46, 16384
    s_and_b32 s46, s46, 0x1ffff
    s_lshr_b32 s53, s37, 2
    s_and_b32 s52, s37, 3
    s_lshl_b32 s52, s52, 1
    s_add_u32 s52, s52, s38
    s_and_b32 s24, s26, 24
    s_add_u32 s52, s52, s24
    s_lshl_b32 s54, s54, 19
    s_lshl_b32 s38, s38, 21
    s_add_u32 s54, s54, s38
    s_and_b32 s38, s37, 7
    s_lshl_b32 s38, s38, 14
    s_add_u32 s54, s54, s38
    s_and_b32 s38, s37, 3
    s_lshl_b32 s24, s36, 2
    s_add_u32 s24, s24, s38
    s_lshr_b32 s38, s37, 2
    s_lshl_b32 s38, s38, 5
    s_add_u32 s24, s24, s38
    v_accvgpr_write_b32 a189, v59
    s_lshl_b32 s37, s26, 19
    s_add_u32 s37, s37, 393216
    s_add_u32 s12, s66, s37
    s_addc_u32 s13, s67, 0
    s_mov_b32 s14, 0x20000
    s_mov_b32 s15, 0x20000
    s_add_u32 s16, s68, s37
    s_addc_u32 s17, s69, 0
    s_mov_b32 s18, 0x20000
    s_mov_b32 s19, 0x20000
    s_mov_b32 s20, s88
    s_mov_b32 s21, s89
    s_mov_b32 s22, 25165824
    s_mov_b32 s23, 0x20000
    v_and_b32 v24, 1, v23
    v_lshrrev_b32 v25, 1, v23
    v_lshl_add_u32 v26, v24, 1, v25
    v_bfe_u32 v27, v21, 2, 2
    v_and_b32 v28, 3, v21
    v_lshlrev_b32 v3, 12, v23
    v_lshl_add_u32 v3, v22, 4, v3
    v_lshl_add_u32 v3, v20, 10, v3
    v_lshlrev_b32 v4, 11, v23
    v_lshl_add_u32 v4, v22, 4, v4
    v_lshl_add_u32 v4, v20, 9, v4
    s_mov_b32 s37, 0x64753120
    v_lshrrev_b32 v29, 1, v22
    v_lshlrev_b32 v29, 2, v29
    v_bfe_u32 v29, s37, v29, 4
    v_mul_u32_u24 v5, 1040, v29
    v_and_b32 v29, 1, v22
    v_lshl_add_u32 v5, v29, 7, v5
    v_lshl_add_u32 v5, v26, 4, v5
    v_add_u32 v5, s40, v5
    v_lshl_add_u32 v29, v24, 2, v27
    v_mul_u32_u24 v29, 1056, v29
    v_lshl_add_u32 v29, v28, 3, v29
    v_lshl_add_u32 v6, v25, 9, v29
    v_add_u32 v6, 33280, v6
    v_lshl_add_u32 v8, v25, 8, v29
    v_add_u32 v8, 16640, v8
    s_mov_b32 s37, 0x8910
    v_lshrrev_b32 v29, 2, v22
    v_lshlrev_b32 v29, 2, v29
    v_bfe_u32 v29, s37, v29, 4
    v_lshl_add_u32 v29, v28, 1, v29
    v_mul_u32_u24 v7, 1040, v29
    v_lshl_add_u32 v7, v26, 4, v7
    s_lshl_b32 s38, s3, 2
    s_lshr_b32 s37, s37, s38
    s_and_b32 s37, s37, 15
    s_mul_i32 s44, s37, 1040
    s_mul_i32 s45, s3, 2112
    s_add_u32 s45, s45, 16640
    s_lshl_b32 s37, s3, 12
    s_add_u32 s54, s54, s37
    v_mov_b32 v16, 0
    v_mov_b32 v17, 0
    v_mov_b32 v18, 0
    v_mov_b32 v19, 0
    v_mov_b32 v29, 163616
    ds_write_b32 v29, v16
    v_lshlrev_b32 v42, 4, v22
    v_lshl_add_u32 v42, s3, 8, v42
    v_add_u32 v42, 159360, v42
    s_cmp_lg_u32 s49, 0
    s_cbranch_scc1 L_nomf
    v_mov_b32 v44, 0xff800000
    v_mov_b32 v45, 0xff800000
    v_mov_b32 v46, 0xff800000
    v_mov_b32 v47, 0xff800000
    s_branch L_mf
L_nomf:
    ds_read_b128 v[44:47], v42
L_mf:
    v_mov_b32 v12, 0x3f803f80
    v_mov_b32 v13, 0x3f803f80
    v_mov_b32 v14, 0x3f803f80
    v_mov_b32 v15, 0x3f803f80
    s_lshl_b32 s36, s27, 8
    s_add_u32 s36, s36, s39
    v_lshrrev_b32 v115, 5, v21
    v_add_u32 v115, s36, v115
    v_lshlrev_b32 v115, 6, v115
    v_and_b32 v56, 7, v21
    v_lshl_add_u32 v56, v56, 3, v115
    s_mov_b32 s36, 24117248
    v_add_u32 v9, 50432, v5
    v_add_u32 v10, 50432, v6
    v_lshl_add_u32 v11, s3, 6, v10
    s_waitcnt vmcnt(14)
    v_lshlrev_b32 v64, 16, v96
    v_and_b32 v65, 0xffff0000, v96
    s_add_u32 s32, s50, 1
    v_lshlrev_b32 v66, 16, v97
    v_and_b32 v67, 0xffff0000, v97
    v_lshlrev_b32 v68, 16, v98
    s_and_b32 s32, s32, 7
    v_and_b32 v69, 0xffff0000, v98
    v_lshlrev_b32 v70, 16, v99
    s_lshl_b32 s29, s32, 19
    v_and_b32 v71, 0xffff0000, v99
    v_lshlrev_b32 v72, 16, v100
    v_and_b32 v73, 0xffff0000, v100
    s_add_u32 s29, s29, s43
    v_lshlrev_b32 v74, 16, v101
    v_and_b32 v75, 0xffff0000, v101
    s_lshl_b32 s28, s32, 7
    v_lshlrev_b32 v76, 16, v102
    v_and_b32 v77, 0xffff0000, v102
    v_lshlrev_b32 v78, 16, v103
    s_add_u32 s28, s28, s42
    v_and_b32 v79, 0xffff0000, v103
    v_add_f32 v48, v64, v65
    s_add_u32 m0, s41, 100864
    v_add_f32 v49, v66, v67
    v_add_f32 v48, v68, v48
    v_add_f32 v49, v69, v49
    buffer_load_dwordx4 v2, s[8:11], s29 offen lds
    v_add_f32 v48, v70, v48
    v_add_f32 v49, v71, v49
    s_add_u32 s29, s29, 8192
    v_add_f32 v48, v72, v48
    v_add_f32 v49, v73, v49
    v_add_f32 v48, v74, v48
    s_add_u32 m0, s41, 101920
    v_add_f32 v49, v75, v49
    v_add_f32 v48, v76, v48
    buffer_load_dwordx4 v2, s[8:11], s29 offen lds
    v_add_f32 v49, v77, v49
    v_add_f32 v48, v78, v48
    v_add_f32 v49, v79, v49
    s_add_u32 s29, s29, 8192
    v_add_f32 v48, v48, v49
    s_nop 1
    v_add_f32_dpp v48, v48, v48 quad_perm:[1,0,3,2] row_mask:0xf bank_mask:0xf
    s_nop 1
    v_add_f32_dpp v48, v48, v48 quad_perm:[2,3,0,1] row_mask:0xf bank_mask:0xf
    s_add_u32 m0, s41, 102976
    s_nop 0
    v_add_f32_dpp v48, v48, v48 row_half_mirror row_mask:0xf bank_mask:0xf
    s_nop 1
    v_add_f32_dpp v48, v48, v48 row_mirror row_mask:0xf bank_mask:0xf
    buffer_load_dwordx4 v2, s[8:11], s29 offen lds
    v_mov_b32 v49, v48
    s_nop 1
    v_permlane16_swap_b32 v48, v49
    v_add_f32 v48, v48, v49
    s_add_u32 s29, s29, 8192
    v_mul_f32 v48, 0x3b000000, v48
    v_sub_f32 v80, v64, v48
    s_add_u32 m0, s41, 104032
    v_sub_f32 v81, v65, v48
    v_sub_f32 v82, v66, v48
    v_sub_f32 v83, v67, v48
    buffer_load_dwordx4 v2, s[8:11], s29 offen lds
    v_sub_f32 v84, v68, v48
    v_sub_f32 v85, v69, v48
    s_add_u32 m0, s40, 100864
    v_sub_f32 v86, v70, v48
    v_sub_f32 v87, v71, v48
    v_sub_f32 v88, v72, v48
    buffer_load_dwordx4 v1, s[4:7], s28 offen offset:0 lds
    v_sub_f32 v89, v73, v48
    v_sub_f32 v90, v74, v48
    s_add_u32 m0, s40, 100896
    v_sub_f32 v91, v75, v48
    v_sub_f32 v92, v76, v48
    v_sub_f32 v93, v77, v48
    buffer_load_dwordx4 v1, s[4:7], s28 offen offset:2048 lds
    v_sub_f32 v94, v78, v48
    v_sub_f32 v95, v79, v48
    s_add_u32 s28, s28, 4096
    v_mul_f32 v50, v80, v80
    v_mul_f32 v51, v81, v81
    v_fmac_f32 v50, v82, v82
    s_add_u32 m0, s40, 101904
    v_fmac_f32 v51, v83, v83
    v_fmac_f32 v50, v84, v84
    buffer_load_dwordx4 v1, s[4:7], s28 offen offset:0 lds
    v_fmac_f32 v51, v85, v85
    v_fmac_f32 v50, v86, v86
    v_fmac_f32 v51, v87, v87
    s_add_u32 m0, s40, 101936
    v_fmac_f32 v50, v88, v88
    v_fmac_f32 v51, v89, v89
    v_fmac_f32 v50, v90, v90
    buffer_load_dwordx4 v1, s[4:7], s28 offen offset:2048 lds
    v_fmac_f32 v51, v91, v91
    v_fmac_f32 v50, v92, v92
    s_add_u32 s28, s28, 4096
    v_fmac_f32 v51, v93, v93
    v_fmac_f32 v50, v94, v94
    v_fmac_f32 v51, v95, v95
    s_add_u32 m0, s40, 106064
    v_add_f32 v50, v50, v51
    s_nop 1
    v_add_f32_dpp v50, v50, v50 quad_perm:[1,0,3,2] row_mask:0xf bank_mask:0xf
    buffer_load_dwordx4 v1, s[4:7], s28 offen offset:0 lds
    s_nop 0
    v_add_f32_dpp v50, v50, v50 quad_perm:[2,3,0,1] row_mask:0xf bank_mask:0xf
    s_nop 1
    v_add_f32_dpp v50, v50, v50 row_half_mirror row_mask:0xf bank_mask:0xf
    s_nop 1
    v_add_f32_dpp v50, v50, v50 row_mirror row_mask:0xf bank_mask:0xf
    s_add_u32 m0, s40, 106096
    v_mov_b32 v51, v50
    s_nop 1
    v_permlane16_swap_b32 v50, v51
    buffer_load_dwordx4 v1, s[4:7], s28 offen offset:2048 lds
    v_add_f32 v50, v50, v51
    v_mul_f32 v50, 0x3b000000, v50
    v_cvt_pk_bf16_f32 v51, v48, v50
    s_add_u32 s28, s28, 4096
    v_lshlrev_b32 v112, 16, v51
    v_and_b32 v50, 0xffff0000, v51
    s_add_u32 m0, s40, 105024
    v_add_f32 v50, 0x3727c5ac, v50
    v_cvt_pk_bf16_f32 v50, v50, v50
    v_and_b32 v50, 0xffff0000, v50
    buffer_load_dwordx4 v1, s[4:7], s28 offen offset:0 lds
    v_sqrt_f32 v50, v50
    s_nop 0
    v_cvt_pk_bf16_f32 v118, v112, v50
    s_add_u32 m0, s40, 105056
    v_and_b32 v50, 0xffff0000, v118
    s_waitcnt lgkmcnt(0)
    s_add_u32 s47, s47, 0x9e3779b9
    s_nop 0
    s_cmp_eq_u32 s49, 0
    s_cselect_b32 s35, s47, s35
    buffer_load_dwordx4 v1, s[4:7], s28 offen offset:2048 lds
    v_rcp_f32 v113, v50
    v_mov_b32 v119, s35
    s_mov_b32 exec_lo, 0xff
    s_mov_b32 exec_hi, 0xff
    buffer_store_dwordx2 v[118:119], v56, s[20:23], s36 offen sc1
    s_mov_b64 exec, -1
    s_xor_b32 s32, s51, 2
    s_add_u32 s32, s32, s50
    s_and_b32 s32, s32, 7
    s_waitcnt vmcnt(15)
    s_barrier
    s_lshl_b32 s29, s32, 19
    s_add_u32 m0, s41, 0
    s_add_u32 s29, s29, s43
    buffer_load_dwordx4 v2, s[8:11], s29 offen lds
    s_add_u32 m0, s41, 1056
    s_add_u32 s29, s29, 8192
    s_xor_b32 s34, s51, 2
    s_add_u32 s34, s34, s50
    s_and_b32 s34, s34, 7
    s_lshl_b32 s28, s34, 7
    s_add_u32 s28, s28, s42
    ds_read_b64_tr_b16 a[112:113], v11 offset:0
    ds_read_b64_tr_b16 a[114:115], v11 offset:256
    s_xor_b32 s34, s51, 3
    ds_read_b64_tr_b16 a[116:117], v11 offset:32
    s_add_u32 s34, s34, s50
    s_and_b32 s34, s34, 7
    ds_read_b64_tr_b16 a[118:119], v11 offset:288
    s_xor_b32 s32, s51, 3
    ds_read_b128 a[0:3], v9 offset:0
    s_add_u32 s32, s32, s50
    buffer_load_dwordx4 v2, s[8:11], s29 offen lds
    s_add_u32 m0, s41, 2112
    s_add_u32 s29, s29, 8192
    ds_read_b64_tr_b16 a[64:65], v10 offset:0
    s_and_b32 s32, s32, 7
    ds_read_b64_tr_b16 a[66:67], v10 offset:256
    v_sub_f32 v64, v64, v112
    ds_read_b128 a[4:7], v9 offset:256
    v_sub_f32 v65, v65, v112
    v_sub_f32 v66, v66, v112
    v_sub_f32 v67, v67, v112
    v_sub_f32 v68, v68, v112
    ds_read_b128 a[8:11], v9 offset:512
    v_sub_f32 v69, v69, v112
    v_sub_f32 v70, v70, v112
    v_sub_f32 v71, v71, v112
    v_sub_f32 v72, v72, v112
    ds_read_b128 a[12:15], v9 offset:768
    buffer_load_dwordx4 v2, s[8:11], s29 offen lds
    s_add_u32 m0, s41, 3168
    s_add_u32 s29, s29, 8192
    s_waitcnt lgkmcnt(8)
    v_mfma_f32_16x16x32_bf16 v[32:35], v[12:15], a[112:115], 0
    ds_read_b64_tr_b16 a[68:69], v10 offset:32
    ds_read_b64_tr_b16 a[70:71], v10 offset:288
    v_sub_f32 v73, v73, v112
    s_waitcnt lgkmcnt(8)
    v_mfma_f32_16x16x32_bf16 v[36:39], v[12:15], a[116:119], 0
    ds_read_b64_tr_b16 a[72:73], v10 offset:64
    ds_read_b64_tr_b16 a[74:75], v10 offset:320
    v_sub_f32 v74, v74, v112
    ds_read_b64_tr_b16 a[76:77], v10 offset:96
    v_sub_f32 v75, v75, v112
    v_sub_f32 v76, v76, v112
    ds_read_b64_tr_b16 a[78:79], v10 offset:352
    v_sub_f32 v77, v77, v112
    s_waitcnt lgkmcnt(9)
    v_mfma_f32_16x16x32_bf16 v[128:131], a[64:67], a[0:3], 0
    buffer_load_dwordx4 v2, s[8:11], s29 offen lds
    s_waitcnt lgkmcnt(8)
    v_mfma_f32_16x16x32_bf16 v[132:135], a[64:67], a[4:7], 0
    s_add_u32 m0, s40, 0
    ds_read_b64_tr_b16 a[80:81], v10 offset:128
    s_waitcnt lgkmcnt(8)
    v_mfma_f32_16x16x32_bf16 v[136:139], a[64:67], a[8:11], 0
    ds_read_b64_tr_b16 a[82:83], v10 offset:384
    ds_read_b64_tr_b16 a[84:85], v10 offset:160
    s_waitcnt lgkmcnt(9)
    v_mfma_f32_16x16x32_bf16 v[140:143], a[64:67], a[12:15], 0
    ds_read_b64_tr_b16 a[86:87], v10 offset:416
    s_lshl_b32 s29, s32, 19
    ds_read_b64_tr_b16 a[88:89], v10 offset:192
    s_add_u32 s29, s29, s43
    ds_read_b64_tr_b16 a[90:91], v10 offset:448
    s_xor_b32 s32, s51, 4
    s_waitcnt lgkmcnt(10)
    v_mfma_f32_16x16x32_bf16 v[144:147], a[68:71], a[0:3], 0
    buffer_load_dwordx4 v1, s[4:7], s28 offen offset:0 lds
    v_mfma_f32_16x16x32_bf16 v[148:151], a[68:71], a[4:7], 0
    s_add_u32 m0, s40, 32
    ds_read_b64_tr_b16 a[92:93], v10 offset:224
    v_mfma_f32_16x16x32_bf16 v[152:155], a[68:71], a[8:11], 0
    ds_read_b64_tr_b16 a[94:95], v10 offset:480
    ds_read_b64_tr_b16 a[176:177], v11 offset:8448
    v_mfma_f32_16x16x32_bf16 v[156:159], a[68:71], a[12:15], 0
    ds_read_b64_tr_b16 a[178:179], v11 offset:8704
    s_add_u32 s32, s32, s50
    s_waitcnt lgkmcnt(10)
    v_mfma_f32_16x16x32_bf16 v[160:163], a[72:75], a[0:3], 0
    ds_read_b64_tr_b16 a[180:181], v11 offset:8480
    ds_read_b64_tr_b16 a[182:183], v11 offset:8736
    v_mfma_f32_16x16x32_bf16 v[164:167], a[72:75], a[4:7], 0
    buffer_load_dwordx4 v1, s[4:7], s28 offen offset:2048 lds
    v_mfma_f32_16x16x32_bf16 v[168:171], a[72:75], a[8:11], 0
    s_add_u32 m0, s40, 1040
    s_add_u32 s28, s28, 4096
    v_mfma_f32_16x16x32_bf16 v[172:175], a[72:75], a[12:15], 0
    ds_read_b64_tr_b16 a[128:129], v10 offset:8448
    ds_read_b64_tr_b16 a[130:131], v10 offset:8704
    v_mfma_f32_16x16x32_bf16 v[176:179], a[76:79], a[0:3], 0
    ds_read_b64_tr_b16 a[132:133], v10 offset:8480
    s_and_b32 s32, s32, 7
    v_mfma_f32_16x16x32_bf16 v[180:183], a[76:79], a[4:7], 0
    ds_read_b64_tr_b16 a[134:135], v10 offset:8736
    ds_read_b64_tr_b16 a[136:137], v10 offset:8512
    v_mfma_f32_16x16x32_bf16 v[184:187], a[76:79], a[8:11], 0
    buffer_load_dwordx4 v1, s[4:7], s28 offen offset:0 lds
    v_mfma_f32_16x16x32_bf16 v[188:191], a[76:79], a[12:15], 0
    s_add_u32 m0, s40, 1072
    ds_read_b64_tr_b16 a[138:139], v10 offset:8768
    s_waitcnt lgkmcnt(8)
    v_mfma_f32_16x16x32_bf16 v[192:195], a[80:83], a[0:3], 0
    ds_read_b64_tr_b16 a[140:141], v10 offset:8544
    ds_read_b64_tr_b16 a[142:143], v10 offset:8800
    v_mfma_f32_16x16x32_bf16 v[196:199], a[80:83], a[4:7], 0
    ds_read_b64_tr_b16 a[144:145], v10 offset:8576
    v_sub_f32 v78, v78, v112
    v_mfma_f32_16x16x32_bf16 v[200:203], a[80:83], a[8:11], 0
    ds_read_b64_tr_b16 a[146:147], v10 offset:8832
    ds_read_b64_tr_b16 a[148:149], v10 offset:8608
    v_mfma_f32_16x16x32_bf16 v[204:207], a[80:83], a[12:15], 0
    buffer_load_dwordx4 v1, s[4:7], s28 offen offset:2048 lds
    v_mfma_f32_16x16x32_bf16 v[208:211], a[84:87], a[0:3], 0
    s_add_u32 m0, s40, 5200
    s_add_u32 s28, s28, 4096
    v_mfma_f32_16x16x32_bf16 v[212:215], a[84:87], a[4:7], 0
    ds_read_b64_tr_b16 a[150:151], v10 offset:8864
    ds_read_b64_tr_b16 a[152:153], v10 offset:8640
    v_mfma_f32_16x16x32_bf16 v[216:219], a[84:87], a[8:11], 0
    ds_read_b64_tr_b16 a[154:155], v10 offset:8896
    v_sub_f32 v79, v79, v112
    v_mfma_f32_16x16x32_bf16 v[220:223], a[84:87], a[12:15], 0
    ds_read_b64_tr_b16 a[156:157], v10 offset:8672
    ds_read_b64_tr_b16 a[158:159], v10 offset:8928
    v_mfma_f32_16x16x32_bf16 v[224:227], a[88:91], a[0:3], 0
    buffer_load_dwordx4 v1, s[4:7], s28 offen offset:0 lds
    v_mfma_f32_16x16x32_bf16 v[228:231], a[88:91], a[4:7], 0
    s_add_u32 m0, s40, 5232
    ds_read_b128 a[16:19], v9 offset:64
    v_mfma_f32_16x16x32_bf16 v[232:235], a[88:91], a[8:11], 0
    ds_read_b128 a[20:23], v9 offset:320
    v_add_u32 v10, 100864, v6
    v_mfma_f32_16x16x32_bf16 v[236:239], a[88:91], a[12:15], 0
    v_lshl_add_u32 v11, s3, 6, v10
    ds_read_b128 a[24:27], v9 offset:576
    v_mfma_f32_16x16x32_bf16 v[240:243], a[92:95], a[0:3], 0
    v_cvt_pk_bf16_f32 v80, v64, v65
    v_cvt_pk_bf16_f32 v81, v66, v67
    v_mfma_f32_16x16x32_bf16 v[244:247], a[92:95], a[4:7], 0
    buffer_load_dwordx4 v1, s[4:7], s28 offen offset:2048 lds
    v_mfma_f32_16x16x32_bf16 v[248:251], a[92:95], a[8:11], 0
    s_add_u32 m0, s40, 4160
    s_add_u32 s28, s28, 4096
    v_mfma_f32_16x16x32_bf16 v[252:255], a[92:95], a[12:15], 0
    ds_read_b128 a[28:31], v9 offset:832
    v_add_u32 v9, 100864, v5
    v_mfma_f32_16x16x32_bf16 v[32:35], v[12:15], a[176:179], v[32:35]
    v_cvt_pk_bf16_f32 v82, v68, v69
    v_cvt_pk_bf16_f32 v83, v70, v71
    s_waitcnt lgkmcnt(4)
    v_mfma_f32_16x16x32_bf16 v[36:39], v[12:15], a[180:183], v[36:39]
    v_cvt_pk_bf16_f32 v84, v72, v73
    v_cvt_pk_bf16_f32 v85, v74, v75
    s_waitcnt lgkmcnt(3)
    v_mfma_f32_16x16x32_bf16 v[128:131], a[128:131], a[16:19], v[128:131]
    buffer_load_dwordx4 v1, s[4:7], s28 offen offset:0 lds
    s_waitcnt lgkmcnt(2)
    v_mfma_f32_16x16x32_bf16 v[132:135], a[128:131], a[20:23], v[132:135]
    s_add_u32 m0, s40, 4192
    v_cvt_pk_bf16_f32 v86, v76, v77
    s_waitcnt lgkmcnt(1)
    v_mfma_f32_16x16x32_bf16 v[136:139], a[128:131], a[24:27], v[136:139]
    v_cvt_pk_bf16_f32 v87, v78, v79
    v_lshlrev_b32 v64, 16, v80
    v_and_b32 v65, 0xffff0000, v80
    v_lshlrev_b32 v66, 16, v81
    v_and_b32 v67, 0xffff0000, v81
    v_lshlrev_b32 v68, 16, v82
    v_and_b32 v69, 0xffff0000, v82
    v_lshlrev_b32 v70, 16, v83
    v_and_b32 v71, 0xffff0000, v83
    v_lshlrev_b32 v72, 16, v84
    v_and_b32 v73, 0xffff0000, v84
    v_lshlrev_b32 v74, 16, v85
    s_waitcnt lgkmcnt(0)
    v_mfma_f32_16x16x32_bf16 v[140:143], a[128:131], a[28:31], v[140:143]
    buffer_load_dwordx4 v1, s[4:7], s28 offen offset:2048 lds
    v_mfma_f32_16x16x32_bf16 v[144:147], a[132:135], a[16:19], v[144:147]
    s_waitcnt vmcnt(12)
    s_barrier
    v_mfma_f32_16x16x32_bf16 v[148:151], a[132:135], a[20:23], v[148:151]
    s_lshl_b32 s28, s34, 7
    s_add_u32 m0, s40, 50432
    v_mfma_f32_16x16x32_bf16 v[152:155], a[132:135], a[24:27], v[152:155]
    s_add_u32 s28, s28, s42
    ds_read_b128 a[96:99], v9 offset:0
    v_mfma_f32_16x16x32_bf16 v[156:159], a[132:135], a[28:31], v[156:159]
    buffer_load_dwordx4 v1, s[4:7], s28 offen offset:0 lds
    v_mfma_f32_16x16x32_bf16 v[160:163], a[136:139], a[16:19], v[160:163]
    s_add_u32 m0, s40, 50464
    ds_read_b128 a[100:103], v9 offset:256
    v_mfma_f32_16x16x32_bf16 v[164:167], a[136:139], a[20:23], v[164:167]
    ds_read_b128 a[104:107], v9 offset:512
    s_xor_b32 s34, s51, 4
    v_mfma_f32_16x16x32_bf16 v[168:171], a[136:139], a[24:27], v[168:171]
    s_add_u32 s34, s34, s50
    ds_read_b128 a[108:111], v9 offset:768
    v_mfma_f32_16x16x32_bf16 v[172:175], a[136:139], a[28:31], v[172:175]
    s_and_b32 s34, s34, 7
    v_and_b32 v75, 0xffff0000, v85
    v_mfma_f32_16x16x32_bf16 v[176:179], a[140:143], a[16:19], v[176:179]
    buffer_load_dwordx4 v1, s[4:7], s28 offen offset:2048 lds
    v_mfma_f32_16x16x32_bf16 v[180:183], a[140:143], a[20:23], v[180:183]
    s_add_u32 m0, s40, 51472
    s_add_u32 s28, s28, 4096
    v_mfma_f32_16x16x32_bf16 v[184:187], a[140:143], a[24:27], v[184:187]
    ds_read_b128 a[160:163], v9 offset:64
    v_lshlrev_b32 v76, 16, v86
    v_mfma_f32_16x16x32_bf16 v[188:191], a[140:143], a[28:31], v[188:191]
    ds_read_b128 a[164:167], v9 offset:320
    v_and_b32 v77, 0xffff0000, v86
    v_mfma_f32_16x16x32_bf16 v[192:195], a[144:147], a[16:19], v[192:195]
    ds_read_b128 a[168:171], v9 offset:576
    v_lshlrev_b32 v78, 16, v87
    v_mfma_f32_16x16x32_bf16 v[196:199], a[144:147], a[20:23], v[196:199]
    buffer_load_dwordx4 v1, s[4:7], s28 offen offset:0 lds
    v_mfma_f32_16x16x32_bf16 v[200:203], a[144:147], a[24:27], v[200:203]
    s_add_u32 m0, s40, 51504
    ds_read_b128 a[172:175], v9 offset:832
    v_mfma_f32_16x16x32_bf16 v[204:207], a[144:147], a[28:31], v[204:207]
    ds_read_b64_tr_b16 a[112:113], v11 offset:0
    v_add_u32 v9, 0, v5
    v_mfma_f32_16x16x32_bf16 v[208:211], a[148:151], a[16:19], v[208:211]
    ds_read_b64_tr_b16 a[114:115], v11 offset:256
    ds_read_b64_tr_b16 a[116:117], v11 offset:32
    v_mfma_f32_16x16x32_bf16 v[212:215], a[148:151], a[20:23], v[212:215]
    ds_read_b64_tr_b16 a[118:119], v11 offset:288
    v_and_b32 v79, 0xffff0000, v87
    v_mfma_f32_16x16x32_bf16 v[216:219], a[148:151], a[24:27], v[216:219]
    buffer_load_dwordx4 v1, s[4:7], s28 offen offset:2048 lds
    v_mfma_f32_16x16x32_bf16 v[220:223], a[148:151], a[28:31], v[220:223]
    s_add_u32 m0, s40, 55632
    s_add_u32 s28, s28, 4096
    v_mfma_f32_16x16x32_bf16 v[224:227], a[152:155], a[16:19], v[224:227]
    ds_read_b64_tr_b16 a[64:65], v10 offset:0
    ds_read_b64_tr_b16 a[66:67], v10 offset:256
    v_mfma_f32_16x16x32_bf16 v[228:231], a[152:155], a[20:23], v[228:231]
    ds_read_b64_tr_b16 a[68:69], v10 offset:32
    v_mul_f32 v64, v64, v113
    v_mfma_f32_16x16x32_bf16 v[232:235], a[152:155], a[24:27], v[232:235]
    ds_read_b64_tr_b16 a[70:71], v10 offset:288
    ds_read_b64_tr_b16 a[72:73], v10 offset:64
    v_mfma_f32_16x16x32_bf16 v[236:239], a[152:155], a[28:31], v[236:239]
    buffer_load_dwordx4 v1, s[4:7], s28 offen offset:0 lds
    v_mfma_f32_16x16x32_bf16 v[240:243], a[156:159], a[16:19], v[240:243]
    s_add_u32 m0, s40, 55664
    ds_read_b64_tr_b16 a[74:75], v10 offset:320
    v_mfma_f32_16x16x32_bf16 v[244:247], a[156:159], a[20:23], v[244:247]
    ds_read_b64_tr_b16 a[76:77], v10 offset:96
    ds_read_b64_tr_b16 a[78:79], v10 offset:352
    v_mfma_f32_16x16x32_bf16 v[248:251], a[156:159], a[24:27], v[248:251]
    ds_read_b64_tr_b16 a[80:81], v10 offset:128
    v_mul_f32 v65, v65, v113
    v_mfma_f32_16x16x32_bf16 v[252:255], a[156:159], a[28:31], v[252:255]
    ds_read_b64_tr_b16 a[82:83], v10 offset:384
    ds_read_b64_tr_b16 a[84:85], v10 offset:160
    s_waitcnt lgkmcnt(11)
    v_mfma_f32_16x16x32_bf16 v[32:35], v[12:15], a[112:115], v[32:35]
    buffer_load_dwordx4 v1, s[4:7], s28 offen offset:2048 lds
    v_mfma_f32_16x16x32_bf16 v[36:39], v[12:15], a[116:119], v[36:39]
    s_add_u32 m0, s40, 54592
    s_add_u32 s28, s28, 4096
    s_waitcnt lgkmcnt(8)
    v_mfma_f32_16x16x32_bf16 v[128:131], a[64:67], a[96:99], v[128:131]
    ds_read_b64_tr_b16 a[86:87], v10 offset:416
    ds_read_b64_tr_b16 a[88:89], v10 offset:192
    v_mfma_f32_16x16x32_bf16 v[132:135], a[64:67], a[100:103], v[132:135]
    ds_read_b64_tr_b16 a[90:91], v10 offset:448
    v_mul_f32 v66, v66, v113
    v_mfma_f32_16x16x32_bf16 v[136:139], a[64:67], a[104:107], v[136:139]
    ds_read_b64_tr_b16 a[92:93], v10 offset:224
    ds_read_b64_tr_b16 a[94:95], v10 offset:480
    v_mfma_f32_16x16x32_bf16 v[140:143], a[64:67], a[108:111], v[140:143]
    buffer_load_dwordx4 v1, s[4:7], s28 offen offset:0 lds
    s_waitcnt lgkmcnt(8)
    v_mfma_f32_16x16x32_bf16 v[144:147], a[68:71], a[96:99], v[144:147]
    s_add_u32 m0, s40, 54624
    ds_read_b64_tr_b16 a[176:177], v11 offset:8448
    v_mfma_f32_16x16x32_bf16 v[148:151], a[68:71], a[100:103], v[148:151]
    ds_read_b64_tr_b16 a[178:179], v11 offset:8704
    ds_read_b64_tr_b16 a[180:181], v11 offset:8480
    v_mfma_f32_16x16x32_bf16 v[152:155], a[68:71], a[104:107], v[152:155]
    ds_read_b64_tr_b16 a[182:183], v11 offset:8736
    v_mul_f32 v67, v67, v113
    v_mfma_f32_16x16x32_bf16 v[156:159], a[68:71], a[108:111], v[156:159]
    ds_read_b64_tr_b16 a[128:129], v10 offset:8448
    ds_read_b64_tr_b16 a[130:131], v10 offset:8704
    v_mfma_f32_16x16x32_bf16 v[160:163], a[72:75], a[96:99], v[160:163]
    buffer_load_dwordx4 v1, s[4:7], s28 offen offset:2048 lds
    v_mfma_f32_16x16x32_bf16 v[164:167], a[72:75], a[100:103], v[164:167]
    s_add_u32 m0, s41, 50432
    s_lshl_b32 s28, s34, 7
    v_mfma_f32_16x16x32_bf16 v[168:171], a[72:75], a[104:107], v[168:171]
    s_add_u32 s28, s28, s42
    ds_read_b64_tr_b16 a[132:133], v10 offset:8480
    v_mfma_f32_16x16x32_bf16 v[172:175], a[72:75], a[108:111], v[172:175]
    ds_read_b64_tr_b16 a[134:135], v10 offset:8736
    ds_read_b64_tr_b16 a[136:137], v10 offset:8512
    v_mfma_f32_16x16x32_bf16 v[176:179], a[76:79], a[96:99], v[176:179]
    ds_read_b64_tr_b16 a[138:139], v10 offset:8768
    s_xor_b32 s34, s51, 5
    v_mfma_f32_16x16x32_bf16 v[180:183], a[76:79], a[100:103], v[180:183]
    buffer_load_dwordx4 v2, s[8:11], s29 offen lds
    v_mfma_f32_16x16x32_bf16 v[184:187], a[76:79], a[104:107], v[184:187]
    s_add_u32 m0, s41, 51488
    s_add_u32 s29, s29, 8192
    v_mfma_f32_16x16x32_bf16 v[188:191], a[76:79], a[108:111], v[188:191]
    ds_read_b64_tr_b16 a[140:141], v10 offset:8544
    ds_read_b64_tr_b16 a[142:143], v10 offset:8800
    s_waitcnt lgkmcnt(6)
    v_mfma_f32_16x16x32_bf16 v[192:195], a[80:83], a[96:99], v[192:195]
    ds_read_b64_tr_b16 a[144:145], v10 offset:8576
    s_add_u32 s34, s34, s50
    v_mfma_f32_16x16x32_bf16 v[196:199], a[80:83], a[100:103], v[196:199]
    ds_read_b64_tr_b16 a[146:147], v10 offset:8832
    ds_read_b64_tr_b16 a[148:149], v10 offset:8608
    v_mfma_f32_16x16x32_bf16 v[200:203], a[80:83], a[104:107], v[200:203]
    buffer_load_dwordx4 v2, s[8:11], s29 offen lds
    v_mfma_f32_16x16x32_bf16 v[204:207], a[80:83], a[108:111], v[204:207]
    s_add_u32 m0, s41, 52544
    s_add_u32 s29, s29, 8192
    v_mfma_f32_16x16x32_bf16 v[208:211], a[84:87], a[96:99], v[208:211]
    ds_read_b64_tr_b16 a[150:151], v10 offset:8864
    ds_read_b64_tr_b16 a[152:153], v10 offset:8640
    v_mfma_f32_16x16x32_bf16 v[212:215], a[84:87], a[100:103], v[212:215]
    ds_read_b64_tr_b16 a[154:155], v10 offset:8896
    s_and_b32 s34, s34, 7
    v_mfma_f32_16x16x32_bf16 v[216:219], a[84:87], a[104:107], v[216:219]
    ds_read_b64_tr_b16 a[156:157], v10 offset:8672
    ds_read_b64_tr_b16 a[158:159], v10 offset:8928
    v_mfma_f32_16x16x32_bf16 v[220:223], a[84:87], a[108:111], v[220:223]
    buffer_load_dwordx4 v2, s[8:11], s29 offen lds
    v_mfma_f32_16x16x32_bf16 v[224:227], a[88:91], a[96:99], v[224:227]
    s_add_u32 m0, s41, 53600
    s_add_u32 s29, s29, 8192
    v_mfma_f32_16x16x32_bf16 v[228:231], a[88:91], a[100:103], v[228:231]
    v_add_u32 v10, 0, v6
    v_lshl_add_u32 v11, s3, 6, v10
    v_mfma_f32_16x16x32_bf16 v[232:235], a[88:91], a[104:107], v[232:235]
    v_mul_f32 v68, v68, v113
    v_mul_f32 v69, v69, v113
    v_mfma_f32_16x16x32_bf16 v[236:239], a[88:91], a[108:111], v[236:239]
    v_mul_f32 v70, v70, v113
    v_mul_f32 v71, v71, v113
    v_mfma_f32_16x16x32_bf16 v[240:243], a[92:95], a[96:99], v[240:243]
    buffer_load_dwordx4 v2, s[8:11], s29 offen lds
    v_mfma_f32_16x16x32_bf16 v[244:247], a[92:95], a[100:103], v[244:247]
    s_add_u32 m0, s40, 100864
    s_lshl_b32 s29, s32, 19
    v_mfma_f32_16x16x32_bf16 v[248:251], a[92:95], a[104:107], v[248:251]
    s_add_u32 s29, s29, s43
    s_xor_b32 s32, s51, 5
    v_mfma_f32_16x16x32_bf16 v[252:255], a[92:95], a[108:111], v[252:255]
    s_add_u32 s32, s32, s50
    s_and_b32 s32, s32, 7
    v_mfma_f32_16x16x32_bf16 v[32:35], v[12:15], a[176:179], v[32:35]
    v_mul_f32 v72, v72, v113
    v_mul_f32 v73, v73, v113
    v_mfma_f32_16x16x32_bf16 v[36:39], v[12:15], a[180:183], v[36:39]
    buffer_load_dwordx4 v1, s[4:7], s28 offen offset:0 lds
    v_mfma_f32_16x16x32_bf16 v[128:131], a[128:131], a[160:163], v[128:131]
    s_add_u32 m0, s40, 100896
    v_mul_f32 v74, v74, v113
    v_mfma_f32_16x16x32_bf16 v[132:135], a[128:131], a[164:167], v[132:135]
    v_mul_f32 v75, v75, v113
    v_mul_f32 v76, v76, v113
    v_mfma_f32_16x16x32_bf16 v[136:139], a[128:131], a[168:171], v[136:139]
    v_mul_f32 v77, v77, v113
    v_mul_f32 v78, v78, v113
    v_mfma_f32_16x16x32_bf16 v[140:143], a[128:131], a[172:175], v[140:143]
    v_mul_f32 v79, v79, v113
    v_cvt_pk_bf16_f32 v80, v64, v65
    s_waitcnt lgkmcnt(0)
    v_mfma_f32_16x16x32_bf16 v[144:147], a[132:135], a[160:163], v[144:147]
    buffer_load_dwordx4 v1, s[4:7], s28 offen offset:2048 lds
    v_mfma_f32_16x16x32_bf16 v[148:151], a[132:135], a[164:167], v[148:151]
    s_waitcnt vmcnt(14)
    s_barrier
    v_mfma_f32_16x16x32_bf16 v[152:155], a[132:135], a[168:171], v[152:155]
    s_add_u32 m0, s40, 101904
    s_add_u32 s28, s28, 4096
    v_mfma_f32_16x16x32_bf16 v[156:159], a[132:135], a[172:175], v[156:159]
    buffer_load_dwordx4 v1, s[4:7], s28 offen offset:0 lds
    v_mfma_f32_16x16x32_bf16 v[160:163], a[136:139], a[160:163], v[160:163]
    s_add_u32 m0, s40, 101936
    ds_read_b128 a[0:3], v9 offset:0
    v_mfma_f32_16x16x32_bf16 v[164:167], a[136:139], a[164:167], v[164:167]
    ds_read_b128 a[4:7], v9 offset:256
    v_cvt_pk_bf16_f32 v81, v66, v67
    v_mfma_f32_16x16x32_bf16 v[168:171], a[136:139], a[168:171], v[168:171]
    v_cvt_pk_bf16_f32 v82, v68, v69
    ds_read_b128 a[8:11], v9 offset:512
    v_mfma_f32_16x16x32_bf16 v[172:175], a[136:139], a[172:175], v[172:175]
    v_cvt_pk_bf16_f32 v83, v70, v71
    v_cvt_pk_bf16_f32 v84, v72, v73
    v_mfma_f32_16x16x32_bf16 v[176:179], a[140:143], a[160:163], v[176:179]
    buffer_load_dwordx4 v1, s[4:7], s28 offen offset:2048 lds
    v_mfma_f32_16x16x32_bf16 v[180:183], a[140:143], a[164:167], v[180:183]
    s_add_u32 m0, s40, 106064
    s_add_u32 s28, s28, 4096
    v_mfma_f32_16x16x32_bf16 v[184:187], a[140:143], a[168:171], v[184:187]
    ds_read_b128 a[12:15], v9 offset:768
    v_cvt_pk_bf16_f32 v85, v74, v75
    v_mfma_f32_16x16x32_bf16 v[188:191], a[140:143], a[172:175], v[188:191]
    ds_read_b128 a[16:19], v9 offset:64
    v_cvt_pk_bf16_f32 v86, v76, v77
    v_mfma_f32_16x16x32_bf16 v[192:195], a[144:147], a[160:163], v[192:195]
    ds_read_b128 a[20:23], v9 offset:320
    v_cvt_pk_bf16_f32 v87, v78, v79
    v_mfma_f32_16x16x32_bf16 v[196:199], a[144:147], a[164:167], v[196:199]
    buffer_load_dwordx4 v1, s[4:7], s28 offen offset:0 lds
    v_mfma_f32_16x16x32_bf16 v[200:203], a[144:147], a[168:171], v[200:203]
    s_add_u32 m0, s40, 106096
    ds_read_b128 a[24:27], v9 offset:576
    v_mfma_f32_16x16x32_bf16 v[204:207], a[144:147], a[172:175], v[204:207]
    ds_read_b128 a[28:31], v9 offset:832
    v_add_u32 v9, 50432, v5
    v_mfma_f32_16x16x32_bf16 v[208:211], a[148:151], a[160:163], v[208:211]
    v_mov_b32 v114, 0
    ds_read_b64_tr_b16 a[112:113], v11 offset:0
    v_mfma_f32_16x16x32_bf16 v[212:215], a[148:151], a[164:167], v[212:215]
    ds_read_b64_tr_b16 a[114:115], v11 offset:256
    s_mov_b32 s38, 0xffff
    v_mfma_f32_16x16x32_bf16 v[216:219], a[148:151], a[168:171], v[216:219]
    buffer_load_dwordx4 v1, s[4:7], s28 offen offset:2048 lds
    v_mfma_f32_16x16x32_bf16 v[220:223], a[148:151], a[172:175], v[220:223]
    s_add_u32 m0, s40, 105024
    s_add_u32 s28, s28, 4096
    v_mfma_f32_16x16x32_bf16 v[224:227], a[152:155], a[160:163], v[224:227]
    ds_read_b64_tr_b16 a[116:117], v11 offset:32
    ds_read_b64_tr_b16 a[118:119], v11 offset:288
    v_mfma_f32_16x16x32_bf16 v[228:231], a[152:155], a[164:167], v[228:231]
    ds_read_b64_tr_b16 a[64:65], v10 offset:0
    s_mov_b32 s37, 24117304
    v_mfma_f32_16x16x32_bf16 v[232:235], a[152:155], a[168:171], v[232:235]
    ds_read_b64_tr_b16 a[66:67], v10 offset:256
    ds_read_b64_tr_b16 a[68:69], v10 offset:32
    v_mfma_f32_16x16x32_bf16 v[236:239], a[152:155], a[172:175], v[236:239]
    buffer_load_dwordx4 v1, s[4:7], s28 offen offset:0 lds
    v_mfma_f32_16x16x32_bf16 v[240:243], a[156:159], a[160:163], v[240:243]
    s_add_u32 m0, s40, 105056
    ds_read_b64_tr_b16 a[70:71], v10 offset:288
    v_mfma_f32_16x16x32_bf16 v[244:247], a[156:159], a[164:167], v[244:247]
    ds_read_b64_tr_b16 a[72:73], v10 offset:64
    ds_read_b64_tr_b16 a[74:75], v10 offset:320
    v_mfma_f32_16x16x32_bf16 v[248:251], a[156:159], a[168:171], v[248:251]
    ds_read_b64_tr_b16 a[76:77], v10 offset:96
    s_lshr_b32 s36, s2, 3
    v_mfma_f32_16x16x32_bf16 v[252:255], a[156:159], a[172:175], v[252:255]
    ds_read_b64_tr_b16 a[78:79], v10 offset:352
    ds_read_b64_tr_b16 a[80:81], v10 offset:128
    s_waitcnt lgkmcnt(11)
    v_mfma_f32_16x16x32_bf16 v[32:35], v[12:15], a[112:115], v[32:35]
    buffer_load_dwordx4 v1, s[4:7], s28 offen offset:2048 lds
    s_waitcnt lgkmcnt(9)
    v_mfma_f32_16x16x32_bf16 v[36:39], v[12:15], a[116:119], v[36:39]
    s_add_u32 m0, s41, 100864
    s_lshl_b32 s28, s34, 7
    s_add_u32 s28, s28, s42
    ds_read_b64_tr_b16 a[82:83], v10 offset:384
    s_waitcnt lgkmcnt(8)
    v_mfma_f32_16x16x32_bf16 v[128:131], a[64:67], a[0:3], v[128:131]
    ds_read_b64_tr_b16 a[84:85], v10 offset:160
    ds_read_b64_tr_b16 a[86:87], v10 offset:416
    v_mfma_f32_16x16x32_bf16 v[132:135], a[64:67], a[4:7], v[132:135]
    ds_read_b64_tr_b16 a[88:89], v10 offset:192
    s_xor_b32 s34, s51, 6
    v_mfma_f32_16x16x32_bf16 v[136:139], a[64:67], a[8:11], v[136:139]
    ds_read_b64_tr_b16 a[90:91], v10 offset:448
    ds_read_b64_tr_b16 a[92:93], v10 offset:224
    v_mfma_f32_16x16x32_bf16 v[140:143], a[64:67], a[12:15], v[140:143]
    buffer_load_dwordx4 v2, s[8:11], s29 offen lds
    s_waitcnt lgkmcnt(8)
    v_mfma_f32_16x16x32_bf16 v[144:147], a[68:71], a[0:3], v[144:147]
    s_add_u32 m0, s41, 101920
    s_add_u32 s29, s29, 8192
    v_mfma_f32_16x16x32_bf16 v[148:151], a[68:71], a[4:7], v[148:151]
    ds_read_b64_tr_b16 a[94:95], v10 offset:480
    ds_read_b64_tr_b16 a[176:177], v11 offset:8448
    v_mfma_f32_16x16x32_bf16 v[152:155], a[68:71], a[8:11], v[152:155]
    ds_read_b64_tr_b16 a[178:179], v11 offset:8704
    s_add_u32 s34, s34, s50
    v_mfma_f32_16x16x32_bf16 v[156:159], a[68:71], a[12:15], v[156:159]
    ds_read_b64_tr_b16 a[180:181], v11 offset:8480
    ds_read_b64_tr_b16 a[182:183], v11 offset:8736
    v_mfma_f32_16x16x32_bf16 v[160:163], a[72:75], a[0:3], v[160:163]
    buffer_load_dwordx4 v2, s[8:11], s29 offen lds
    v_mfma_f32_16x16x32_bf16 v[164:167], a[72:75], a[4:7], v[164:167]
    s_add_u32 m0, s41, 102976
    s_add_u32 s29, s29, 8192
    v_mfma_f32_16x16x32_bf16 v[168:171], a[72:75], a[8:11], v[168:171]
    ds_read_b64_tr_b16 a[128:129], v10 offset:8448
    ds_read_b64_tr_b16 a[130:131], v10 offset:8704
    v_mfma_f32_16x16x32_bf16 v[172:175], a[72:75], a[12:15], v[172:175]
    ds_read_b64_tr_b16 a[132:133], v10 offset:8480
    s_and_b32 s34, s34, 7
    s_waitcnt lgkmcnt(8)
    v_mfma_f32_16x16x32_bf16 v[176:179], a[76:79], a[0:3], v[176:179]
    ds_read_b64_tr_b16 a[134:135], v10 offset:8736
    ds_read_b64_tr_b16 a[136:137], v10 offset:8512
    v_mfma_f32_16x16x32_bf16 v[180:183], a[76:79], a[4:7], v[180:183]
    buffer_load_dwordx4 v2, s[8:11], s29 offen lds
    v_mfma_f32_16x16x32_bf16 v[184:187], a[76:79], a[8:11], v[184:187]
    s_add_u32 m0, s41, 104032
    s_add_u32 s29, s29, 8192
    v_mfma_f32_16x16x32_bf16 v[188:191], a[76:79], a[12:15], v[188:191]
    ds_read_b64_tr_b16 a[138:139], v10 offset:8768
    ds_read_b64_tr_b16 a[140:141], v10 offset:8544
    v_mfma_f32_16x16x32_bf16 v[192:195], a[80:83], a[0:3], v[192:195]
    ds_read_b64_tr_b16 a[142:143], v10 offset:8800
    s_lshl_b32 s36, s36, 2
    v_mfma_f32_16x16x32_bf16 v[196:199], a[80:83], a[4:7], v[196:199]
    ds_read_b64_tr_b16 a[144:145], v10 offset:8576
    ds_read_b64_tr_b16 a[146:147], v10 offset:8832
    v_mfma_f32_16x16x32_bf16 v[200:203], a[80:83], a[8:11], v[200:203]
    buffer_load_dwordx4 v2, s[8:11], s29 offen lds
    v_mfma_f32_16x16x32_bf16 v[204:207], a[80:83], a[12:15], v[204:207]
    s_add_u32 m0, s40, 0
    ds_read_b64_tr_b16 a[148:149], v10 offset:8608
    v_mfma_f32_16x16x32_bf16 v[208:211], a[84:87], a[0:3], v[208:211]
    ds_read_b64_tr_b16 a[150:151], v10 offset:8864
    ds_read_b64_tr_b16 a[152:153], v10 offset:8640
    v_mfma_f32_16x16x32_bf16 v[212:215], a[84:87], a[4:7], v[212:215]
    ds_read_b64_tr_b16 a[154:155], v10 offset:8896
    s_lshl_b32 s29, s32, 19
    v_mfma_f32_16x16x32_bf16 v[216:219], a[84:87], a[8:11], v[216:219]
    ds_read_b64_tr_b16 a[156:157], v10 offset:8672
    ds_read_b64_tr_b16 a[158:159], v10 offset:8928
    v_mfma_f32_16x16x32_bf16 v[220:223], a[84:87], a[12:15], v[220:223]
    buffer_load_dwordx4 v1, s[4:7], s28 offen offset:0 lds
    v_mfma_f32_16x16x32_bf16 v[224:227], a[88:91], a[0:3], v[224:227]
    s_add_u32 m0, s40, 32
    s_add_u32 s29, s29, s43
    v_mfma_f32_16x16x32_bf16 v[228:231], a[88:91], a[4:7], v[228:231]
    v_add_u32 v10, 50432, v6
    v_lshl_add_u32 v11, s3, 6, v10
    v_mfma_f32_16x16x32_bf16 v[232:235], a[88:91], a[8:11], v[232:235]
    s_xor_b32 s32, s51, 6
    s_add_u32 s32, s32, s50
    v_mfma_f32_16x16x32_bf16 v[236:239], a[88:91], a[12:15], v[236:239]
    s_and_b32 s32, s32, 7
    s_lshl_b32 s25, s27, 14
    s_waitcnt lgkmcnt(5)
    v_mfma_f32_16x16x32_bf16 v[240:243], a[92:95], a[0:3], v[240:243]
    buffer_load_dwordx4 v1, s[4:7], s28 offen offset:2048 lds
    v_mfma_f32_16x16x32_bf16 v[244:247], a[92:95], a[4:7], v[244:247]
    s_add_u32 m0, s40, 1040
    s_add_u32 s28, s28, 4096
    v_mfma_f32_16x16x32_bf16 v[248:251], a[92:95], a[8:11], v[248:251]
    s_add_u32 s36, s36, s3
    s_lshl_b32 s48, s27, 14
    v_mfma_f32_16x16x32_bf16 v[252:255], a[92:95], a[12:15], v[252:255]
    v_lshlrev_b32 v43, 6, v22
    s_add_u32 s47, s46, 8192
    v_mfma_f32_16x16x32_bf16 v[32:35], v[12:15], a[176:179], v[32:35]
    s_add_u32 s46, s46, 16384
    s_and_b32 s46, s46, 0x1ffff
    v_mfma_f32_16x16x32_bf16 v[36:39], v[12:15], a[180:183], v[36:39]
    buffer_load_dwordx4 v1, s[4:7], s28 offen offset:0 lds
    v_mfma_f32_16x16x32_bf16 v[128:131], a[128:131], a[16:19], v[128:131]
    s_add_u32 m0, s40, 1072
    s_add_u32 s47, s46, 8192
    v_mfma_f32_16x16x32_bf16 v[132:135], a[128:131], a[20:23], v[132:135]
    v_lshlrev_b32 v18, 3, v22
    v_add_u32 v18, 162560, v18
    v_mfma_f32_16x16x32_bf16 v[136:139], a[128:131], a[24:27], v[136:139]
    v_mov_b32 v57, 0
    v_mov_b32 v59, 0
    v_mfma_f32_16x16x32_bf16 v[140:143], a[128:131], a[28:31], v[140:143]
    v_mov_b32 v61, 0
    s_and_b32 s30, s53, 3
    v_mfma_f32_16x16x32_bf16 v[144:147], a[132:135], a[16:19], v[144:147]
    buffer_load_dwordx4 v1, s[4:7], s28 offen offset:2048 lds
    v_mfma_f32_16x16x32_bf16 v[148:151], a[132:135], a[20:23], v[148:151]
    s_waitcnt lgkmcnt(0)
    s_waitcnt vmcnt(16)
    s_barrier
    v_mfma_f32_16x16x32_bf16 v[152:155], a[132:135], a[24:27], v[152:155]
    s_add_u32 m0, s40, 5200
    s_add_u32 s28, s28, 4096
    v_mfma_f32_16x16x32_bf16 v[156:159], a[132:135], a[28:31], v[156:159]
    buffer_load_dwordx4 v1, s[4:7], s28 offen offset:0 lds
    v_mfma_f32_16x16x32_bf16 v[160:163], a[136:139], a[16:19], v[160:163]
    s_add_u32 m0, s40, 5232
    ds_read_b128 a[96:99], v9 offset:0
    v_mfma_f32_16x16x32_bf16 v[164:167], a[136:139], a[20:23], v[164:167]
    ds_read_b128 a[100:103], v9 offset:256
    s_mul_i32 s33, s3, 4192
    v_mfma_f32_16x16x32_bf16 v[168:171], a[136:139], a[24:27], v[168:171]
    s_cmp_lt_u32 s36, 48
    s_cselect_b32 s56, s78, s80
    v_mfma_f32_16x16x32_bf16 v[172:175], a[136:139], a[28:31], v[172:175]
    ds_read_b128 a[104:107], v9 offset:512
    v_mov_b32 v63, 0
    v_mfma_f32_16x16x32_bf16 v[176:179], a[140:143], a[16:19], v[176:179]
    buffer_load_dwordx4 v1, s[4:7], s28 offen offset:2048 lds
    v_mfma_f32_16x16x32_bf16 v[180:183], a[140:143], a[20:23], v[180:183]
    s_add_u32 m0, s40, 4160
    s_add_u32 s28, s28, 4096
    v_mfma_f32_16x16x32_bf16 v[184:187], a[140:143], a[24:27], v[184:187]
    ds_read_b128 a[108:111], v9 offset:768
    v_lshrrev_b32 v40, 1, v21
    v_mfma_f32_16x16x32_bf16 v[188:191], a[140:143], a[28:31], v[188:191]
    ds_read_b128 a[160:163], v9 offset:64
    v_and_b32 v41, 1, v21
    v_mfma_f32_16x16x32_bf16 v[192:195], a[144:147], a[16:19], v[192:195]
    ds_read_b128 a[164:167], v9 offset:320
    v_mul_u32_u24 v40, 2752, v40
    v_mfma_f32_16x16x32_bf16 v[196:199], a[144:147], a[20:23], v[196:199]
    buffer_load_dwordx4 v1, s[4:7], s28 offen offset:0 lds
    v_mfma_f32_16x16x32_bf16 v[200:203], a[144:147], a[24:27], v[200:203]
    s_add_u32 m0, s40, 4192
    ds_read_b128 a[168:171], v9 offset:576
    v_mfma_f32_16x16x32_bf16 v[204:207], a[144:147], a[28:31], v[204:207]
    ds_read_b128 a[172:175], v9 offset:832
    v_add_u32 v9, 100864, v5
    v_mfma_f32_16x16x32_bf16 v[208:211], a[148:151], a[16:19], v[208:211]
    s_cmp_lt_u32 s36, 48
    s_cselect_b32 s57, s79, s81
    v_mfma_f32_16x16x32_bf16 v[212:215], a[148:151], a[20:23], v[212:215]
    ds_read_b64_tr_b16 a[112:113], v11 offset:0
    ds_read_b64_tr_b16 a[114:115], v11 offset:256
    v_mfma_f32_16x16x32_bf16 v[216:219], a[148:151], a[24:27], v[216:219]
    buffer_load_dwordx4 v1, s[4:7], s28 offen offset:2048 lds
    v_mfma_f32_16x16x32_bf16 v[220:223], a[148:151], a[28:31], v[220:223]
    s_add_u32 m0, s41, 0
    s_lshl_b32 s28, s34, 7
    v_mfma_f32_16x16x32_bf16 v[224:227], a[152:155], a[16:19], v[224:227]
    s_add_u32 s28, s28, s42
    ds_read_b64_tr_b16 a[116:117], v11 offset:32
    v_mfma_f32_16x16x32_bf16 v[228:231], a[152:155], a[20:23], v[228:231]
    ds_read_b64_tr_b16 a[118:119], v11 offset:288
    ds_read_b64_tr_b16 a[64:65], v10 offset:0
    v_mfma_f32_16x16x32_bf16 v[232:235], a[152:155], a[24:27], v[232:235]
    ds_read_b64_tr_b16 a[66:67], v10 offset:256
    s_xor_b32 s34, s51, 7
    v_mfma_f32_16x16x32_bf16 v[236:239], a[152:155], a[28:31], v[236:239]
    buffer_load_dwordx4 v2, s[8:11], s29 offen lds
    v_mfma_f32_16x16x32_bf16 v[240:243], a[156:159], a[16:19], v[240:243]
    s_add_u32 m0, s41, 1056
    s_add_u32 s29, s29, 8192
    v_mfma_f32_16x16x32_bf16 v[244:247], a[156:159], a[20:23], v[244:247]
    ds_read_b64_tr_b16 a[68:69], v10 offset:32
    ds_read_b64_tr_b16 a[70:71], v10 offset:288
    v_mfma_f32_16x16x32_bf16 v[248:251], a[156:159], a[24:27], v[248:251]
    ds_read_b64_tr_b16 a[72:73], v10 offset:64
    s_add_u32 s34, s34, s50
    v_mfma_f32_16x16x32_bf16 v[252:255], a[156:159], a[28:31], v[252:255]
    ds_read_b64_tr_b16 a[74:75], v10 offset:320
    ds_read_b64_tr_b16 a[76:77], v10 offset:96
    s_waitcnt lgkmcnt(9)
    v_mfma_f32_16x16x32_bf16 v[32:35], v[12:15], a[112:115], v[32:35]
    buffer_load_dwordx4 v2, s[8:11], s29 offen lds
    s_add_u32 m0, s41, 2112
    s_add_u32 s29, s29, 8192
    s_waitcnt lgkmcnt(7)
    v_mfma_f32_16x16x32_bf16 v[36:39], v[12:15], a[116:119], v[36:39]
    ds_read_b64_tr_b16 a[78:79], v10 offset:352
    ds_read_b64_tr_b16 a[80:81], v10 offset:128
    s_waitcnt lgkmcnt(7)
    v_mfma_f32_16x16x32_bf16 v[128:131], a[64:67], a[96:99], v[128:131]
    ds_read_b64_tr_b16 a[82:83], v10 offset:384
    s_and_b32 s34, s34, 7
    v_mfma_f32_16x16x32_bf16 v[132:135], a[64:67], a[100:103], v[132:135]
    ds_read_b64_tr_b16 a[84:85], v10 offset:160
    ds_read_b64_tr_b16 a[86:87], v10 offset:416
    v_mfma_f32_16x16x32_bf16 v[136:139], a[64:67], a[104:107], v[136:139]
    ds_read_b64_tr_b16 a[88:89], v10 offset:192
    v_mul_u32_u24 v41, 124, v41
    v_mfma_f32_16x16x32_bf16 v[140:143], a[64:67], a[108:111], v[140:143]
    buffer_load_dwordx4 v2, s[8:11], s29 offen lds
    s_waitcnt lgkmcnt(8)
    v_mfma_f32_16x16x32_bf16 v[144:147], a[68:71], a[96:99], v[144:147]
    s_add_u32 m0, s41, 3168
    s_add_u32 s29, s29, 8192
    v_mfma_f32_16x16x32_bf16 v[148:151], a[68:71], a[100:103], v[148:151]
    ds_read_b64_tr_b16 a[90:91], v10 offset:448
    ds_read_b64_tr_b16 a[92:93], v10 offset:224
    v_mfma_f32_16x16x32_bf16 v[152:155], a[68:71], a[104:107], v[152:155]
    ds_read_b64_tr_b16 a[94:95], v10 offset:480
    v_add_u32 v40, v40, v41
    v_mfma_f32_16x16x32_bf16 v[156:159], a[68:71], a[108:111], v[156:159]
    ds_read_b64_tr_b16 a[176:177], v11 offset:8448
    ds_read_b64_tr_b16 a[178:179], v11 offset:8704
    s_waitcnt lgkmcnt(9)
    v_mfma_f32_16x16x32_bf16 v[160:163], a[72:75], a[96:99], v[160:163]
    buffer_load_dwordx4 v2, s[8:11], s29 offen lds
    v_mfma_f32_16x16x32_bf16 v[164:167], a[72:75], a[100:103], v[164:167]
    s_add_u32 m0, s40, 50432
    ds_read_b64_tr_b16 a[180:181], v11 offset:8480
    v_mfma_f32_16x16x32_bf16 v[168:171], a[72:75], a[104:107], v[168:171]
    ds_read_b64_tr_b16 a[182:183], v11 offset:8736
    ds_read_b64_tr_b16 a[128:129], v10 offset:8448
    v_mfma_f32_16x16x32_bf16 v[172:175], a[72:75], a[108:111], v[172:175]
    ds_read_b64_tr_b16 a[130:131], v10 offset:8704
    s_lshl_b32 s29, s32, 19
    v_mfma_f32_16x16x32_bf16 v[176:179], a[76:79], a[96:99], v[176:179]
    ds_read_b64_tr_b16 a[132:133], v10 offset:8480
    ds_read_b64_tr_b16 a[134:135], v10 offset:8736
    v_mfma_f32_16x16x32_bf16 v[180:183], a[76:79], a[100:103], v[180:183]
    buffer_load_dwordx4 v1, s[4:7], s28 offen offset:0 lds
    v_mfma_f32_16x16x32_bf16 v[184:187], a[76:79], a[104:107], v[184:187]
    s_add_u32 m0, s40, 50464
    ds_read_b64_tr_b16 a[136:137], v10 offset:8512
    v_mfma_f32_16x16x32_bf16 v[188:191], a[76:79], a[108:111], v[188:191]
    ds_read_b64_tr_b16 a[138:139], v10 offset:8768
    ds_read_b64_tr_b16 a[140:141], v10 offset:8544
    s_waitcnt lgkmcnt(9)
    v_mfma_f32_16x16x32_bf16 v[192:195], a[80:83], a[96:99], v[192:195]
    ds_read_b64_tr_b16 a[142:143], v10 offset:8800
    s_add_u32 s29, s29, s43
    v_mfma_f32_16x16x32_bf16 v[196:199], a[80:83], a[100:103], v[196:199]
    ds_read_b64_tr_b16 a[144:145], v10 offset:8576
    ds_read_b64_tr_b16 a[146:147], v10 offset:8832
    v_mfma_f32_16x16x32_bf16 v[200:203], a[80:83], a[104:107], v[200:203]
    buffer_load_dwordx4 v1, s[4:7], s28 offen offset:2048 lds
    v_mfma_f32_16x16x32_bf16 v[204:207], a[80:83], a[108:111], v[204:207]
    s_add_u32 m0, s40, 51472
    s_add_u32 s28, s28, 4096
    v_mfma_f32_16x16x32_bf16 v[208:211], a[84:87], a[96:99], v[208:211]
    ds_read_b64_tr_b16 a[148:149], v10 offset:8608
    ds_read_b64_tr_b16 a[150:151], v10 offset:8864
    v_mfma_f32_16x16x32_bf16 v[212:215], a[84:87], a[100:103], v[212:215]
    ds_read_b64_tr_b16 a[152:153], v10 offset:8640
    s_xor_b32 s32, s51, 7
    v_mfma_f32_16x16x32_bf16 v[216:219], a[84:87], a[104:107], v[216:219]
    ds_read_b64_tr_b16 a[154:155], v10 offset:8896
    ds_read_b64_tr_b16 a[156:157], v10 offset:8672
    v_mfma_f32_16x16x32_bf16 v[220:223], a[84:87], a[108:111], v[220:223]
    buffer_load_dwordx4 v1, s[4:7], s28 offen offset:0 lds
    v_mfma_f32_16x16x32_bf16 v[224:227], a[88:91], a[96:99], v[224:227]
    s_add_u32 m0, s40, 51504
    ds_read_b64_tr_b16 a[158:159], v10 offset:8928
    v_mfma_f32_16x16x32_bf16 v[228:231], a[88:91], a[100:103], v[228:231]
    v_add_u32 v10, 100864, v6
    v_lshl_add_u32 v11, s3, 6, v10
    v_mfma_f32_16x16x32_bf16 v[232:235], a[88:91], a[104:107], v[232:235]
    s_add_u32 s32, s32, s50
    s_and_b32 s32, s32, 7
    v_mfma_f32_16x16x32_bf16 v[236:239], a[88:91], a[108:111], v[236:239]
    s_cmp_ge_u32 s36, 96
    s_cselect_b32 s56, s82, s56
    v_mfma_f32_16x16x32_bf16 v[240:243], a[92:95], a[96:99], v[240:243]
    buffer_load_dwordx4 v1, s[4:7], s28 offen offset:2048 lds
    v_mfma_f32_16x16x32_bf16 v[244:247], a[92:95], a[100:103], v[244:247]
    s_add_u32 m0, s40, 55632
    s_add_u32 s28, s28, 4096
    v_mfma_f32_16x16x32_bf16 v[248:251], a[92:95], a[104:107], v[248:251]
    s_cmp_ge_u32 s36, 96
    s_cselect_b32 s57, s83, s57
    v_mfma_f32_16x16x32_bf16 v[252:255], a[92:95], a[108:111], v[252:255]
    s_cmp_ge_u32 s36, 96
    s_cselect_b64 s[60:61], -1, 0
    v_mfma_f32_16x16x32_bf16 v[32:35], v[12:15], a[176:179], v[32:35]
    v_lshlrev_b32 v41, 7, v21
    v_cndmask_b32 v40, v40, v41, s[60:61]
    s_waitcnt lgkmcnt(0)
    v_mfma_f32_16x16x32_bf16 v[36:39], v[12:15], a[180:183], v[36:39]
    buffer_load_dwordx4 v1, s[4:7], s28 offen offset:0 lds
    v_mfma_f32_16x16x32_bf16 v[128:131], a[128:131], a[160:163], v[128:131]
    s_add_u32 m0, s40, 55664
    s_mov_b32 s59, 0x20000
    v_mfma_f32_16x16x32_bf16 v[132:135], a[128:131], a[164:167], v[132:135]
    s_mov_b32 s58, 1409024
    s_lshl_b32 s31, s3, 19
    v_mfma_f32_16x16x32_bf16 v[136:139], a[128:131], a[168:171], v[136:139]
    s_lshl_b32 s51, s2, 2
    s_add_u32 s51, s51, s3
    v_mfma_f32_16x16x32_bf16 v[140:143], a[128:131], a[172:175], v[140:143]
    v_dot2c_f32_bf16 v114, v80, v104
    v_dot2c_f32_bf16 v114, v81, v105
    v_dot2c_f32_bf16 v114, v82, v106
    v_dot2c_f32_bf16 v114, v83, v107
    v_dot2c_f32_bf16 v114, v84, v108
    v_dot2c_f32_bf16 v114, v85, v109
    v_dot2c_f32_bf16 v114, v86, v110
    v_dot2c_f32_bf16 v114, v87, v111
    s_nop 3
    v_mfma_f32_16x16x32_bf16 v[144:147], a[132:135], a[160:163], v[144:147]
    buffer_load_dwordx4 v1, s[4:7], s28 offen offset:2048 lds
    v_mfma_f32_16x16x32_bf16 v[148:151], a[132:135], a[164:167], v[148:151]
    v_add_f32_dpp v114, v114, v114 quad_perm:[1,0,3,2] row_mask:0xf bank_mask:0xf
    s_add_u32 m0, s40, 54592
    v_mfma_f32_16x16x32_bf16 v[152:155], a[132:135], a[168:171], v[152:155]
    v_add_f32_dpp v114, v114, v114 quad_perm:[2,3,0,1] row_mask:0xf bank_mask:0xf
    s_add_u32 s28, s28, 4096
    v_mfma_f32_16x16x32_bf16 v[156:159], a[132:135], a[172:175], v[156:159]
    v_add_f32_dpp v114, v114, v114 row_half_mirror row_mask:0xf bank_mask:0xf
    v_mfma_f32_16x16x32_bf16 v[160:163], a[136:139], a[160:163], v[160:163]
    s_nop 0
    v_add_f32_dpp v114, v114, v114 row_mirror row_mask:0xf bank_mask:0xf
    v_mov_b32 v116, v114
    v_mfma_f32_16x16x32_bf16 v[164:167], a[136:139], a[164:167], v[164:167]
    s_nop 0
    v_permlane16_swap_b32 v114, v116
    v_add_f32 v114, v114, v116
    v_mfma_f32_16x16x32_bf16 v[168:171], a[136:139], a[168:171], v[168:171]
    v_cvt_pk_bf16_f32 v114, v114, v114
    v_and_b32 v114, 0xffff0000, v114
    v_mfma_f32_16x16x32_bf16 v[172:175], a[136:139], a[172:175], v[172:175]
    v_ashrrev_i32 v116, 31, v114
    v_or_b32 v116, 0x80000000, v116
    v_mfma_f32_16x16x32_bf16 v[176:179], a[140:143], a[160:163], v[176:179]
    v_xor_b32 v114, v114, v116
    v_bfi_b32 v114, s38, v119, v114
    v_mfma_f32_16x16x32_bf16 v[180:183], a[140:143], a[164:167], v[180:183]
    s_lshl_b32 s38, s3, 12
    s_add_u32 s25, s25, s38
    s_mov_b32 exec_lo, 1
    s_mov_b32 exec_hi, 1
    buffer_store_dword v114, v115, s[20:23], s37 offen sc1
    s_mov_b64 exec, -1
    v_mfma_f32_16x16x32_bf16 v[184:187], a[140:143], a[168:171], v[184:187]
    s_waitcnt vmcnt(19)
    s_barrier
    v_mfma_f32_16x16x32_bf16 v[188:191], a[140:143], a[172:175], v[188:191]
    buffer_load_dwordx4 v1, s[4:7], s28 offen offset:0 lds
    v_mfma_f32_16x16x32_bf16 v[192:195], a[144:147], a[160:163], v[192:195]
    s_add_u32 m0, s40, 54624
    ds_read_b128 a[0:3], v9 offset:0
    v_mfma_f32_16x16x32_bf16 v[196:199], a[144:147], a[164:167], v[196:199]
    ds_read_b128 a[4:7], v9 offset:256
    s_lshl_b32 s38, s26, 7
    v_mfma_f32_16x16x32_bf16 v[200:203], a[144:147], a[168:171], v[200:203]
    s_cmp_lt_u32 s36, 48
    s_cselect_b32 s37, 0, 48
    v_mfma_f32_16x16x32_bf16 v[204:207], a[144:147], a[172:175], v[204:207]
    ds_read_b128 a[8:11], v9 offset:512
    s_add_u32 s25, s25, s38
    v_mfma_f32_16x16x32_bf16 v[208:211], a[148:151], a[160:163], v[208:211]
    buffer_load_dwordx4 v1, s[4:7], s28 offen offset:2048 lds
    v_mfma_f32_16x16x32_bf16 v[212:215], a[148:151], a[164:167], v[212:215]
    s_add_u32 m0, s41, 50432
    ds_read_b128 a[12:15], v9 offset:768
    v_mfma_f32_16x16x32_bf16 v[216:219], a[148:151], a[168:171], v[216:219]
    ds_read_b128 a[16:19], v9 offset:64
    s_lshl_b32 s28, s34, 7
    v_mfma_f32_16x16x32_bf16 v[220:223], a[148:151], a[172:175], v[220:223]
    s_add_u32 s28, s28, s42
    ds_read_b128 a[20:23], v9 offset:320
    v_mfma_f32_16x16x32_bf16 v[224:227], a[152:155], a[160:163], v[224:227]
    s_sub_u32 s37, s36, s37
    s_and_b32 s38, s37, 15
    v_mfma_f32_16x16x32_bf16 v[228:231], a[152:155], a[164:167], v[228:231]
    buffer_load_dwordx4 v2, s[8:11], s29 offen lds
    v_mfma_f32_16x16x32_bf16 v[232:235], a[152:155], a[168:171], v[232:235]
    s_add_u32 m0, s41, 51488
    s_add_u32 s29, s29, 8192
    ds_read_b64_tr_b16 a[112:113], v11 offset:0
    ds_read_b64_tr_b16 a[114:115], v11 offset:256
    v_mfma_f32_16x16x32_bf16 v[236:239], a[152:155], a[172:175], v[236:239]
    ds_read_b128 a[24:27], v9 offset:576
    s_lshr_b32 s37, s37, 4
    v_mfma_f32_16x16x32_bf16 v[240:243], a[156:159], a[160:163], v[240:243]
    ds_read_b128 a[28:31], v9 offset:832
    v_add_u32 v9, 0, v5
    v_mfma_f32_16x16x32_bf16 v[244:247], a[156:159], a[164:167], v[244:247]
    s_mul_i32 s38, s38, 88064
    ds_read_b64_tr_b16 a[116:117], v11 offset:32
    v_mfma_f32_16x16x32_bf16 v[248:251], a[156:159], a[168:171], v[248:251]
    buffer_load_dwordx4 v2, s[8:11], s29 offen lds
    ds_read_b64_tr_b16 a[118:119], v11 offset:288
    ds_read_b64_tr_b16 a[64:65], v10 offset:0
    v_mfma_f32_16x16x32_bf16 v[252:255], a[156:159], a[172:175], v[252:255]
    s_add_u32 m0, s41, 52544
    s_add_u32 s29, s29, 8192
    ds_read_b64_tr_b16 a[66:67], v10 offset:256
    ds_read_b64_tr_b16 a[68:69], v10 offset:32
    s_lshl_b32 s37, s37, 10
    ds_read_b64_tr_b16 a[70:71], v10 offset:288
    s_add_u32 s38, s38, s37
    s_and_b32 s37, s2, 7
    ds_read_b64_tr_b16 a[72:73], v10 offset:64
    s_lshl_b32 s50, s37, 7
    ds_read_b64_tr_b16 a[74:75], v10 offset:320
    s_waitcnt lgkmcnt(10)
    v_mfma_f32_16x16x32_bf16 v[32:35], v[12:15], a[112:115], v[32:35]
    buffer_load_dwordx4 v2, s[8:11], s29 offen lds
    s_add_u32 m0, s41, 53600
    s_add_u32 s29, s29, 8192
    ds_read_b64_tr_b16 a[76:77], v10 offset:96
    ds_read_b64_tr_b16 a[78:79], v10 offset:352
    s_add_u32 s38, s38, s50
    ds_read_b64_tr_b16 a[80:81], v10 offset:128
    s_sub_u32 s50, s36, 96
    s_lshr_b32 s39, s50, 3
    ds_read_b64_tr_b16 a[82:83], v10 offset:384
    s_and_b32 s50, s50, 7
    ds_read_b64_tr_b16 a[84:85], v10 offset:160
    s_lshl_b32 s39, s39, 19
    s_lshl_b32 s50, s50, 13
    s_waitcnt lgkmcnt(11)
    v_mfma_f32_16x16x32_bf16 v[36:39], v[12:15], a[116:119], v[36:39]
    ds_read_b64_tr_b16 a[86:87], v10 offset:416
    ds_read_b64_tr_b16 a[88:89], v10 offset:192
    buffer_load_dwordx4 v2, s[8:11], s29 offen lds
    s_waitcnt lgkmcnt(11)
    v_mfma_f32_16x16x32_bf16 v[128:131], a[64:67], a[0:3], v[128:131]
    s_add_u32 m0, s40, 100864
    ds_read_b64_tr_b16 a[90:91], v10 offset:448
    v_mfma_f32_16x16x32_bf16 v[132:135], a[64:67], a[4:7], v[132:135]
    ds_read_b64_tr_b16 a[92:93], v10 offset:224
    ds_read_b64_tr_b16 a[94:95], v10 offset:480
    v_mfma_f32_16x16x32_bf16 v[136:139], a[64:67], a[8:11], v[136:139]
    ds_read_b64_tr_b16 a[176:177], v11 offset:8448
    s_lshl_b32 s29, s32, 19
    v_mfma_f32_16x16x32_bf16 v[140:143], a[64:67], a[12:15], v[140:143]
    ds_read_b64_tr_b16 a[178:179], v11 offset:8704
    ds_read_b64_tr_b16 a[180:181], v11 offset:8480
    s_waitcnt lgkmcnt(11)
    v_mfma_f32_16x16x32_bf16 v[144:147], a[68:71], a[0:3], v[144:147]
    buffer_load_dwordx4 v1, s[4:7], s28 offen offset:0 lds
    v_mfma_f32_16x16x32_bf16 v[148:151], a[68:71], a[4:7], v[148:151]
    s_add_u32 m0, s40, 100896
    ds_read_b64_tr_b16 a[182:183], v11 offset:8736
    v_mfma_f32_16x16x32_bf16 v[152:155], a[68:71], a[8:11], v[152:155]
    ds_read_b64_tr_b16 a[128:129], v10 offset:8448
    ds_read_b64_tr_b16 a[130:131], v10 offset:8704
    v_mfma_f32_16x16x32_bf16 v[156:159], a[68:71], a[12:15], v[156:159]
    ds_read_b64_tr_b16 a[132:133], v10 offset:8480
    s_add_u32 s29, s29, s43
    v_mfma_f32_16x16x32_bf16 v[160:163], a[72:75], a[0:3], v[160:163]
    ds_read_b64_tr_b16 a[134:135], v10 offset:8736
    ds_read_b64_tr_b16 a[136:137], v10 offset:8512
    v_mfma_f32_16x16x32_bf16 v[164:167], a[72:75], a[4:7], v[164:167]
    buffer_load_dwordx4 v1, s[4:7], s28 offen offset:2048 lds
    v_mfma_f32_16x16x32_bf16 v[168:171], a[72:75], a[8:11], v[168:171]
    s_add_u32 m0, s40, 101904
    s_add_u32 s28, s28, 4096
    v_mfma_f32_16x16x32_bf16 v[172:175], a[72:75], a[12:15], v[172:175]
    ds_read_b64_tr_b16 a[138:139], v10 offset:8768
    ds_read_b64_tr_b16 a[140:141], v10 offset:8544
    v_mfma_f32_16x16x32_bf16 v[176:179], a[76:79], a[0:3], v[176:179]
    ds_read_b64_tr_b16 a[142:143], v10 offset:8800
    s_add_u32 s50, s50, s39
    v_mfma_f32_16x16x32_bf16 v[180:183], a[76:79], a[4:7], v[180:183]
    ds_read_b64_tr_b16 a[144:145], v10 offset:8576
    ds_read_b64_tr_b16 a[146:147], v10 offset:8832
    v_mfma_f32_16x16x32_bf16 v[184:187], a[76:79], a[8:11], v[184:187]
    buffer_load_dwordx4 v1, s[4:7], s28 offen offset:0 lds
    v_mfma_f32_16x16x32_bf16 v[188:191], a[76:79], a[12:15], v[188:191]
    s_add_u32 m0, s40, 101936
    ds_read_b64_tr_b16 a[148:149], v10 offset:8608
    s_waitcnt lgkmcnt(8)
    v_mfma_f32_16x16x32_bf16 v[192:195], a[80:83], a[0:3], v[192:195]
    ds_read_b64_tr_b16 a[150:151], v10 offset:8864
    ds_read_b64_tr_b16 a[152:153], v10 offset:8640
    v_mfma_f32_16x16x32_bf16 v[196:199], a[80:83], a[4:7], v[196:199]
    ds_read_b64_tr_b16 a[154:155], v10 offset:8896
    s_lshl_b32 s37, s37, 16
    v_mfma_f32_16x16x32_bf16 v[200:203], a[80:83], a[8:11], v[200:203]
    ds_read_b64_tr_b16 a[156:157], v10 offset:8672
    ds_read_b64_tr_b16 a[158:159], v10 offset:8928
    v_mfma_f32_16x16x32_bf16 v[204:207], a[80:83], a[12:15], v[204:207]
    buffer_load_dwordx4 v1, s[4:7], s28 offen offset:2048 lds
    v_mfma_f32_16x16x32_bf16 v[208:211], a[84:87], a[0:3], v[208:211]
    s_add_u32 m0, s40, 106064
    s_add_u32 s28, s28, 4096
    v_mfma_f32_16x16x32_bf16 v[212:215], a[84:87], a[4:7], v[212:215]
    v_add_u32 v10, 0, v6
    v_lshl_add_u32 v11, s3, 6, v10
    v_mfma_f32_16x16x32_bf16 v[216:219], a[84:87], a[8:11], v[216:219]
    s_add_u32 s50, s50, s37
    s_lshl_b32 s37, s3, 12
    v_mfma_f32_16x16x32_bf16 v[220:223], a[84:87], a[12:15], v[220:223]
    s_add_u32 s48, s48, s37
    s_add_u32 s48, s48, 24117248
    v_mfma_f32_16x16x32_bf16 v[224:227], a[88:91], a[0:3], v[224:227]
    buffer_load_dwordx4 v1, s[4:7], s28 offen offset:0 lds
    v_mfma_f32_16x16x32_bf16 v[228:231], a[88:91], a[4:7], v[228:231]
    s_add_u32 m0, s40, 106096
    s_lshl_b32 s32, s3, 19
    v_mfma_f32_16x16x32_bf16 v[232:235], a[88:91], a[8:11], v[232:235]
    s_cmp_ge_u32 s36, 96
    s_cselect_b32 s38, s50, s38
    v_mfma_f32_16x16x32_bf16 v[236:239], a[88:91], a[12:15], v[236:239]
    s_lshl_b32 s36, s53, 7
    s_add_u32 s32, s32, s36
    v_mfma_f32_16x16x32_bf16 v[240:243], a[92:95], a[0:3], v[240:243]
    s_and_b32 s36, s52, 1
    s_lshl_b32 s36, s36, 21
    v_mfma_f32_16x16x32_bf16 v[244:247], a[92:95], a[4:7], v[244:247]
    buffer_load_dwordx4 v1, s[4:7], s28 offen offset:2048 lds
    v_mfma_f32_16x16x32_bf16 v[248:251], a[92:95], a[8:11], v[248:251]
    s_add_u32 m0, s40, 105024
    s_add_u32 s28, s28, 4096
    v_mfma_f32_16x16x32_bf16 v[252:255], a[92:95], a[12:15], v[252:255]
    s_add_u32 s32, s32, s36
    s_lshl_b32 s36, s30, 15
    v_mfma_f32_16x16x32_bf16 v[32:35], v[12:15], a[176:179], v[32:35]
    s_add_u32 s32, s32, s36
    v_add_u32 v40, s38, v40
    v_mfma_f32_16x16x32_bf16 v[36:39], v[12:15], a[180:183], v[36:39]
    v_accvgpr_write_b32 a190, v40
    s_add_u32 s38, s33, 100608
    v_mfma_f32_16x16x32_bf16 v[128:131], a[128:131], a[16:19], v[128:131]
    buffer_load_dwordx4 v1, s[4:7], s28 offen offset:0 lds
    v_mfma_f32_16x16x32_bf16 v[132:135], a[128:131], a[20:23], v[132:135]
    s_add_u32 m0, s40, 105056
    s_min_u32 s39, s24, 85
    v_mfma_f32_16x16x32_bf16 v[136:139], a[128:131], a[24:27], v[136:139]
    s_lshl_b32 s36, s39, 14
    s_lshl_b32 s37, s3, 12
    v_mfma_f32_16x16x32_bf16 v[140:143], a[128:131], a[28:31], v[140:143]
    s_add_u32 s36, s36, s37
    s_lshl_b32 s37, s39, 5
    s_waitcnt lgkmcnt(0)
    v_mfma_f32_16x16x32_bf16 v[144:147], a[132:135], a[16:19], v[144:147]
    s_lshl_b32 s40, s27, 21
    s_add_u32 s40, s40, s31
    v_mfma_f32_16x16x32_bf16 v[148:151], a[132:135], a[20:23], v[148:151]
    buffer_load_dwordx4 v1, s[4:7], s28 offen offset:2048 lds
    v_mfma_f32_16x16x32_bf16 v[152:155], a[132:135], a[24:27], v[152:155]
    s_waitcnt vmcnt(21)
    s_barrier
    v_mfma_f32_16x16x32_bf16 v[156:159], a[132:135], a[28:31], v[156:159]
    s_add_u32 m0, s41, 100864
    ds_read_b64_tr_b16 a[112:113], v11 offset:0
    v_mfma_f32_16x16x32_bf16 v[160:163], a[136:139], a[16:19], v[160:163]
    buffer_load_dwordx4 v2, s[8:11], s29 offen lds
    v_mfma_f32_16x16x32_bf16 v[164:167], a[136:139], a[20:23], v[164:167]
    s_add_u32 m0, s41, 101920
    s_add_u32 s29, s29, 8192
    v_mfma_f32_16x16x32_bf16 v[168:171], a[136:139], a[24:27], v[168:171]
    ds_read_b64_tr_b16 a[114:115], v11 offset:256
    ds_read_b64_tr_b16 a[116:117], v11 offset:32
    v_mfma_f32_16x16x32_bf16 v[172:175], a[136:139], a[28:31], v[172:175]
    ds_read_b64_tr_b16 a[118:119], v11 offset:288
    v_and_b32 v1, 31, v21
    v_mfma_f32_16x16x32_bf16 v[176:179], a[140:143], a[16:19], v[176:179]
    ds_read_b128 a[96:99], v9 offset:0
    v_lshlrev_b32 v1, 7, v1
    v_mfma_f32_16x16x32_bf16 v[180:183], a[140:143], a[20:23], v[180:183]
    buffer_load_dwordx4 v2, s[8:11], s29 offen lds
    v_mfma_f32_16x16x32_bf16 v[184:187], a[140:143], a[24:27], v[184:187]
    s_add_u32 m0, s41, 102976
    s_add_u32 s29, s29, 8192
    v_mfma_f32_16x16x32_bf16 v[188:191], a[140:143], a[28:31], v[188:191]
    ds_read_b64_tr_b16 a[64:65], v10 offset:0
    ds_read_b64_tr_b16 a[66:67], v10 offset:256
    v_mfma_f32_16x16x32_bf16 v[192:195], a[144:147], a[16:19], v[192:195]
    ds_read_b128 a[100:103], v9 offset:256
    s_lshl_b32 s31, s26, 12
    v_mfma_f32_16x16x32_bf16 v[196:199], a[144:147], a[20:23], v[196:199]
    ds_read_b128 a[104:107], v9 offset:512
    s_add_u32 s40, s40, s31
    v_mfma_f32_16x16x32_bf16 v[200:203], a[144:147], a[24:27], v[200:203]
    buffer_load_dwordx4 v2, s[8:11], s29 offen lds
    v_mfma_f32_16x16x32_bf16 v[204:207], a[144:147], a[28:31], v[204:207]
    ds_read_b128 a[108:111], v9 offset:768
    s_add_u32 m0, s41, 104032
    v_mfma_f32_16x16x32_bf16 v[208:211], a[148:151], a[16:19], v[208:211]
    ds_read_b64_tr_b16 a[68:69], v10 offset:32
    s_add_u32 s29, s29, 8192
    v_mfma_f32_16x16x32_bf16 v[212:215], a[148:151], a[20:23], v[212:215]
    ds_read_b64_tr_b16 a[70:71], v10 offset:288
    ds_read_b64_tr_b16 a[72:73], v10 offset:64
    v_mfma_f32_16x16x32_bf16 v[216:219], a[148:151], a[24:27], v[216:219]
    ds_read_b64_tr_b16 a[74:75], v10 offset:320
    s_xor_b32 s41, s32, 0
    v_mfma_f32_16x16x32_bf16 v[220:223], a[148:151], a[28:31], v[220:223]
    ds_read_b64_tr_b16 a[76:77], v10 offset:96
    ds_read_b64_tr_b16 a[78:79], v10 offset:352
    v_mfma_f32_16x16x32_bf16 v[224:227], a[152:155], a[16:19], v[224:227]
    ds_read_b64_tr_b16 a[80:81], v10 offset:128
    s_add_u32 s25, s25, 24248320
    v_mfma_f32_16x16x32_bf16 v[228:231], a[152:155], a[20:23], v[228:231]
    ds_read_b64_tr_b16 a[82:83], v10 offset:384
    ds_read_b64_tr_b16 a[84:85], v10 offset:160
    v_mfma_f32_16x16x32_bf16 v[232:235], a[152:155], a[24:27], v[232:235]
    ds_read_b64_tr_b16 a[86:87], v10 offset:416
    v_mfma_f32_16x16x32_bf16 v[236:239], a[152:155], a[28:31], v[236:239]
    ds_read_b64_tr_b16 a[88:89], v10 offset:192
    ds_read_b64_tr_b16 a[90:91], v10 offset:448
    v_mfma_f32_16x16x32_bf16 v[240:243], a[156:159], a[16:19], v[240:243]
    ds_read_b64_tr_b16 a[92:93], v10 offset:224
    v_mfma_f32_16x16x32_bf16 v[244:247], a[156:159], a[20:23], v[244:247]
    ds_read_b64_tr_b16 a[94:95], v10 offset:480
    ds_read_b64_tr_b16 a[176:177], v11 offset:8448
    v_mfma_f32_16x16x32_bf16 v[248:251], a[156:159], a[24:27], v[248:251]
    buffer_load_dwordx4 v2, s[8:11], s29 offen lds
    v_mfma_f32_16x16x32_bf16 v[252:255], a[156:159], a[28:31], v[252:255]
    ds_read_b64_tr_b16 a[178:179], v11 offset:8704
    ds_read_b64_tr_b16 a[180:181], v11 offset:8480
    s_waitcnt lgkmcnt(11)
    v_mfma_f32_16x16x32_bf16 v[32:35], v[12:15], a[112:115], v[32:35]
    ds_read_b64_tr_b16 a[182:183], v11 offset:8736
    s_add_u32 m0, s44, 0
    v_mfma_f32_16x16x32_bf16 v[36:39], v[12:15], a[116:119], v[36:39]
    ds_read_b128 a[160:163], v9 offset:64
    s_mov_b32 s8, s72
    v_mfma_f32_16x16x32_bf16 v[128:131], a[64:67], a[96:99], v[128:131]
    ds_read_b64_tr_b16 a[128:129], v10 offset:8448
    s_mov_b32 s9, s73
    v_mfma_f32_16x16x32_bf16 v[132:135], a[64:67], a[100:103], v[132:135]
    ds_read_b64_tr_b16 a[130:131], v10 offset:8704
    ds_read_b128 a[164:167], v9 offset:320
    v_mfma_f32_16x16x32_bf16 v[136:139], a[64:67], a[104:107], v[136:139]
    s_mov_b32 s10, 0x400000
    s_mov_b32 s11, 0x20000
    v_mfma_f32_16x16x32_bf16 v[140:143], a[64:67], a[108:111], v[140:143]
    ds_read_b128 a[168:171], v9 offset:576
    v_mfma_f32_16x16x32_bf16 v[144:147], a[68:71], a[96:99], v[144:147]
    ds_read_b128 a[172:175], v9 offset:832
    v_add_u32 v9, 50432, v5
    v_mfma_f32_16x16x32_bf16 v[148:151], a[68:71], a[100:103], v[148:151]
    ds_read_b64_tr_b16 a[132:133], v10 offset:8480
    v_mfma_f32_16x16x32_bf16 v[152:155], a[68:71], a[104:107], v[152:155]
    ds_read_b64_tr_b16 a[134:135], v10 offset:8736
    ds_read_b64_tr_b16 a[136:137], v10 offset:8512
    v_mfma_f32_16x16x32_bf16 v[156:159], a[68:71], a[108:111], v[156:159]
    ds_read_b64_tr_b16 a[138:139], v10 offset:8768
    v_mfma_f32_16x16x32_bf16 v[160:163], a[72:75], a[96:99], v[160:163]
    ds_read_b64_tr_b16 a[140:141], v10 offset:8544
    ds_read_b64_tr_b16 a[142:143], v10 offset:8800
    v_mfma_f32_16x16x32_bf16 v[164:167], a[72:75], a[100:103], v[164:167]
    ds_read_b64_tr_b16 a[144:145], v10 offset:8576
    v_mfma_f32_16x16x32_bf16 v[168:171], a[72:75], a[104:107], v[168:171]
    ds_read_b64_tr_b16 a[146:147], v10 offset:8832
    ds_read_b64_tr_b16 a[148:149], v10 offset:8608
    v_mfma_f32_16x16x32_bf16 v[172:175], a[72:75], a[108:111], v[172:175]
    ds_read_b64_tr_b16 a[150:151], v10 offset:8864
    v_mfma_f32_16x16x32_bf16 v[176:179], a[76:79], a[96:99], v[176:179]
    ds_read_b64_tr_b16 a[152:153], v10 offset:8640
    ds_read_b64_tr_b16 a[154:155], v10 offset:8896
    v_mfma_f32_16x16x32_bf16 v[180:183], a[76:79], a[100:103], v[180:183]
    ds_read_b64_tr_b16 a[156:157], v10 offset:8672
    v_mfma_f32_16x16x32_bf16 v[184:187], a[76:79], a[104:107], v[184:187]
    ds_read_b64_tr_b16 a[158:159], v10 offset:8928
    v_add_u32 v10, 50432, v6
    v_mfma_f32_16x16x32_bf16 v[188:191], a[76:79], a[108:111], v[188:191]
    v_lshl_add_u32 v11, s3, 6, v10
    s_waitcnt lgkmcnt(10)
    v_mfma_f32_16x16x32_bf16 v[192:195], a[80:83], a[96:99], v[192:195]
    s_cmp_lt_u32 s24, 86
    s_cselect_b32 s50, 1, 0
    v_mfma_f32_16x16x32_bf16 v[196:199], a[80:83], a[100:103], v[196:199]
    s_cmp_eq_u32 s3, 2
    s_cselect_b32 s50, s50, 0
    v_mfma_f32_16x16x32_bf16 v[200:203], a[80:83], a[104:107], v[200:203]
    v_mfma_f32_16x16x32_bf16 v[204:207], a[80:83], a[108:111], v[204:207]
    v_mfma_f32_16x16x32_bf16 v[208:211], a[84:87], a[96:99], v[208:211]
    v_mfma_f32_16x16x32_bf16 v[212:215], a[84:87], a[100:103], v[212:215]
    v_mfma_f32_16x16x32_bf16 v[216:219], a[84:87], a[104:107], v[216:219]
    s_waitcnt lgkmcnt(0)
    s_waitcnt vmcnt(12)
    s_barrier
    v_mfma_f32_16x16x32_bf16 v[220:223], a[84:87], a[108:111], v[220:223]
    buffer_load_dwordx2 v[48:49], v43, s[20:23], s48 offen offset:0 sc1
    v_mfma_f32_16x16x32_bf16 v[224:227], a[88:91], a[96:99], v[224:227]
    ds_read_b64_tr_b16 a[112:113], v11 offset:0
    ds_read_b64_tr_b16 a[114:115], v11 offset:256
    v_mfma_f32_16x16x32_bf16 v[228:231], a[88:91], a[100:103], v[228:231]
    ds_read_b64_tr_b16 a[116:117], v11 offset:32
    v_mfma_f32_16x16x32_bf16 v[232:235], a[88:91], a[104:107], v[232:235]
    buffer_load_dwordx2 v[50:51], v43, s[20:23], s48 offen offset:1024 sc1
    v_mfma_f32_16x16x32_bf16 v[236:239], a[88:91], a[108:111], v[236:239]
    ds_read_b64_tr_b16 a[118:119], v11 offset:288
    ds_read_b128 a[0:3], v9 offset:0
    v_mfma_f32_16x16x32_bf16 v[240:243], a[92:95], a[96:99], v[240:243]
    v_mfma_f32_16x16x32_bf16 v[244:247], a[92:95], a[100:103], v[244:247]
    ds_read_b64_tr_b16 a[64:65], v10 offset:0
    ds_read_b64_tr_b16 a[66:67], v10 offset:256
    v_mfma_f32_16x16x32_bf16 v[248:251], a[92:95], a[104:107], v[248:251]
    buffer_load_dwordx2 v[52:53], v43, s[20:23], s48 offen offset:2048 sc1
    v_mfma_f32_16x16x32_bf16 v[252:255], a[92:95], a[108:111], v[252:255]
    ds_read_b128 a[4:7], v9 offset:256
    v_mfma_f32_16x16x32_bf16 v[32:35], v[12:15], a[176:179], v[32:35]
    ds_read_b128 a[8:11], v9 offset:512
    v_mfma_f32_16x16x32_bf16 v[36:39], v[12:15], a[180:183], v[36:39]
    buffer_load_dwordx2 v[54:55], v43, s[20:23], s48 offen offset:3072 sc1
    v_mfma_f32_16x16x32_bf16 v[128:131], a[128:131], a[160:163], v[128:131]
    ds_read_b128 a[12:15], v9 offset:768
    v_mfma_f32_16x16x32_bf16 v[132:135], a[128:131], a[164:167], v[132:135]
    ds_read_b64_tr_b16 a[68:69], v10 offset:32
    v_mfma_f32_16x16x32_bf16 v[136:139], a[128:131], a[168:171], v[136:139]
    ds_read_b64_tr_b16 a[70:71], v10 offset:288
    ds_read_b64_tr_b16 a[72:73], v10 offset:64
    v_mfma_f32_16x16x32_bf16 v[140:143], a[128:131], a[172:175], v[140:143]
    buffer_load_dwordx4 v3, s[12:15], s46 offen offset:0 lds
    v_mfma_f32_16x16x32_bf16 v[144:147], a[132:135], a[160:163], v[144:147]
    s_add_u32 m0, s44, 1824
    ds_read_b64_tr_b16 a[74:75], v10 offset:320
    v_mfma_f32_16x16x32_bf16 v[148:151], a[132:135], a[164:167], v[148:151]
    ds_read_b64_tr_b16 a[76:77], v10 offset:96
    ds_read_b64_tr_b16 a[78:79], v10 offset:352
    v_mfma_f32_16x16x32_bf16 v[152:155], a[132:135], a[168:171], v[152:155]
    ds_read_b128 a[16:19], v9 offset:64
    v_mfma_f32_16x16x32_bf16 v[156:159], a[132:135], a[172:175], v[156:159]
    ds_read_b128 a[20:23], v9 offset:320
    v_mfma_f32_16x16x32_bf16 v[160:163], a[136:139], a[160:163], v[160:163]
    buffer_load_dwordx4 v3, s[12:15], s46 offen offset:256 lds
    v_mfma_f32_16x16x32_bf16 v[164:167], a[136:139], a[164:167], v[164:167]
    s_add_u32 m0, s44, 3648
    ds_read_b128 a[24:27], v9 offset:576
    v_mfma_f32_16x16x32_bf16 v[168:171], a[136:139], a[168:171], v[168:171]
    ds_read_b128 a[28:31], v9 offset:832
    v_add_u32 v9, 100864, v5
    v_mfma_f32_16x16x32_bf16 v[172:175], a[136:139], a[172:175], v[172:175]
    v_lshrrev_b32 v5, 3, v21
    ds_read_b64_tr_b16 a[80:81], v10 offset:128
    v_mfma_f32_16x16x32_bf16 v[176:179], a[140:143], a[160:163], v[176:179]
    ds_read_b64_tr_b16 a[82:83], v10 offset:384
    v_lshlrev_b32 v5, 12, v5
    v_mfma_f32_16x16x32_bf16 v[180:183], a[140:143], a[164:167], v[180:183]
    buffer_load_dwordx4 v3, s[12:15], s46 offen offset:512 lds
    v_mfma_f32_16x16x32_bf16 v[184:187], a[140:143], a[168:171], v[184:187]
    s_add_u32 m0, s44, 5472
    ds_read_b64_tr_b16 a[84:85], v10 offset:160
    v_mfma_f32_16x16x32_bf16 v[188:191], a[140:143], a[172:175], v[188:191]
    ds_read_b64_tr_b16 a[86:87], v10 offset:416
    ds_read_b64_tr_b16 a[88:89], v10 offset:192
    v_mfma_f32_16x16x32_bf16 v[192:195], a[144:147], a[160:163], v[192:195]
    ds_read_b64_tr_b16 a[90:91], v10 offset:448
    v_mfma_f32_16x16x32_bf16 v[196:199], a[144:147], a[164:167], v[196:199]
    ds_read_b64_tr_b16 a[92:93], v10 offset:224
    ds_read_b64_tr_b16 a[94:95], v10 offset:480
    v_mfma_f32_16x16x32_bf16 v[200:203], a[144:147], a[168:171], v[200:203]
    buffer_load_dwordx4 v3, s[12:15], s46 offen offset:768 lds
    v_mfma_f32_16x16x32_bf16 v[204:207], a[144:147], a[172:175], v[204:207]
    ds_read_b64_tr_b16 a[176:177], v11 offset:8448
    ds_read_b64_tr_b16 a[178:179], v11 offset:8704
    v_mfma_f32_16x16x32_bf16 v[208:211], a[148:151], a[160:163], v[208:211]
    ds_read_b64_tr_b16 a[180:181], v11 offset:8480
    s_add_u32 m0, s45, 8448
    v_mfma_f32_16x16x32_bf16 v[212:215], a[148:151], a[164:167], v[212:215]
    ds_read_b64_tr_b16 a[182:183], v11 offset:8736
    ds_read_b64_tr_b16 a[128:129], v10 offset:8448
    v_mfma_f32_16x16x32_bf16 v[216:219], a[148:151], a[168:171], v[216:219]
    ds_read_b64_tr_b16 a[130:131], v10 offset:8704
    v_mfma_f32_16x16x32_bf16 v[220:223], a[148:151], a[172:175], v[220:223]
    ds_read_b64_tr_b16 a[132:133], v10 offset:8480
    ds_read_b64_tr_b16 a[134:135], v10 offset:8736
    v_mfma_f32_16x16x32_bf16 v[224:227], a[152:155], a[160:163], v[224:227]
    ds_read_b64_tr_b16 a[136:137], v10 offset:8512
    v_mfma_f32_16x16x32_bf16 v[228:231], a[152:155], a[164:167], v[228:231]
    ds_read_b64_tr_b16 a[138:139], v10 offset:8768
    ds_read_b64_tr_b16 a[140:141], v10 offset:8544
    v_mfma_f32_16x16x32_bf16 v[232:235], a[152:155], a[168:171], v[232:235]
    ds_read_b64_tr_b16 a[142:143], v10 offset:8800
    v_mfma_f32_16x16x32_bf16 v[236:239], a[152:155], a[172:175], v[236:239]
    ds_read_b64_tr_b16 a[144:145], v10 offset:8576
    ds_read_b64_tr_b16 a[146:147], v10 offset:8832
    v_mfma_f32_16x16x32_bf16 v[240:243], a[156:159], a[160:163], v[240:243]
    ds_read_b64_tr_b16 a[148:149], v10 offset:8608
    v_mfma_f32_16x16x32_bf16 v[244:247], a[156:159], a[164:167], v[244:247]
    ds_read_b64_tr_b16 a[150:151], v10 offset:8864
    ds_read_b64_tr_b16 a[152:153], v10 offset:8640
    v_mfma_f32_16x16x32_bf16 v[248:251], a[156:159], a[168:171], v[248:251]
    ds_read_b64_tr_b16 a[154:155], v10 offset:8896
    v_mfma_f32_16x16x32_bf16 v[252:255], a[156:159], a[172:175], v[252:255]
    ds_read_b64_tr_b16 a[156:157], v10 offset:8672
    ds_read_b64_tr_b16 a[158:159], v10 offset:8928
    s_waitcnt lgkmcnt(12)
    v_mfma_f32_16x16x32_bf16 v[32:35], v[12:15], a[112:115], v[32:35]
    buffer_load_dwordx4 v4, s[16:19], s46 offen offset:0 lds
    v_mfma_f32_16x16x32_bf16 v[36:39], v[12:15], a[116:119], v[36:39]
    s_add_u32 m0, s45, 9248
    v_add_u32 v10, 100864, v6
    v_mfma_f32_16x16x32_bf16 v[128:131], a[64:67], a[0:3], v[128:131]
    v_lshl_add_u32 v11, s3, 6, v10
    v_mul_u32_u24 v6, 1056, v27
    v_mfma_f32_16x16x32_bf16 v[132:135], a[64:67], a[4:7], v[132:135]
    v_lshl_add_u32 v6, v23, 7, v6
    v_lshl_add_u32 v6, v28, 3, v6
    v_mfma_f32_16x16x32_bf16 v[136:139], a[64:67], a[8:11], v[136:139]
    v_add_u32 v6, s38, v6
    s_mul_i32 s38, s3, 4160
    v_mfma_f32_16x16x32_bf16 v[140:143], a[64:67], a[12:15], v[140:143]
    buffer_load_dwordx4 v4, s[16:19], s46 offen offset:256 lds
    v_mfma_f32_16x16x32_bf16 v[144:147], a[68:71], a[0:3], v[144:147]
    s_add_u32 s46, s46, 16384
    s_add_u32 m0, s44, 33536
    v_mfma_f32_16x16x32_bf16 v[148:151], a[68:71], a[4:7], v[148:151]
    s_and_b32 s46, s46, 0x1ffff
    v_mfma_f32_16x16x32_bf16 v[152:155], a[68:71], a[8:11], v[152:155]
    v_mfma_f32_16x16x32_bf16 v[156:159], a[68:71], a[12:15], v[156:159]
    v_mfma_f32_16x16x32_bf16 v[160:163], a[72:75], a[0:3], v[160:163]
    v_mfma_f32_16x16x32_bf16 v[164:167], a[72:75], a[4:7], v[164:167]
    v_mfma_f32_16x16x32_bf16 v[168:171], a[72:75], a[8:11], v[168:171]
    v_mfma_f32_16x16x32_bf16 v[172:175], a[72:75], a[12:15], v[172:175]
    v_mfma_f32_16x16x32_bf16 v[176:179], a[76:79], a[0:3], v[176:179]
    v_mfma_f32_16x16x32_bf16 v[180:183], a[76:79], a[4:7], v[180:183]
    v_mfma_f32_16x16x32_bf16 v[184:187], a[76:79], a[8:11], v[184:187]
    v_mfma_f32_16x16x32_bf16 v[188:191], a[76:79], a[12:15], v[188:191]
    v_mfma_f32_16x16x32_bf16 v[192:195], a[80:83], a[0:3], v[192:195]
    v_mfma_f32_16x16x32_bf16 v[196:199], a[80:83], a[4:7], v[196:199]
    s_waitcnt lgkmcnt(0)
    s_waitcnt vmcnt(6)
    s_barrier
    v_mfma_f32_16x16x32_bf16 v[200:203], a[80:83], a[8:11], v[200:203]
    v_xor_b32 v16, v49, v51
    v_xor_b32 v17, v53, v55
    v_mfma_f32_16x16x32_bf16 v[204:207], a[80:83], a[12:15], v[204:207]
    v_xor_b32 v19, s35, v49
    v_or3_b32 v16, v16, v17, v19
    v_mfma_f32_16x16x32_bf16 v[208:211], a[84:87], a[0:3], v[208:211]
    v_xor_b32 v17, s35, v53
    v_or_b32 v16, v16, v17
    v_mfma_f32_16x16x32_bf16 v[212:215], a[84:87], a[4:7], v[212:215]
    v_cmp_ne_u32 vcc, 0, v16
    ds_read_b64_tr_b16 a[112:113], v11 offset:0
    v_mfma_f32_16x16x32_bf16 v[216:219], a[84:87], a[8:11], v[216:219]
    s_cmp_lg_u64 vcc, 0
    s_cbranch_scc1 L_sp1x
L_sp1_ok:
    v_mfma_f32_16x16x32_bf16 v[220:223], a[84:87], a[12:15], v[220:223]
    ds_read_b64_tr_b16 a[114:115], v11 offset:256
    ds_read_b64_tr_b16 a[116:117], v11 offset:32
    v_mfma_f32_16x16x32_bf16 v[224:227], a[88:91], a[0:3], v[224:227]
    ds_read_b64_tr_b16 a[118:119], v11 offset:288
    v_lshl_add_u32 v19, s3, 8, v18
    v_mfma_f32_16x16x32_bf16 v[228:231], a[88:91], a[4:7], v[228:231]
    buffer_load_dwordx4 v3, s[12:15], s46 offen offset:0 lds
    v_mfma_f32_16x16x32_bf16 v[232:235], a[88:91], a[8:11], v[232:235]
    s_add_u32 m0, s44, 35360
    ds_read_b128 a[96:99], v9 offset:0
    v_mfma_f32_16x16x32_bf16 v[236:239], a[88:91], a[12:15], v[236:239]
    ds_read_b64_tr_b16 a[64:65], v10 offset:0
    v_and_b32 v56, 0xffff, v48
    v_mfma_f32_16x16x32_bf16 v[240:243], a[92:95], a[0:3], v[240:243]
    ds_read_b64_tr_b16 a[66:67], v10 offset:256
    ds_read_b64_tr_b16 a[68:69], v10 offset:32
    v_mfma_f32_16x16x32_bf16 v[244:247], a[92:95], a[4:7], v[244:247]
    ds_read_b64_tr_b16 a[70:71], v10 offset:288
    v_cmp_gt_u32 vcc, 16, v21
    v_mfma_f32_16x16x32_bf16 v[248:251], a[92:95], a[8:11], v[248:251]
    buffer_load_dwordx4 v3, s[12:15], s46 offen offset:256 lds
    v_mfma_f32_16x16x32_bf16 v[252:255], a[92:95], a[12:15], v[252:255]
    s_add_u32 m0, s44, 37184
    ds_read_b64_tr_b16 a[72:73], v10 offset:64
    v_mfma_f32_16x16x32_bf16 v[32:35], v[12:15], a[176:179], v[32:35]
    ds_read_b64_tr_b16 a[176:177], v11 offset:8448
    ds_read_b64_tr_b16 a[178:179], v11 offset:8704
    v_mfma_f32_16x16x32_bf16 v[36:39], v[12:15], a[180:183], v[36:39]
    ds_read_b64_tr_b16 a[180:181], v11 offset:8480
    v_lshl_or_b32 v56, v56, 16, v56
    v_mfma_f32_16x16x32_bf16 v[128:131], a[128:131], a[16:19], v[128:131]
    ds_read_b64_tr_b16 a[182:183], v11 offset:8736
    ds_read_b64_tr_b16 a[74:75], v10 offset:320
    v_mfma_f32_16x16x32_bf16 v[132:135], a[128:131], a[20:23], v[132:135]
    buffer_load_dwordx4 v3, s[12:15], s46 offen offset:512 lds
    v_mfma_f32_16x16x32_bf16 v[136:139], a[128:131], a[24:27], v[136:139]
    s_add_u32 m0, s44, 39008
    ds_read_b64_tr_b16 a[76:77], v10 offset:96
    v_mfma_f32_16x16x32_bf16 v[140:143], a[128:131], a[28:31], v[140:143]
    ds_read_b64_tr_b16 a[78:79], v10 offset:352
    ds_read_b64_tr_b16 a[80:81], v10 offset:128
    v_mfma_f32_16x16x32_bf16 v[144:147], a[132:135], a[16:19], v[144:147]
    ds_read_b64_tr_b16 a[82:83], v10 offset:384
    v_xor_b32 v56, 0x80008000, v56
    v_mfma_f32_16x16x32_bf16 v[148:151], a[132:135], a[20:23], v[148:151]
    ds_read_b64_tr_b16 a[84:85], v10 offset:160
    ds_read_b64_tr_b16 a[86:87], v10 offset:416
    v_mfma_f32_16x16x32_bf16 v[152:155], a[132:135], a[24:27], v[152:155]
    buffer_load_dwordx4 v3, s[12:15], s46 offen offset:768 lds
    v_mfma_f32_16x16x32_bf16 v[156:159], a[132:135], a[28:31], v[156:159]
    s_add_u32 m0, s45, 33536
    ds_read_b64_tr_b16 a[88:89], v10 offset:192
    s_waitcnt lgkmcnt(9)
    v_mfma_f32_16x16x32_bf16 v[32:35], v[12:15], a[112:115], v[32:35]
    ds_read_b64_tr_b16 a[90:91], v10 offset:448
    ds_read_b64_tr_b16 a[92:93], v10 offset:224
    v_mfma_f32_16x16x32_bf16 v[36:39], v[12:15], a[116:119], v[36:39]
    ds_read_b64_tr_b16 a[94:95], v10 offset:480
    v_cndmask_b32 v56, 0, v56, vcc
    v_mfma_f32_16x16x32_bf16 v[160:163], a[136:139], a[16:19], v[160:163]
    ds_read_b128 a[160:163], v9 offset:64
    v_and_b32 v58, 0xffff, v50
    v_mfma_f32_16x16x32_bf16 v[164:167], a[136:139], a[20:23], v[164:167]
    buffer_load_dwordx4 v4, s[16:19], s47 offen offset:0 lds
    v_mfma_f32_16x16x32_bf16 v[168:171], a[136:139], a[24:27], v[168:171]
    s_add_u32 m0, s45, 34336
    ds_read_b64_tr_b16 a[128:129], v10 offset:8448
    v_mfma_f32_16x16x32_bf16 v[172:175], a[136:139], a[28:31], v[172:175]
    ds_read_b64_tr_b16 a[130:131], v10 offset:8704
    ds_read_b64_tr_b16 a[132:133], v10 offset:8480
    v_mfma_f32_16x16x32_bf16 v[32:35], v[12:15], a[176:179], v[32:35]
    ds_read_b64_tr_b16 a[134:135], v10 offset:8736
    v_lshl_or_b32 v58, v58, 16, v58
    s_waitcnt lgkmcnt(9)
    v_mfma_f32_16x16x32_bf16 v[36:39], v[12:15], a[180:183], v[36:39]
    ds_read_b64_tr_b16 a[136:137], v10 offset:8512
    ds_read_b64_tr_b16 a[138:139], v10 offset:8768
    v_mfma_f32_16x16x32_bf16 v[176:179], a[140:143], a[16:19], v[176:179]
    buffer_load_dwordx4 v4, s[16:19], s47 offen offset:256 lds
    v_mfma_f32_16x16x32_bf16 v[180:183], a[140:143], a[20:23], v[180:183]
    v_cvt_pk_bf16_f32 v33, v32, v32
    s_nop 1
    v_cvt_pk_bf16_f32 v37, v36, v36
    v_mfma_f32_16x16x32_bf16 v[184:187], a[140:143], a[24:27], v[184:187]
    v_and_b32 v33, 0xffff0000, v33
    v_and_b32 v37, 0xffff0000, v37
    v_mfma_f32_16x16x32_bf16 v[188:191], a[140:143], a[28:31], v[188:191]
    v_sub_f32 v32, v32, v33
    v_sub_f32 v36, v36, v37
    v_mfma_f32_16x16x32_bf16 v[192:195], a[144:147], a[16:19], v[192:195]
    v_cvt_pk_bf16_f32 v32, v33, v32
    v_cvt_pk_bf16_f32 v36, v37, v36
    v_mfma_f32_16x16x32_bf16 v[196:199], a[144:147], a[20:23], v[196:199]
    v_mov_b32 v33, 0
    v_mov_b32 v37, 0
    v_mfma_f32_16x16x32_bf16 v[200:203], a[144:147], a[24:27], v[200:203]
    ds_write_b64 v19, v[32:33] offset:0
    s_add_u32 m0, s45, 41984
    v_mfma_f32_16x16x32_bf16 v[204:207], a[144:147], a[28:31], v[204:207]
    buffer_load_dwordx4 v4, s[16:19], s46 offen offset:0 lds
    v_mfma_f32_16x16x32_bf16 v[208:211], a[148:151], a[16:19], v[208:211]
    ds_write_b64 v19, v[36:37] offset:128
    s_add_u32 m0, s45, 42784
    v_mfma_f32_16x16x32_bf16 v[212:215], a[148:151], a[20:23], v[212:215]
    v_xor_b32 v58, 0x80008000, v58
    v_cndmask_b32 v58, 0, v58, vcc
    v_mfma_f32_16x16x32_bf16 v[216:219], a[148:151], a[24:27], v[216:219]
    ds_read_b64_tr_b16 a[140:141], v10 offset:8544
    ds_read_b64_tr_b16 a[142:143], v10 offset:8800
    v_mfma_f32_16x16x32_bf16 v[220:223], a[148:151], a[28:31], v[220:223]
    ds_read_b64_tr_b16 a[144:145], v10 offset:8576
    v_and_b32 v60, 0xffff, v52
    v_mfma_f32_16x16x32_bf16 v[224:227], a[152:155], a[16:19], v[224:227]
    ds_read_b64_tr_b16 a[146:147], v10 offset:8832
    ds_read_b64_tr_b16 a[148:149], v10 offset:8608
    v_mfma_f32_16x16x32_bf16 v[228:231], a[152:155], a[20:23], v[228:231]
    ds_read_b64_tr_b16 a[150:151], v10 offset:8864
    v_lshl_or_b32 v60, v60, 16, v60
    v_mfma_f32_16x16x32_bf16 v[232:235], a[152:155], a[24:27], v[232:235]
    buffer_load_dwordx4 v4, s[16:19], s46 offen offset:256 lds
    v_mfma_f32_16x16x32_bf16 v[236:239], a[152:155], a[28:31], v[236:239]
    ds_read_b64_tr_b16 a[152:153], v10 offset:8640
    ds_read_b64_tr_b16 a[154:155], v10 offset:8896
    v_mfma_f32_16x16x32_bf16 v[240:243], a[156:159], a[16:19], v[240:243]
    s_waitcnt lgkmcnt(8)
    s_waitcnt vmcnt(8)
    s_barrier
    v_mfma_f32_16x16x32_bf16 v[244:247], a[156:159], a[20:23], v[244:247]
    ds_read_b64 a[224:225], v18 offset:0
    ds_read_b64 a[226:227], v18 offset:128
    v_mfma_f32_16x16x32_bf16 v[248:251], a[156:159], a[24:27], v[248:251]
    ds_read_b64 a[228:229], v18 offset:256
    v_xor_b32 v60, 0x80008000, v60
    v_mfma_f32_16x16x32_bf16 v[252:255], a[156:159], a[28:31], v[252:255]
    ds_read_b64_tr_b16 a[156:157], v10 offset:8672
    ds_read_b64_tr_b16 a[158:159], v10 offset:8928
    v_mfma_f32_16x16x32_bf16 v[128:131], a[64:67], a[96:99], v[128:131]
    ds_read_b64 a[230:231], v18 offset:384
    v_cndmask_b32 v60, 0, v60, vcc
    v_mfma_f32_16x16x32_bf16 v[144:147], a[68:71], a[96:99], v[144:147]
    ds_read_b64 a[232:233], v18 offset:512
    ds_read_b64 a[234:235], v18 offset:640
    v_mfma_f32_16x16x32_bf16 v[160:163], a[72:75], a[96:99], v[160:163]
    ds_read_b64 a[236:237], v18 offset:768
    s_add_u32 s47, s46, 8192
    v_mfma_f32_16x16x32_bf16 v[176:179], a[76:79], a[96:99], v[176:179]
    ds_read_b64 a[238:239], v18 offset:896
    ds_read_b128 a[100:103], v9 offset:256
    v_mfma_f32_16x16x32_bf16 v[192:195], a[80:83], a[96:99], v[192:195]
    s_add_u32 s46, s46, 16384
    s_add_u32 m0, s44, 67072
    v_mfma_f32_16x16x32_bf16 v[208:211], a[84:87], a[96:99], v[208:211]
    ds_read_b128 a[164:167], v9 offset:320
    s_and_b32 s46, s46, 0x1ffff
    v_mfma_f32_16x16x32_bf16 v[224:227], a[88:91], a[96:99], v[224:227]
    ds_read_b128 a[104:107], v9 offset:512
    v_and_b32 v49, 0xffff0000, v48
    v_mfma_f32_16x16x32_bf16 v[240:243], a[92:95], a[96:99], v[240:243]
    ds_read_b128 a[168:171], v9 offset:576
    v_and_b32 v11, 7, v21
    v_mfma_f32_16x16x32_bf16 v[128:131], a[128:131], a[160:163], v[128:131]
    buffer_load_dwordx4 v3, s[12:15], s46 offen offset:0 lds
    v_mfma_f32_16x16x32_bf16 v[144:147], a[132:135], a[160:163], v[144:147]
    ds_read_b128 a[192:195], v7 offset:0
    s_add_u32 m0, s44, 68896
    v_mfma_f32_16x16x32_bf16 v[160:163], a[136:139], a[160:163], v[160:163]
    ds_read_b128 a[196:199], v7 offset:64
    v_lshl_add_u32 v5, v11, 4, v5
    s_waitcnt lgkmcnt(7)
    v_mfma_f32_16x16x32_bf16 v[176:179], a[140:143], a[160:163], v[176:179]
    v_rcp_f32 v49, v49
    v_mfma_f32_16x16x32_bf16 v[192:195], a[144:147], a[160:163], v[192:195]
    ds_read_b128 a[200:203], v7 offset:128
    v_mul_f32 v49, 0x3e0293ee, v49
    v_mfma_f32_16x16x32_bf16 v[208:211], a[148:151], a[160:163], v[208:211]
    buffer_load_dwordx4 v3, s[12:15], s46 offen offset:256 lds
    v_mfma_f32_16x16x32_bf16 v[224:227], a[152:155], a[160:163], v[224:227]
    ds_read_b128 a[204:207], v7 offset:192
    s_add_u32 m0, s44, 70720
    v_mfma_f32_16x16x32_bf16 v[240:243], a[156:159], a[160:163], v[240:243]
    ds_read_b128 a[208:211], v7 offset:256
    v_and_b32 v62, 0xffff, v54
    v_mfma_f32_16x16x16_bf16 v[128:131], a[224:225], v[56:57], v[128:131]
    ds_read_b128 a[212:215], v7 offset:320
    v_lshl_or_b32 v62, v62, 16, v62
    v_mfma_f32_16x16x16_bf16 v[144:147], a[226:227], v[56:57], v[144:147]
    v_xor_b32 v62, 0x80008000, v62
    ds_read_b128 a[216:219], v7 offset:384
    v_mfma_f32_16x16x16_bf16 v[160:163], a[228:229], v[56:57], v[160:163]
    buffer_load_dwordx4 v3, s[12:15], s46 offen offset:512 lds
    v_mfma_f32_16x16x16_bf16 v[176:179], a[230:231], v[56:57], v[176:179]
    v_mul_f32 v128, v128, v49
    v_mul_f32 v129, v129, v49
    v_mfma_f32_16x16x16_bf16 v[192:195], a[232:233], v[56:57], v[192:195]
    v_mul_f32 v144, v144, v49
    v_mul_f32 v145, v145, v49
    v_mfma_f32_16x16x16_bf16 v[208:211], a[234:235], v[56:57], v[208:211]
    v_mul_f32 v130, v130, v49
    v_mul_f32 v131, v131, v49
    v_mfma_f32_16x16x16_bf16 v[224:227], a[236:237], v[56:57], v[224:227]
    v_cvt_pk_bf16_f32 v128, v128, v129
    v_mul_f32 v146, v146, v49
    s_waitcnt lgkmcnt(3)
    v_mfma_f32_16x16x16_bf16 v[240:243], a[238:239], v[56:57], v[240:243]
    v_mul_f32 v147, v147, v49
    v_cvt_pk_bf16_f32 v144, v144, v145
    v_mfma_f32_16x16x32_bf16 v[132:135], a[64:67], a[100:103], v[132:135]
    v_cvt_pk_bf16_f32 v129, v130, v131
    v_cvt_pk_bf16_f32 v145, v146, v147
    v_mfma_f32_16x16x32_bf16 v[148:151], a[68:71], a[100:103], v[148:151]
    v_mul_f32 v160, v160, v49
    v_mul_f32 v161, v161, v49
    v_mfma_f32_16x16x32_bf16 v[164:167], a[72:75], a[100:103], v[164:167]
    v_mul_f32 v176, v176, v49
    v_mul_f32 v177, v177, v49
    v_mfma_f32_16x16x32_bf16 v[180:183], a[76:79], a[100:103], v[180:183]
    v_permlane16_swap_b32 v128, v144
    v_permlane16_swap_b32 v129, v145
    v_mfma_f32_16x16x32_bf16 v[196:199], a[80:83], a[100:103], v[196:199]
    v_mul_f32 v162, v162, v49
    v_mul_f32 v163, v163, v49
    v_mfma_f32_16x16x32_bf16 v[212:215], a[84:87], a[100:103], v[212:215]
    v_cvt_pk_bf16_f32 v160, v160, v161
    v_mul_f32 v178, v178, v49
    v_mfma_f32_16x16x32_bf16 v[228:231], a[88:91], a[100:103], v[228:231]
    v_mul_f32 v179, v179, v49
    v_cvt_pk_bf16_f32 v176, v176, v177
    v_mfma_f32_16x16x32_bf16 v[244:247], a[92:95], a[100:103], v[244:247]
    v_accvgpr_write_b32 a0, v128
    v_accvgpr_write_b32 a1, v129
    v_mfma_f32_16x16x32_bf16 v[132:135], a[128:131], a[164:167], v[132:135]
    v_accvgpr_write_b32 a2, v144
    v_accvgpr_write_b32 a3, v145
    v_mfma_f32_16x16x32_bf16 v[148:151], a[132:135], a[164:167], v[148:151]
    v_cvt_pk_bf16_f32 v161, v162, v163
    v_cvt_pk_bf16_f32 v177, v178, v179
    v_mfma_f32_16x16x32_bf16 v[164:167], a[136:139], a[164:167], v[164:167]
    v_mul_f32 v192, v192, v49
    v_mul_f32 v193, v193, v49
    v_mfma_f32_16x16x32_bf16 v[180:183], a[140:143], a[164:167], v[180:183]
    v_mul_f32 v208, v208, v49
    v_mul_f32 v209, v209, v49
    v_mfma_f32_16x16x32_bf16 v[196:199], a[144:147], a[164:167], v[196:199]
    v_permlane16_swap_b32 v160, v176
    v_permlane16_swap_b32 v161, v177
    v_mfma_f32_16x16x32_bf16 v[212:215], a[148:151], a[164:167], v[212:215]
    v_mul_f32 v194, v194, v49
    v_mul_f32 v195, v195, v49
    v_mfma_f32_16x16x32_bf16 v[228:231], a[152:155], a[164:167], v[228:231]
    v_cvt_pk_bf16_f32 v192, v192, v193
    v_mul_f32 v210, v210, v49
    v_mfma_f32_16x16x32_bf16 v[244:247], a[156:159], a[164:167], v[244:247]
    v_mul_f32 v211, v211, v49
    v_cvt_pk_bf16_f32 v208, v208, v209
    v_mfma_f32_16x16x16_bf16 v[132:135], a[224:225], v[58:59], v[132:135]
    v_accvgpr_write_b32 a4, v160
    v_accvgpr_write_b32 a5, v161
    v_mfma_f32_16x16x16_bf16 v[148:151], a[226:227], v[58:59], v[148:151]
    v_accvgpr_write_b32 a6, v176
    v_accvgpr_write_b32 a7, v177
    v_mfma_f32_16x16x16_bf16 v[164:167], a[228:229], v[58:59], v[164:167]
    v_cvt_pk_bf16_f32 v193, v194, v195
    v_cvt_pk_bf16_f32 v209, v210, v211
    v_mfma_f32_16x16x16_bf16 v[180:183], a[230:231], v[58:59], v[180:183]
    v_mul_f32 v224, v224, v49
    v_mul_f32 v225, v225, v49
    v_mfma_f32_16x16x16_bf16 v[196:199], a[232:233], v[58:59], v[196:199]
    v_mul_f32 v240, v240, v49
    v_mul_f32 v241, v241, v49
    v_mfma_f32_16x16x16_bf16 v[212:215], a[234:235], v[58:59], v[212:215]
    v_permlane16_swap_b32 v192, v208
    v_permlane16_swap_b32 v193, v209
    v_mfma_f32_16x16x16_bf16 v[228:231], a[236:237], v[58:59], v[228:231]
    v_mul_f32 v226, v226, v49
    v_mul_f32 v227, v227, v49
    v_mfma_f32_16x16x16_bf16 v[244:247], a[238:239], v[58:59], v[244:247]
    v_cvt_pk_bf16_f32 v224, v224, v225
    v_mul_f32 v242, v242, v49
    v_mfma_f32_16x16x32_bf16 v[136:139], a[64:67], a[104:107], v[136:139]
    v_mul_f32 v243, v243, v49
    v_cvt_pk_bf16_f32 v240, v240, v241
    v_mfma_f32_16x16x32_bf16 v[152:155], a[68:71], a[104:107], v[152:155]
    v_accvgpr_write_b32 a8, v192
    v_accvgpr_write_b32 a9, v193
    v_mfma_f32_16x16x32_bf16 v[168:171], a[72:75], a[104:107], v[168:171]
    v_accvgpr_write_b32 a10, v208
    v_accvgpr_write_b32 a11, v209
    v_mfma_f32_16x16x32_bf16 v[184:187], a[76:79], a[104:107], v[184:187]
    v_cvt_pk_bf16_f32 v225, v226, v227
    v_cvt_pk_bf16_f32 v241, v242, v243
    v_mfma_f32_16x16x32_bf16 v[200:203], a[80:83], a[104:107], v[200:203]
    ds_read_b128 a[220:223], v7 offset:448
    v_permlane16_swap_b32 v224, v240
    v_mfma_f32_16x16x32_bf16 v[216:219], a[84:87], a[104:107], v[216:219]
    v_permlane16_swap_b32 v225, v241
    v_accvgpr_write_b32 a12, v224
    v_mfma_f32_16x16x32_bf16 v[232:235], a[88:91], a[104:107], v[232:235]
    v_accvgpr_write_b32 a13, v225
    v_accvgpr_write_b32 a14, v240
    v_mfma_f32_16x16x32_bf16 v[248:251], a[92:95], a[104:107], v[248:251]
    v_accvgpr_write_b32 a15, v241
    ds_read_b128 a[108:111], v9 offset:768
    v_mfma_f32_16x16x32_bf16 v[136:139], a[128:131], a[168:171], v[136:139]
    s_add_u32 m0, s44, 72544
    ds_read_b128 a[172:175], v9 offset:832
    v_mfma_f32_16x16x32_bf16 v[152:155], a[132:135], a[168:171], v[152:155]
    buffer_load_dwordx4 v3, s[12:15], s46 offen offset:768 lds
    v_mfma_f32_16x16x32_bf16 v[168:171], a[136:139], a[168:171], v[168:171]
    s_add_u32 m0, s45, 67072
    ds_read_b64_tr_b16 a[96:97], v8 offset:8448
    v_mfma_f32_16x16x32_bf16 v[184:187], a[140:143], a[168:171], v[184:187]
    ds_read_b64_tr_b16 a[98:99], v8 offset:8960
    ds_read_b64_tr_b16 a[100:101], v8 offset:8480
    v_mfma_f32_16x16x32_bf16 v[200:203], a[144:147], a[168:171], v[200:203]
    ds_read_b64_tr_b16 a[102:103], v8 offset:8992
    v_cndmask_b32 v62, 0, v62, vcc
    v_mfma_f32_16x16x32_bf16 v[216:219], a[148:151], a[168:171], v[216:219]
    ds_read_b64_tr_b16 a[104:105], v8 offset:8512
    ds_read_b64_tr_b16 a[106:107], v8 offset:9024
    v_mfma_f32_16x16x32_bf16 v[232:235], a[152:155], a[168:171], v[232:235]
    buffer_load_dwordx4 v4, s[16:19], s47 offen offset:0 lds
    v_mfma_f32_16x16x32_bf16 v[248:251], a[156:159], a[168:171], v[248:251]
    s_add_u32 m0, s45, 67872
    ds_read_b64_tr_b16 a[112:113], v8 offset:8576
    v_mfma_f32_16x16x16_bf16 v[136:139], a[224:225], v[60:61], v[136:139]
    ds_read_b64_tr_b16 a[114:115], v8 offset:9088
    ds_read_b64_tr_b16 a[116:117], v8 offset:8608
    v_mfma_f32_16x16x16_bf16 v[152:155], a[226:227], v[60:61], v[152:155]
    ds_read_b64_tr_b16 a[118:119], v8 offset:9120
    v_and_b32 v51, 0xffff0000, v50
    v_mfma_f32_16x16x16_bf16 v[168:171], a[228:229], v[60:61], v[168:171]
    ds_read_b64_tr_b16 a[120:121], v8 offset:8640
    ds_read_b64_tr_b16 a[122:123], v8 offset:9152
    v_mfma_f32_16x16x16_bf16 v[184:187], a[230:231], v[60:61], v[184:187]
    buffer_load_dwordx4 v4, s[16:19], s47 offen offset:256 lds
    v_mfma_f32_16x16x16_bf16 v[200:203], a[232:233], v[60:61], v[200:203]
    s_add_u32 m0, s45, 75520
    ds_read_b64_tr_b16 a[124:125], v8 offset:8672
    v_mfma_f32_16x16x16_bf16 v[216:219], a[234:235], v[60:61], v[216:219]
    ds_read_b64_tr_b16 a[126:127], v8 offset:9184
    s_add_u32 s47, s46, 8192
    v_mfma_f32_16x16x16_bf16 v[232:235], a[236:237], v[60:61], v[232:235]
    v_rcp_f32 v51, v51
    v_mfma_f32_16x16x16_bf16 v[248:251], a[238:239], v[60:61], v[248:251]
    v_mul_f32 v51, 0x3e0293ee, v51
    v_mul_f32 v132, v132, v51
    v_mfma_f32_16x16x32_bf16 v[64:67], a[192:195], a[0:3], 0
    buffer_load_dwordx4 v4, s[16:19], s46 offen offset:0 lds
    v_mfma_f32_16x16x32_bf16 v[64:67], a[196:199], a[4:7], v[64:67]
    s_add_u32 m0, s45, 76320
    v_mul_f32 v133, v133, v51
    v_mfma_f32_16x16x32_bf16 v[64:67], a[200:203], a[8:11], v[64:67]
    v_mul_f32 v148, v148, v51
    v_mul_f32 v149, v149, v51
    v_mfma_f32_16x16x32_bf16 v[64:67], a[204:207], a[12:15], v[64:67]
    v_mul_f32 v134, v134, v51
    v_mul_f32 v135, v135, v51
    s_waitcnt lgkmcnt(2)
    v_mfma_f32_16x16x32_bf16 v[80:83], a[208:211], a[0:3], 0
    v_cvt_pk_bf16_f32 v132, v132, v133
    v_mul_f32 v150, v150, v51
    v_mfma_f32_16x16x32_bf16 v[80:83], a[212:215], a[4:7], v[80:83]
    buffer_load_dwordx4 v4, s[16:19], s46 offen offset:256 lds
    v_mfma_f32_16x16x32_bf16 v[80:83], a[216:219], a[8:11], v[80:83]
    s_add_u32 m0, s33, 142592
    s_add_u32 s46, s46, 16384
    v_mfma_f32_16x16x32_bf16 v[80:83], a[220:223], a[12:15], v[80:83]
    s_and_b32 s46, s46, 0x1ffff
    v_mul_f32 v151, v151, v51
    v_mfma_f32_16x16x32_bf16 v[140:143], a[64:67], a[108:111], v[140:143]
    ds_read_b128 a[64:67], v7 offset:512
    v_cvt_pk_bf16_f32 v148, v148, v149
    v_mfma_f32_16x16x32_bf16 v[156:159], a[68:71], a[108:111], v[156:159]
    ds_read_b128 a[68:71], v7 offset:576
    v_cvt_pk_bf16_f32 v133, v134, v135
    v_mfma_f32_16x16x32_bf16 v[172:175], a[72:75], a[108:111], v[172:175]
    ds_read_b128 a[72:75], v7 offset:640
    v_cvt_pk_bf16_f32 v149, v150, v151
    v_mfma_f32_16x16x32_bf16 v[188:191], a[76:79], a[108:111], v[188:191]
    buffer_load_dword v2, v1, s[8:11], s54 offen
    v_mfma_f32_16x16x32_bf16 v[204:207], a[80:83], a[108:111], v[204:207]
    ds_read_b128 a[76:79], v7 offset:704
    v_mul_f32 v164, v164, v51
    v_mfma_f32_16x16x32_bf16 v[220:223], a[84:87], a[108:111], v[220:223]
    ds_read_b128 a[80:83], v7 offset:768
    v_mul_f32 v165, v165, v51
    v_mfma_f32_16x16x32_bf16 v[236:239], a[88:91], a[108:111], v[236:239]
    ds_read_b128 a[84:87], v7 offset:832
    v_mul_f32 v180, v180, v51
    v_mfma_f32_16x16x32_bf16 v[252:255], a[92:95], a[108:111], v[252:255]
    v_mul_f32 v181, v181, v51
    ds_read_b128 a[88:91], v7 offset:896
    v_mfma_f32_16x16x32_bf16 v[140:143], a[128:131], a[172:175], v[140:143]
    v_permlane16_swap_b32 v132, v148
    v_permlane16_swap_b32 v133, v149
    v_mfma_f32_16x16x32_bf16 v[156:159], a[132:135], a[172:175], v[156:159]
    ds_read_b128 a[92:95], v7 offset:960
    v_mul_f32 v166, v166, v51
    v_mfma_f32_16x16x32_bf16 v[172:175], a[136:139], a[172:175], v[172:175]
    ds_read_b64_tr_b16 a[108:109], v8 offset:8544
    v_mul_f32 v167, v167, v51
    v_mfma_f32_16x16x32_bf16 v[188:191], a[140:143], a[172:175], v[188:191]
    ds_read_b64_tr_b16 a[110:111], v8 offset:9056
    v_cvt_pk_bf16_f32 v164, v164, v165
    v_mfma_f32_16x16x32_bf16 v[204:207], a[144:147], a[172:175], v[204:207]
    v_mul_f32 v182, v182, v51
    v_mul_f32 v183, v183, v51
    v_mfma_f32_16x16x32_bf16 v[220:223], a[148:151], a[172:175], v[220:223]
    v_cvt_pk_bf16_f32 v180, v180, v181
    v_accvgpr_write_b32 a16, v132
    v_mfma_f32_16x16x32_bf16 v[236:239], a[152:155], a[172:175], v[236:239]
    v_accvgpr_write_b32 a17, v133
    v_accvgpr_write_b32 a18, v148
    v_mfma_f32_16x16x32_bf16 v[252:255], a[156:159], a[172:175], v[252:255]
    v_accvgpr_write_b32 a19, v149
    v_cvt_pk_bf16_f32 v165, v166, v167
    v_mfma_f32_16x16x16_bf16 v[140:143], a[224:225], v[62:63], v[140:143]
    v_cvt_pk_bf16_f32 v181, v182, v183
    v_mul_f32 v196, v196, v51
    v_mfma_f32_16x16x16_bf16 v[156:159], a[226:227], v[62:63], v[156:159]
    v_mul_f32 v197, v197, v51
    v_mul_f32 v212, v212, v51
    v_mfma_f32_16x16x16_bf16 v[172:175], a[228:229], v[62:63], v[172:175]
    v_mul_f32 v213, v213, v51
    v_permlane16_swap_b32 v164, v180
    v_mfma_f32_16x16x16_bf16 v[188:191], a[230:231], v[62:63], v[188:191]
    s_waitcnt lgkmcnt(0)
    s_waitcnt vmcnt(9)
    s_barrier
    v_mfma_f32_16x16x16_bf16 v[204:207], a[232:233], v[62:63], v[204:207]
    buffer_load_dwordx4 v5, s[8:11], s41 offen offset:0 lds
    v_mfma_f32_16x16x16_bf16 v[220:223], a[234:235], v[62:63], v[220:223]
    s_add_u32 m0, s33, 142624
    v_permlane16_swap_b32 v165, v181
    v_mfma_f32_16x16x16_bf16 v[236:239], a[236:237], v[62:63], v[236:239]
    v_mul_f32 v198, v198, v51
    v_mul_f32 v199, v199, v51
    v_mfma_f32_16x16x16_bf16 v[252:255], a[238:239], v[62:63], v[252:255]
    v_cvt_pk_bf16_f32 v196, v196, v197
    v_mul_f32 v214, v214, v51
    v_mfma_f32_16x16x32_bf16 v[68:71], a[192:195], a[16:19], 0
    v_mul_f32 v215, v215, v51
    v_cvt_pk_bf16_f32 v212, v212, v213
    v_accvgpr_write_b32 a20, v164
    buffer_load_dwordx4 v5, s[8:11], s41 offen offset:1024 lds
    s_add_u32 m0, s33, 142656
    v_accvgpr_write_b32 a21, v165
    v_accvgpr_write_b32 a22, v180
    v_accvgpr_write_b32 a23, v181
    v_cvt_pk_bf16_f32 v197, v198, v199
    v_cvt_pk_bf16_f32 v213, v214, v215
    v_mfma_f32_16x16x32_bf16 v[68:71], a[196:199], a[20:23], v[68:71]
    v_mul_f32 v228, v228, v51
    v_mul_f32 v229, v229, v51
    v_mul_f32 v244, v244, v51
    v_mul_f32 v245, v245, v51
    v_permlane16_swap_b32 v196, v212
    v_permlane16_swap_b32 v197, v213
    v_mul_f32 v230, v230, v51
    v_mul_f32 v231, v231, v51
    v_cvt_pk_bf16_f32 v228, v228, v229
    buffer_load_dwordx4 v5, s[8:11], s41 offen offset:2048 lds
    s_add_u32 m0, s33, 142688
    v_mul_f32 v246, v246, v51
    v_mul_f32 v247, v247, v51
    v_cvt_pk_bf16_f32 v244, v244, v245
    v_accvgpr_write_b32 a24, v196
    v_accvgpr_write_b32 a25, v197
    v_accvgpr_write_b32 a26, v212
    v_accvgpr_write_b32 a27, v213
    v_cvt_pk_bf16_f32 v229, v230, v231
    v_cvt_pk_bf16_f32 v245, v246, v247
    v_mfma_f32_16x16x32_bf16 v[68:71], a[200:203], a[24:27], v[68:71]
    v_permlane16_swap_b32 v228, v244
    v_permlane16_swap_b32 v229, v245
    v_accvgpr_write_b32 a28, v228
    v_accvgpr_write_b32 a29, v229
    v_accvgpr_write_b32 a30, v244
    buffer_load_dwordx4 v5, s[8:11], s41 offen offset:3072 lds
    s_add_u32 m0, s44, 100608
    v_accvgpr_write_b32 a31, v245
    v_max3_f32 v16, v64, v65, v66
    v_max3_f32 v17, v67, v80, v81
    v_mfma_f32_16x16x32_bf16 v[68:71], a[204:207], a[28:31], v[68:71]
    v_max3_f32 v16, v16, v82, v83
    v_max3_f32 v16, v16, v17, v44
    v_mfma_f32_16x16x32_bf16 v[84:87], a[208:211], a[16:19], 0
    v_mov_b32 v17, v16
    v_and_b32 v53, 0xffff0000, v52
    v_mfma_f32_16x16x32_bf16 v[84:87], a[212:215], a[20:23], v[84:87]
    v_permlane16_swap_b32 v16, v17
    v_max_f32 v16, v16, v17
    v_mfma_f32_16x16x32_bf16 v[84:87], a[216:219], a[24:27], v[84:87]
    buffer_load_dwordx4 v3, s[12:15], s46 offen offset:0 lds
    v_mov_b32 v17, v16
    v_mfma_f32_16x16x32_bf16 v[84:87], a[220:223], a[28:31], v[84:87]
    s_add_u32 m0, s44, 102432
    v_permlane32_swap_b32 v16, v17
    v_max_f32 v17, v16, v17
    v_sub_f32 v16, 0, v17
    v_sub_f32 v18, 0, v17
    v_sub_f32 v19, 0, v17
    v_sub_f32 v17, 0, v17
    v_rcp_f32 v53, v53
    s_nop 0
    v_mfma_f32_16x16x32_bf16 v[96:99], a[64:67], a[0:3], v[16:19]
    v_mul_f32 v53, 0x3e0293ee, v53
    v_mul_f32 v136, v136, v53
    v_mfma_f32_16x16x32_bf16 v[96:99], a[68:71], a[4:7], v[96:99]
    buffer_load_dwordx4 v3, s[12:15], s46 offen offset:256 lds
    v_mfma_f32_16x16x32_bf16 v[96:99], a[72:75], a[8:11], v[96:99]
    s_add_u32 m0, s44, 104256
    v_mul_f32 v137, v137, v53
    v_mfma_f32_16x16x32_bf16 v[96:99], a[76:79], a[12:15], v[96:99]
    v_mul_f32 v152, v152, v53
    v_mul_f32 v153, v153, v53
    v_mfma_f32_16x16x32_bf16 v[112:115], a[80:83], a[0:3], v[16:19]
    v_mul_f32 v138, v138, v53
    v_mul_f32 v139, v139, v53
    v_mfma_f32_16x16x32_bf16 v[112:115], a[84:87], a[4:7], v[112:115]
    v_cvt_pk_bf16_f32 v136, v136, v137
    v_mul_f32 v154, v154, v53
    v_mfma_f32_16x16x32_bf16 v[112:115], a[88:91], a[8:11], v[112:115]
    buffer_load_dwordx4 v3, s[12:15], s46 offen offset:512 lds
    v_mul_f32 v155, v155, v53
    v_cvt_pk_bf16_f32 v152, v152, v153
    v_cvt_pk_bf16_f32 v137, v138, v139
    v_cvt_pk_bf16_f32 v153, v154, v155
    v_mfma_f32_16x16x32_bf16 v[112:115], a[92:95], a[12:15], v[112:115]
    s_add_u32 m0, s44, 106080
    v_mul_f32 v168, v168, v53
    v_mul_f32 v169, v169, v53
    v_mul_f32 v184, v184, v53
    v_mul_f32 v185, v185, v53
    v_permlane16_swap_b32 v136, v152
    v_permlane16_swap_b32 v137, v153
    v_mul_f32 v170, v170, v53
    v_mul_f32 v171, v171, v53
    v_cvt_pk_bf16_f32 v168, v168, v169
    v_mul_f32 v186, v186, v53
    buffer_load_dwordx4 v3, s[12:15], s46 offen offset:768 lds
    s_add_u32 m0, s45, 100608
    v_mul_f32 v187, v187, v53
    v_cvt_pk_bf16_f32 v184, v184, v185
    v_accvgpr_write_b32 a32, v136
    v_accvgpr_write_b32 a33, v137
    v_accvgpr_write_b32 a34, v152
    v_accvgpr_write_b32 a35, v153
    v_cvt_pk_bf16_f32 v169, v170, v171
    v_cvt_pk_bf16_f32 v185, v186, v187
    v_mfma_f32_16x16x32_bf16 v[72:75], a[192:195], a[32:35], 0
    v_mul_f32 v200, v200, v53
    v_mul_f32 v201, v201, v53
    v_mul_f32 v216, v216, v53
    v_mul_f32 v217, v217, v53
    v_permlane16_swap_b32 v168, v184
    v_permlane16_swap_b32 v169, v185
    buffer_load_dwordx4 v4, s[16:19], s47 offen offset:0 lds
    s_add_u32 m0, s45, 101408
    v_mul_f32 v202, v202, v53
    v_mul_f32 v203, v203, v53
    v_cvt_pk_bf16_f32 v200, v200, v201
    v_mul_f32 v218, v218, v53
    v_mul_f32 v219, v219, v53
    v_cvt_pk_bf16_f32 v216, v216, v217
    v_accvgpr_write_b32 a36, v168
    v_accvgpr_write_b32 a37, v169
    v_accvgpr_write_b32 a38, v184
    v_accvgpr_write_b32 a39, v185
    v_cvt_pk_bf16_f32 v201, v202, v203
    v_cvt_pk_bf16_f32 v217, v218, v219
    v_mfma_f32_16x16x32_bf16 v[72:75], a[196:199], a[36:39], v[72:75]
    v_mul_f32 v232, v232, v53
    v_mul_f32 v233, v233, v53
    buffer_load_dwordx4 v4, s[16:19], s47 offen offset:256 lds
    v_mul_f32 v248, v248, v53
    v_mul_f32 v249, v249, v53
    v_permlane16_swap_b32 v200, v216
    v_permlane16_swap_b32 v201, v217
    v_mul_f32 v234, v234, v53
    v_mul_f32 v235, v235, v53
    v_cvt_pk_bf16_f32 v232, v232, v233
    v_mul_f32 v250, v250, v53
    v_mul_f32 v251, v251, v53
    v_cvt_pk_bf16_f32 v248, v248, v249
    v_accvgpr_write_b32 a40, v200
    v_accvgpr_write_b32 a41, v201
    v_accvgpr_write_b32 a42, v216
    v_accvgpr_write_b32 a43, v217
    v_cvt_pk_bf16_f32 v233, v234, v235
    v_cvt_pk_bf16_f32 v249, v250, v251
    v_mfma_f32_16x16x32_bf16 v[72:75], a[200:203], a[40:43], v[72:75]
    v_permlane16_swap_b32 v232, v248
    v_permlane16_swap_b32 v233, v249
    v_accvgpr_write_b32 a44, v232
    v_accvgpr_write_b32 a45, v233
    v_accvgpr_write_b32 a46, v248
    v_accvgpr_write_b32 a47, v249
    v_max3_f32 v20, v68, v69, v70
    v_max3_f32 v21, v71, v84, v85
    v_mfma_f32_16x16x32_bf16 v[72:75], a[204:207], a[44:47], v[72:75]
    v_max3_f32 v20, v20, v86, v87
    v_max3_f32 v20, v20, v21, v45
    v_mfma_f32_16x16x32_bf16 v[88:91], a[208:211], a[32:35], 0
    v_mov_b32 v21, v20
    v_and_b32 v55, 0xffff0000, v54
    v_mfma_f32_16x16x32_bf16 v[88:91], a[212:215], a[36:39], v[88:91]
    v_permlane16_swap_b32 v20, v21
    v_max_f32 v20, v20, v21
    v_mfma_f32_16x16x32_bf16 v[88:91], a[216:219], a[40:43], v[88:91]
    v_mov_b32 v21, v20
    v_max3_f32 v24, v72, v73, v74
    v_mfma_f32_16x16x32_bf16 v[88:91], a[220:223], a[44:47], v[88:91]
    v_permlane32_swap_b32 v20, v21
    v_max_f32 v21, v20, v21
    v_sub_f32 v20, 0, v21
    v_sub_f32 v22, 0, v21
    v_sub_f32 v23, 0, v21
    v_sub_f32 v21, 0, v21
    v_rcp_f32 v55, v55
    s_nop 0
    v_mfma_f32_16x16x32_bf16 v[100:103], a[64:67], a[16:19], v[20:23]
    v_mul_f32 v55, 0x3e0293ee, v55
    v_mul_f32 v140, v140, v55
    v_mfma_f32_16x16x32_bf16 v[100:103], a[68:71], a[20:23], v[100:103]
    v_mul_f32 v141, v141, v55
    v_mul_f32 v156, v156, v55
    v_mfma_f32_16x16x32_bf16 v[100:103], a[72:75], a[24:27], v[100:103]
    v_mul_f32 v157, v157, v55
    v_mul_f32 v142, v142, v55
    v_mfma_f32_16x16x32_bf16 v[100:103], a[76:79], a[28:31], v[100:103]
    v_mul_f32 v143, v143, v55
    v_cvt_pk_bf16_f32 v140, v140, v141
    v_mfma_f32_16x16x32_bf16 v[116:119], a[80:83], a[16:19], v[20:23]
    v_mul_f32 v158, v158, v55
    v_mul_f32 v159, v159, v55
    v_mfma_f32_16x16x32_bf16 v[116:119], a[84:87], a[20:23], v[116:119]
    v_cvt_pk_bf16_f32 v156, v156, v157
    v_cvt_pk_bf16_f32 v141, v142, v143
    v_mfma_f32_16x16x32_bf16 v[116:119], a[88:91], a[24:27], v[116:119]
    v_cvt_pk_bf16_f32 v157, v158, v159
    v_mul_f32 v172, v172, v55
    v_mfma_f32_16x16x32_bf16 v[116:119], a[92:95], a[28:31], v[116:119]
    v_mul_f32 v173, v173, v55
    v_mul_f32 v188, v188, v55
    v_mul_f32 v189, v189, v55
    v_permlane16_swap_b32 v140, v156
    v_permlane16_swap_b32 v141, v157
    v_mul_f32 v174, v174, v55
    v_mul_f32 v175, v175, v55
    v_cvt_pk_bf16_f32 v172, v172, v173
    v_mul_f32 v190, v190, v55
    v_mul_f32 v191, v191, v55
    v_cvt_pk_bf16_f32 v188, v188, v189
    v_accvgpr_write_b32 a48, v140
    v_accvgpr_write_b32 a49, v141
    v_accvgpr_write_b32 a50, v156
    v_accvgpr_write_b32 a51, v157
    v_cvt_pk_bf16_f32 v173, v174, v175
    v_cvt_pk_bf16_f32 v189, v190, v191
    v_mfma_f32_16x16x32_bf16 v[76:79], a[192:195], a[48:51], 0
    v_mul_f32 v204, v204, v55
    v_mul_f32 v205, v205, v55
    v_mul_f32 v220, v220, v55
    v_mul_f32 v221, v221, v55
    v_permlane16_swap_b32 v172, v188
    v_permlane16_swap_b32 v173, v189
    v_mul_f32 v206, v206, v55
    v_mul_f32 v207, v207, v55
    v_cvt_pk_bf16_f32 v204, v204, v205
    v_mul_f32 v222, v222, v55
    v_mul_f32 v223, v223, v55
    v_cvt_pk_bf16_f32 v220, v220, v221
    v_accvgpr_write_b32 a52, v172
    v_accvgpr_write_b32 a53, v173
    v_accvgpr_write_b32 a54, v188
    v_accvgpr_write_b32 a55, v189
    v_cvt_pk_bf16_f32 v205, v206, v207
    v_cvt_pk_bf16_f32 v221, v222, v223
    v_mfma_f32_16x16x32_bf16 v[76:79], a[196:199], a[52:55], v[76:79]
    v_mul_f32 v236, v236, v55
    v_mul_f32 v237, v237, v55
    v_mul_f32 v252, v252, v55
    v_mul_f32 v253, v253, v55
    v_permlane16_swap_b32 v204, v220
    v_permlane16_swap_b32 v205, v221
    v_mul_f32 v238, v238, v55
    v_mul_f32 v239, v239, v55
    v_cvt_pk_bf16_f32 v236, v236, v237
    v_mul_f32 v254, v254, v55
    v_mul_f32 v255, v255, v55
    v_cvt_pk_bf16_f32 v252, v252, v253
    v_accvgpr_write_b32 a56, v204
    v_accvgpr_write_b32 a57, v205
    v_accvgpr_write_b32 a58, v220
    v_accvgpr_write_b32 a59, v221
    v_cvt_pk_bf16_f32 v237, v238, v239
    v_cvt_pk_bf16_f32 v253, v254, v255
    v_mfma_f32_16x16x32_bf16 v[76:79], a[200:203], a[56:59], v[76:79]
    v_permlane16_swap_b32 v236, v252
    v_permlane16_swap_b32 v237, v253
    v_accvgpr_write_b32 a60, v236
    v_accvgpr_write_b32 a61, v237
    v_accvgpr_write_b32 a62, v252
    v_accvgpr_write_b32 a63, v253
    v_max3_f32 v25, v75, v88, v89
    v_max3_f32 v24, v24, v90, v91
    v_mfma_f32_16x16x32_bf16 v[76:79], a[204:207], a[60:63], v[76:79]
    v_max3_f32 v24, v24, v25, v46
    v_mov_b32 v25, v24
    v_mfma_f32_16x16x32_bf16 v[92:95], a[208:211], a[48:51], 0
    s_add_u32 m0, s45, 109056
    v_permlane16_swap_b32 v24, v25
    v_mfma_f32_16x16x32_bf16 v[92:95], a[212:215], a[52:55], v[92:95]
    buffer_load_dwordx4 v4, s[16:19], s46 offen offset:0 lds
    v_max_f32 v24, v24, v25
    v_mfma_f32_16x16x32_bf16 v[92:95], a[216:219], a[56:59], v[92:95]
    v_mov_b32 v25, v24
    v_max3_f32 v28, v76, v77, v78
    v_mfma_f32_16x16x32_bf16 v[92:95], a[220:223], a[60:63], v[92:95]
    v_permlane32_swap_b32 v24, v25
    v_max_f32 v25, v24, v25
    v_sub_f32 v24, 0, v25
    v_sub_f32 v26, 0, v25
    v_sub_f32 v27, 0, v25
    v_sub_f32 v25, 0, v25
    v_add_f32 v64, v16, v64
    v_add_f32 v65, v16, v65
    v_mfma_f32_16x16x32_bf16 v[104:107], a[64:67], a[32:35], v[24:27]
    v_max3_f32 v29, v79, v92, v93
    v_max3_f32 v28, v28, v94, v95
    v_mfma_f32_16x16x32_bf16 v[104:107], a[68:71], a[36:39], v[104:107]
    v_max3_f32 v28, v28, v29, v47
    v_mov_b32 v29, v28
    v_mfma_f32_16x16x32_bf16 v[104:107], a[72:75], a[40:43], v[104:107]
    s_nop 0
    v_permlane16_swap_b32 v28, v29
    v_max_f32 v28, v28, v29
    v_mfma_f32_16x16x32_bf16 v[104:107], a[76:79], a[44:47], v[104:107]
    v_mov_b32 v29, v28
    v_add_f32 v66, v16, v66
    v_mfma_f32_16x16x32_bf16 v[120:123], a[80:83], a[32:35], v[24:27]
    v_permlane32_swap_b32 v28, v29
    v_max_f32 v29, v28, v29
    v_mfma_f32_16x16x32_bf16 v[120:123], a[84:87], a[36:39], v[120:123]
    v_sub_f32 v28, 0, v29
    v_sub_f32 v30, 0, v29
    v_mfma_f32_16x16x32_bf16 v[120:123], a[88:91], a[40:43], v[120:123]
    v_sub_f32 v31, 0, v29
    v_sub_f32 v29, 0, v29
    v_mfma_f32_16x16x32_bf16 v[120:123], a[92:95], a[44:47], v[120:123]
    v_add_f32 v67, v16, v67
    v_add_f32 v80, v16, v80
    v_mfma_f32_16x16x32_bf16 v[108:111], a[64:67], a[48:51], v[28:31]
    v_add_f32 v81, v16, v81
    v_add_f32 v82, v16, v82
    v_mfma_f32_16x16x32_bf16 v[108:111], a[68:71], a[52:55], v[108:111]
    v_add_f32 v83, v16, v83
    v_add_f32 v68, v20, v68
    v_mfma_f32_16x16x32_bf16 v[108:111], a[72:75], a[56:59], v[108:111]
    v_exp_f32 v64, v64
    v_mfma_f32_16x16x32_bf16 v[108:111], a[76:79], a[60:63], v[108:111]
    v_exp_f32 v65, v65
    v_mfma_f32_16x16x32_bf16 v[124:127], a[80:83], a[48:51], v[28:31]
    v_exp_f32 v66, v66
    v_mfma_f32_16x16x32_bf16 v[124:127], a[84:87], a[52:55], v[124:127]
    v_exp_f32 v67, v67
    v_mfma_f32_16x16x32_bf16 v[124:127], a[88:91], a[56:59], v[124:127]
    v_exp_f32 v80, v80
    v_exp_f32 v81, v81
    v_exp_f32 v82, v82
    v_exp_f32 v83, v83
    v_mfma_f32_16x16x32_bf16 v[124:127], a[92:95], a[60:63], v[124:127]
    v_add_f32 v69, v20, v69
    v_add_f32 v70, v20, v70
    v_add_f32 v71, v20, v71
    v_add_f32 v84, v20, v84
    v_add_f32 v85, v20, v85
    v_add_f32 v86, v20, v86
    v_add_f32 v87, v20, v87
    v_cvt_pk_bf16_f32 v32, v64, v65
    v_cvt_pk_bf16_f32 v33, v66, v67
    v_cvt_pk_bf16_f32 v34, v80, v81
    v_cvt_pk_bf16_f32 v35, v82, v83
    v_exp_f32 v68, v68
    v_exp_f32 v69, v69
    v_exp_f32 v70, v70
    v_exp_f32 v71, v71
    v_exp_f32 v84, v84
    v_exp_f32 v85, v85
    v_exp_f32 v86, v86
    v_exp_f32 v87, v87
    v_mfma_f32_16x16x32_bf16 v[128:131], a[96:99], v[32:35], 0
    v_add_f32 v72, v24, v72
    v_add_f32 v73, v24, v73
    v_add_f32 v74, v24, v74
    v_add_f32 v75, v24, v75
    v_add_f32 v88, v24, v88
    v_add_f32 v89, v24, v89
    v_add_f32 v90, v24, v90
    v_add_f32 v91, v24, v91
    v_cvt_pk_bf16_f32 v36, v68, v69
    v_cvt_pk_bf16_f32 v37, v70, v71
    v_cvt_pk_bf16_f32 v38, v84, v85
    v_cvt_pk_bf16_f32 v39, v86, v87
    v_exp_f32 v72, v72
    v_exp_f32 v73, v73
    v_exp_f32 v74, v74
    v_exp_f32 v75, v75
    v_exp_f32 v88, v88
    v_exp_f32 v89, v89
    v_exp_f32 v90, v90
    v_exp_f32 v91, v91
    v_mfma_f32_16x16x32_bf16 v[132:135], a[96:99], v[36:39], 0
    v_add_f32 v76, v28, v76
    v_add_f32 v77, v28, v77
    v_add_f32 v78, v28, v78
    v_add_f32 v79, v28, v79
    v_add_f32 v92, v28, v92
    v_add_f32 v93, v28, v93
    v_add_f32 v94, v28, v94
    v_add_f32 v95, v28, v95
    v_cvt_pk_bf16_f32 v40, v72, v73
    v_cvt_pk_bf16_f32 v41, v74, v75
    v_cvt_pk_bf16_f32 v42, v88, v89
    v_cvt_pk_bf16_f32 v43, v90, v91
    v_exp_f32 v76, v76
    v_exp_f32 v77, v77
    v_exp_f32 v78, v78
    v_exp_f32 v79, v79
    v_exp_f32 v92, v92
    v_exp_f32 v93, v93
    v_exp_f32 v94, v94
    v_exp_f32 v95, v95
    v_mfma_f32_16x16x32_bf16 v[136:139], a[96:99], v[40:43], 0
    v_cvt_pk_bf16_f32 v44, v76, v77
    v_cvt_pk_bf16_f32 v45, v78, v79
    v_cvt_pk_bf16_f32 v46, v92, v93
    v_cvt_pk_bf16_f32 v47, v94, v95
    ds_read_b128 a[64:67], v7 offset:33536
    s_add_u32 m0, s45, 109856
    v_mfma_f32_16x16x32_bf16 v[140:143], a[96:99], v[44:47], 0
    ds_read_b128 a[68:71], v7 offset:33600
    s_xor_b32 s54, s54, 131072
    v_mfma_f32_16x16x32_bf16 v[144:147], a[100:103], v[32:35], 0
    ds_read_b128 a[72:75], v7 offset:33664
    s_xor_b32 s41, s32, 32768
    v_mfma_f32_16x16x32_bf16 v[148:151], a[100:103], v[36:39], 0
    buffer_load_dwordx4 v4, s[16:19], s46 offen offset:256 lds
    v_mfma_f32_16x16x32_bf16 v[152:155], a[100:103], v[40:43], 0
    ds_read_b128 a[76:79], v7 offset:33728
    s_add_u32 m0, s33, 142592
    v_mfma_f32_16x16x32_bf16 v[156:159], a[100:103], v[44:47], 0
    ds_read_b128 a[80:83], v7 offset:33792
    s_add_u32 s47, s46, 8192
    v_mfma_f32_16x16x32_bf16 v[160:163], a[104:107], v[32:35], 0
    ds_read_b128 a[84:87], v7 offset:33856
    s_add_u32 s46, s46, 16384
    v_mfma_f32_16x16x32_bf16 v[164:167], a[104:107], v[36:39], 0
    v_exp_f32 v96, v96
    v_mfma_f32_16x16x32_bf16 v[168:171], a[104:107], v[40:43], 0
    ds_read_b128 a[88:91], v7 offset:33920
    s_and_b32 s46, s46, 0x1ffff
    v_mfma_f32_16x16x32_bf16 v[172:175], a[104:107], v[44:47], 0
    ds_read_b128 a[92:95], v7 offset:33984
    v_add_u32 v9, 67072, v7
    v_mfma_f32_16x16x32_bf16 v[176:179], a[108:111], v[32:35], 0
    ds_read_b64_tr_b16 a[96:97], v8 offset:33536
    v_add_u32 v10, 67072, v8
    v_mfma_f32_16x16x32_bf16 v[180:183], a[108:111], v[36:39], 0
    ds_read_b64_tr_b16 a[98:99], v8 offset:34048
    ds_read_b64_tr_b16 a[100:101], v8 offset:33568
    v_mfma_f32_16x16x32_bf16 v[184:187], a[108:111], v[40:43], 0
    v_exp_f32 v97, v97
    v_mfma_f32_16x16x32_bf16 v[188:191], a[108:111], v[44:47], 0
    v_exp_f32 v98, v98
    v_mfma_f32_16x16x32_bf16 v[192:195], a[112:115], v[32:35], 0
    v_exp_f32 v99, v99
    v_mfma_f32_16x16x32_bf16 v[196:199], a[112:115], v[36:39], 0
    v_exp_f32 v112, v112
    v_mfma_f32_16x16x32_bf16 v[200:203], a[112:115], v[40:43], 0
    v_exp_f32 v113, v113
    v_mfma_f32_16x16x32_bf16 v[204:207], a[112:115], v[44:47], 0
    v_exp_f32 v114, v114
    v_mfma_f32_16x16x32_bf16 v[208:211], a[116:119], v[32:35], 0
    v_exp_f32 v115, v115
    v_mfma_f32_16x16x32_bf16 v[212:215], a[116:119], v[36:39], 0
    ds_read_b64_tr_b16 a[102:103], v8 offset:34080
    v_cvt_pk_bf16_f32 v48, v96, v97
    v_mfma_f32_16x16x32_bf16 v[216:219], a[116:119], v[40:43], 0
    v_cvt_pk_bf16_f32 v49, v98, v99
    v_cvt_pk_bf16_f32 v50, v112, v113
    v_mfma_f32_16x16x32_bf16 v[220:223], a[116:119], v[44:47], 0
    v_cvt_pk_bf16_f32 v51, v114, v115
    ds_read_b64_tr_b16 a[104:105], v8 offset:33600
    v_mfma_f32_16x16x32_bf16 v[224:227], a[120:123], v[32:35], 0
    v_exp_f32 v100, v100
    v_mfma_f32_16x16x32_bf16 v[228:231], a[120:123], v[36:39], 0
    v_exp_f32 v101, v101
    v_mfma_f32_16x16x32_bf16 v[232:235], a[120:123], v[40:43], 0
    v_exp_f32 v102, v102
    v_mfma_f32_16x16x32_bf16 v[236:239], a[120:123], v[44:47], 0
    v_exp_f32 v103, v103
    v_mfma_f32_16x16x32_bf16 v[240:243], a[124:127], v[32:35], 0
    v_exp_f32 v116, v116
    v_mfma_f32_16x16x32_bf16 v[244:247], a[124:127], v[36:39], 0
    v_exp_f32 v117, v117
    v_mfma_f32_16x16x32_bf16 v[248:251], a[124:127], v[40:43], 0
    v_exp_f32 v118, v118
    v_mfma_f32_16x16x32_bf16 v[252:255], a[124:127], v[44:47], 0
    v_exp_f32 v119, v119
    v_mfma_f32_16x16x32_bf16 a[240:243], v[12:15], v[32:35], 0
    v_cvt_pk_bf16_f32 v52, v100, v101
    v_cvt_pk_bf16_f32 v53, v102, v103
    v_mfma_f32_16x16x32_bf16 a[244:247], v[12:15], v[36:39], 0
    v_cvt_pk_bf16_f32 v54, v116, v117
    v_cvt_pk_bf16_f32 v55, v118, v119
    v_mfma_f32_16x16x32_bf16 a[248:251], v[12:15], v[40:43], 0
    v_exp_f32 v104, v104
    v_mfma_f32_16x16x32_bf16 a[252:255], v[12:15], v[44:47], 0
    v_exp_f32 v105, v105
    s_waitcnt lgkmcnt(0)
    v_mfma_f32_16x16x32_bf16 v[64:67], a[64:67], a[0:3], v[16:19]
    v_exp_f32 v106, v106
    v_mfma_f32_16x16x32_bf16 v[64:67], a[68:71], a[4:7], v[64:67]
    v_exp_f32 v107, v107
    v_mfma_f32_16x16x32_bf16 v[64:67], a[72:75], a[8:11], v[64:67]
    v_exp_f32 v120, v120
    v_mfma_f32_16x16x32_bf16 v[64:67], a[76:79], a[12:15], v[64:67]
    v_exp_f32 v121, v121
    v_mfma_f32_16x16x32_bf16 v[80:83], a[80:83], a[0:3], v[16:19]
    v_exp_f32 v122, v122
    v_mfma_f32_16x16x32_bf16 v[80:83], a[84:87], a[4:7], v[80:83]
    v_exp_f32 v123, v123
    v_mfma_f32_16x16x32_bf16 v[80:83], a[88:91], a[8:11], v[80:83]
    v_cvt_pk_bf16_f32 v56, v104, v105
    v_cvt_pk_bf16_f32 v57, v106, v107
    v_mfma_f32_16x16x32_bf16 v[80:83], a[92:95], a[12:15], v[80:83]
    v_cvt_pk_bf16_f32 v58, v120, v121
    v_cvt_pk_bf16_f32 v59, v122, v123
    v_mfma_f32_16x16x32_bf16 v[68:71], a[64:67], a[16:19], v[20:23]
    v_exp_f32 v108, v108
    v_mfma_f32_16x16x32_bf16 v[68:71], a[68:71], a[20:23], v[68:71]
    v_exp_f32 v109, v109
    v_mfma_f32_16x16x32_bf16 v[68:71], a[72:75], a[24:27], v[68:71]
    v_exp_f32 v110, v110
    v_mfma_f32_16x16x32_bf16 v[68:71], a[76:79], a[28:31], v[68:71]
    v_exp_f32 v111, v111
    v_mfma_f32_16x16x32_bf16 v[84:87], a[80:83], a[16:19], v[20:23]
    v_exp_f32 v124, v124
    v_mfma_f32_16x16x32_bf16 v[84:87], a[84:87], a[20:23], v[84:87]
    v_exp_f32 v125, v125
    v_mfma_f32_16x16x32_bf16 v[84:87], a[88:91], a[24:27], v[84:87]
    v_exp_f32 v126, v126
    v_mfma_f32_16x16x32_bf16 v[84:87], a[92:95], a[28:31], v[84:87]
    v_exp_f32 v127, v127
    v_mfma_f32_16x16x32_bf16 v[72:75], a[64:67], a[32:35], v[24:27]
    v_cvt_pk_bf16_f32 v60, v108, v109
    v_cvt_pk_bf16_f32 v61, v110, v111
    v_mfma_f32_16x16x32_bf16 v[72:75], a[68:71], a[36:39], v[72:75]
    v_cvt_pk_bf16_f32 v62, v124, v125
    v_cvt_pk_bf16_f32 v63, v126, v127
    v_mfma_f32_16x16x32_bf16 v[72:75], a[72:75], a[40:43], v[72:75]
    ds_read_b64_tr_b16 a[106:107], v8 offset:34112
    ds_read_b64_tr_b16 a[108:109], v8 offset:33632
    v_mfma_f32_16x16x32_bf16 v[72:75], a[76:79], a[44:47], v[72:75]
    ds_read_b64_tr_b16 a[110:111], v8 offset:34144
    v_mfma_f32_16x16x32_bf16 v[88:91], a[80:83], a[32:35], v[24:27]
    ds_read_b64_tr_b16 a[112:113], v8 offset:33664
    ds_read_b64_tr_b16 a[114:115], v8 offset:34176
    v_mfma_f32_16x16x32_bf16 v[88:91], a[84:87], a[36:39], v[88:91]
    ds_read_b64_tr_b16 a[116:117], v8 offset:33696
    v_mfma_f32_16x16x32_bf16 v[88:91], a[88:91], a[40:43], v[88:91]
    ds_read_b64_tr_b16 a[118:119], v8 offset:34208
    ds_read_b64_tr_b16 a[120:121], v8 offset:33728
    v_mfma_f32_16x16x32_bf16 v[88:91], a[92:95], a[44:47], v[88:91]
    ds_read_b64_tr_b16 a[122:123], v8 offset:34240
    v_mfma_f32_16x16x32_bf16 v[76:79], a[64:67], a[48:51], v[28:31]
    ds_read_b64_tr_b16 a[124:125], v8 offset:33760
    ds_read_b64_tr_b16 a[126:127], v8 offset:34272
    v_mfma_f32_16x16x32_bf16 v[76:79], a[68:71], a[52:55], v[76:79]
    ds_read_b128 a[64:67], v7 offset:34048
    v_mfma_f32_16x16x32_bf16 v[76:79], a[72:75], a[56:59], v[76:79]
    ds_read_b128 a[68:71], v7 offset:34112
    v_mfma_f32_16x16x32_bf16 v[76:79], a[76:79], a[60:63], v[76:79]
    buffer_load_dword v2, v1, s[8:11], s54 offen
    v_mfma_f32_16x16x32_bf16 v[92:95], a[80:83], a[48:51], v[28:31]
    ds_read_b128 a[72:75], v7 offset:34176
    s_xor_b32 s54, s54, 393216
    v_mfma_f32_16x16x32_bf16 v[92:95], a[84:87], a[52:55], v[92:95]
    ds_read_b128 a[76:79], v7 offset:34240
    v_mfma_f32_16x16x32_bf16 v[92:95], a[88:91], a[56:59], v[92:95]
    ds_read_b128 a[80:83], v7 offset:34304
    v_mfma_f32_16x16x32_bf16 v[92:95], a[92:95], a[60:63], v[92:95]
    v_exp_f32 v64, v64
    v_mfma_f32_16x16x32_bf16 v[128:131], a[96:99], v[48:51], v[128:131]
    ds_read_b128 a[84:87], v7 offset:34368
    v_mfma_f32_16x16x32_bf16 v[132:135], a[96:99], v[52:55], v[132:135]
    ds_read_b128 a[88:91], v7 offset:34432
    v_mfma_f32_16x16x32_bf16 v[136:139], a[96:99], v[56:59], v[136:139]
    ds_read_b128 a[92:95], v7 offset:34496
    v_mfma_f32_16x16x32_bf16 v[140:143], a[96:99], v[60:63], v[140:143]
    v_exp_f32 v65, v65
    v_mfma_f32_16x16x32_bf16 v[144:147], a[100:103], v[48:51], v[144:147]
    ds_read_b64_tr_b16 a[96:97], v8 offset:41984
    ds_read_b64_tr_b16 a[98:99], v8 offset:42496
    v_mfma_f32_16x16x32_bf16 v[148:151], a[100:103], v[52:55], v[148:151]
    v_exp_f32 v66, v66
    v_mfma_f32_16x16x32_bf16 v[152:155], a[100:103], v[56:59], v[152:155]
    v_exp_f32 v67, v67
    v_mfma_f32_16x16x32_bf16 v[156:159], a[100:103], v[60:63], v[156:159]
    ds_read_b64_tr_b16 a[100:101], v8 offset:42016
    ds_read_b64_tr_b16 a[102:103], v8 offset:42528
    s_waitcnt lgkmcnt(7)
    v_mfma_f32_16x16x32_bf16 v[160:163], a[104:107], v[48:51], v[160:163]
    v_exp_f32 v80, v80
    v_mfma_f32_16x16x32_bf16 v[164:167], a[104:107], v[52:55], v[164:167]
    v_exp_f32 v81, v81
    v_mfma_f32_16x16x32_bf16 v[168:171], a[104:107], v[56:59], v[168:171]
    v_exp_f32 v82, v82
    v_mfma_f32_16x16x32_bf16 v[172:175], a[104:107], v[60:63], v[172:175]
    ds_read_b64_tr_b16 a[104:105], v8 offset:42048
    ds_read_b64_tr_b16 a[106:107], v8 offset:42560
    v_mfma_f32_16x16x32_bf16 v[176:179], a[108:111], v[48:51], v[176:179]
    v_exp_f32 v83, v83
    v_mfma_f32_16x16x32_bf16 v[180:183], a[108:111], v[52:55], v[180:183]
    v_cvt_pk_bf16_f32 v32, v64, v65
    v_cvt_pk_bf16_f32 v33, v66, v67
    v_mfma_f32_16x16x32_bf16 v[184:187], a[108:111], v[56:59], v[184:187]
    v_cvt_pk_bf16_f32 v34, v80, v81
    v_cvt_pk_bf16_f32 v35, v82, v83
    v_mfma_f32_16x16x32_bf16 v[188:191], a[108:111], v[60:63], v[188:191]
    ds_read_b64_tr_b16 a[108:109], v8 offset:42080
    ds_read_b64_tr_b16 a[110:111], v8 offset:42592
    v_mfma_f32_16x16x32_bf16 v[192:195], a[112:115], v[48:51], v[192:195]
    v_exp_f32 v68, v68
    v_mfma_f32_16x16x32_bf16 v[196:199], a[112:115], v[52:55], v[196:199]
    v_exp_f32 v69, v69
    v_mfma_f32_16x16x32_bf16 v[200:203], a[112:115], v[56:59], v[200:203]
    v_exp_f32 v70, v70
    v_mfma_f32_16x16x32_bf16 v[204:207], a[112:115], v[60:63], v[204:207]
    ds_read_b64_tr_b16 a[112:113], v8 offset:42112
    ds_read_b64_tr_b16 a[114:115], v8 offset:42624
    v_mfma_f32_16x16x32_bf16 v[208:211], a[116:119], v[48:51], v[208:211]
    v_exp_f32 v71, v71
    v_mfma_f32_16x16x32_bf16 v[212:215], a[116:119], v[52:55], v[212:215]
    v_exp_f32 v84, v84
    v_mfma_f32_16x16x32_bf16 v[216:219], a[116:119], v[56:59], v[216:219]
    v_exp_f32 v85, v85
    v_mfma_f32_16x16x32_bf16 v[220:223], a[116:119], v[60:63], v[220:223]
    ds_read_b64_tr_b16 a[116:117], v8 offset:42144
    ds_read_b64_tr_b16 a[118:119], v8 offset:42656
    v_mfma_f32_16x16x32_bf16 v[224:227], a[120:123], v[48:51], v[224:227]
    v_exp_f32 v86, v86
    v_mfma_f32_16x16x32_bf16 v[228:231], a[120:123], v[52:55], v[228:231]
    v_exp_f32 v87, v87
    v_mfma_f32_16x16x32_bf16 v[232:235], a[120:123], v[56:59], v[232:235]
    v_cvt_pk_bf16_f32 v36, v68, v69
    v_cvt_pk_bf16_f32 v37, v70, v71
    v_mfma_f32_16x16x32_bf16 v[236:239], a[120:123], v[60:63], v[236:239]
    ds_read_b64_tr_b16 a[120:121], v8 offset:42176
    ds_read_b64_tr_b16 a[122:123], v8 offset:42688
    v_mfma_f32_16x16x32_bf16 v[240:243], a[124:127], v[48:51], v[240:243]
    v_cvt_pk_bf16_f32 v38, v84, v85
    v_cvt_pk_bf16_f32 v39, v86, v87
    v_mfma_f32_16x16x32_bf16 v[244:247], a[124:127], v[52:55], v[244:247]
    v_exp_f32 v72, v72
    v_mfma_f32_16x16x32_bf16 v[248:251], a[124:127], v[56:59], v[248:251]
    v_exp_f32 v73, v73
    v_mfma_f32_16x16x32_bf16 v[252:255], a[124:127], v[60:63], v[252:255]
    ds_read_b64_tr_b16 a[124:125], v8 offset:42208
    ds_read_b64_tr_b16 a[126:127], v8 offset:42720
    v_mfma_f32_16x16x32_bf16 a[240:243], v[12:15], v[48:51], a[240:243]
    v_exp_f32 v74, v74
    v_mfma_f32_16x16x32_bf16 a[244:247], v[12:15], v[52:55], a[244:247]
    v_exp_f32 v75, v75
    v_mfma_f32_16x16x32_bf16 a[248:251], v[12:15], v[56:59], a[248:251]
    v_exp_f32 v88, v88
    v_mfma_f32_16x16x32_bf16 a[252:255], v[12:15], v[60:63], a[252:255]
    v_exp_f32 v89, v89
    v_mfma_f32_16x16x32_bf16 v[96:99], a[64:67], a[0:3], v[16:19]
    v_exp_f32 v90, v90
    v_mfma_f32_16x16x32_bf16 v[96:99], a[68:71], a[4:7], v[96:99]
    v_exp_f32 v91, v91
    v_mfma_f32_16x16x32_bf16 v[96:99], a[72:75], a[8:11], v[96:99]
    v_cvt_pk_bf16_f32 v40, v72, v73
    v_cvt_pk_bf16_f32 v41, v74, v75
    v_mfma_f32_16x16x32_bf16 v[96:99], a[76:79], a[12:15], v[96:99]
    v_cvt_pk_bf16_f32 v42, v88, v89
    v_cvt_pk_bf16_f32 v43, v90, v91
    v_mfma_f32_16x16x32_bf16 v[112:115], a[80:83], a[0:3], v[16:19]
    s_waitcnt lgkmcnt(0)
    s_waitcnt vmcnt(9)
    s_barrier
    v_mfma_f32_16x16x32_bf16 v[112:115], a[84:87], a[4:7], v[112:115]
    ds_read_b64_tr_b16 a[128:129], v6 offset:41984
    ds_read_b64_tr_b16 a[130:131], v6 offset:42496
    v_mfma_f32_16x16x32_bf16 v[112:115], a[88:91], a[8:11], v[112:115]
    ds_read_b64_tr_b16 a[132:133], v6 offset:42016
    v_mfma_f32_16x16x32_bf16 v[112:115], a[92:95], a[12:15], v[112:115]
    ds_read_b64_tr_b16 a[134:135], v6 offset:42528
    ds_read_b64_tr_b16 a[136:137], v6 offset:42048
    v_mfma_f32_16x16x32_bf16 v[100:103], a[64:67], a[16:19], v[20:23]
    ds_read_b64_tr_b16 a[138:139], v6 offset:42560
    v_mfma_f32_16x16x32_bf16 v[100:103], a[68:71], a[20:23], v[100:103]
    ds_read_b64_tr_b16 a[140:141], v6 offset:42080
    ds_read_b64_tr_b16 a[142:143], v6 offset:42592
    v_mfma_f32_16x16x32_bf16 v[100:103], a[72:75], a[24:27], v[100:103]
    v_exp_f32 v76, v76
    v_mfma_f32_16x16x32_bf16 v[100:103], a[76:79], a[28:31], v[100:103]
    v_exp_f32 v77, v77
    v_mfma_f32_16x16x32_bf16 v[116:119], a[80:83], a[16:19], v[20:23]
    v_exp_f32 v78, v78
    v_mfma_f32_16x16x32_bf16 v[116:119], a[84:87], a[20:23], v[116:119]
    v_exp_f32 v79, v79
    v_mfma_f32_16x16x32_bf16 v[116:119], a[88:91], a[24:27], v[116:119]
    v_exp_f32 v92, v92
    v_mfma_f32_16x16x32_bf16 v[116:119], a[92:95], a[28:31], v[116:119]
    v_exp_f32 v93, v93
    v_mfma_f32_16x16x32_bf16 v[104:107], a[64:67], a[32:35], v[24:27]
    v_exp_f32 v94, v94
    v_mfma_f32_16x16x32_bf16 v[104:107], a[68:71], a[36:39], v[104:107]
    v_exp_f32 v95, v95
    v_mfma_f32_16x16x32_bf16 v[104:107], a[72:75], a[40:43], v[104:107]
    s_waitcnt lgkmcnt(0)
    buffer_load_dwordx4 v5, s[8:11], s41 offen offset:0 lds
    v_mfma_f32_16x16x32_bf16 v[104:107], a[76:79], a[44:47], v[104:107]
    s_add_u32 m0, s33, 142624
    v_cvt_pk_bf16_f32 v44, v76, v77
    v_mfma_f32_16x16x32_bf16 v[120:123], a[80:83], a[32:35], v[24:27]
    v_cvt_pk_bf16_f32 v45, v78, v79
    v_cvt_pk_bf16_f32 v46, v92, v93
    v_mfma_f32_16x16x32_bf16 v[120:123], a[84:87], a[36:39], v[120:123]
    v_cvt_pk_bf16_f32 v47, v94, v95
    v_mfma_f32_16x16x32_bf16 v[120:123], a[88:91], a[40:43], v[120:123]
    v_exp_f32 v96, v96
    v_mfma_f32_16x16x32_bf16 v[120:123], a[92:95], a[44:47], v[120:123]
    buffer_load_dwordx4 v5, s[8:11], s41 offen offset:1024 lds
    v_mfma_f32_16x16x32_bf16 v[108:111], a[64:67], a[48:51], v[28:31]
    s_add_u32 m0, s33, 142656
    ds_read_b128 a[64:67], v9 offset:0
    v_mfma_f32_16x16x32_bf16 v[108:111], a[68:71], a[52:55], v[108:111]
    ds_read_b128 a[68:71], v9 offset:64
    v_mfma_f32_16x16x32_bf16 v[108:111], a[72:75], a[56:59], v[108:111]
    v_exp_f32 v97, v97
    v_mfma_f32_16x16x32_bf16 v[108:111], a[76:79], a[60:63], v[108:111]
    ds_read_b128 a[72:75], v9 offset:128
    v_cvt_pk_bf16_f32 v48, v96, v97
    v_mfma_f32_16x16x32_bf16 v[124:127], a[80:83], a[48:51], v[28:31]
    buffer_load_dwordx4 v5, s[8:11], s41 offen offset:2048 lds
    v_mfma_f32_16x16x32_bf16 v[124:127], a[84:87], a[52:55], v[124:127]
    s_add_u32 m0, s33, 142688
    ds_read_b128 a[76:79], v9 offset:192
    v_mfma_f32_16x16x32_bf16 v[124:127], a[88:91], a[56:59], v[124:127]
    ds_read_b128 a[80:83], v9 offset:256
    v_mfma_f32_16x16x32_bf16 v[124:127], a[92:95], a[60:63], v[124:127]
    v_exp_f32 v98, v98
    v_mfma_f32_16x16x32_bf16 v[128:131], a[96:99], v[32:35], v[128:131]
    ds_read_b128 a[84:87], v9 offset:320
    v_mfma_f32_16x16x32_bf16 v[132:135], a[96:99], v[36:39], v[132:135]
    buffer_load_dwordx4 v5, s[8:11], s41 offen offset:3072 lds
    v_mfma_f32_16x16x32_bf16 v[136:139], a[96:99], v[40:43], v[136:139]
    s_add_u32 m0, s44, 0
    ds_read_b128 a[88:91], v9 offset:384
    v_mfma_f32_16x16x32_bf16 v[140:143], a[96:99], v[44:47], v[140:143]
    ds_read_b128 a[92:95], v9 offset:448
    s_xor_b32 s41, s32, 65536
    v_mfma_f32_16x16x32_bf16 v[144:147], a[100:103], v[32:35], v[144:147]
    v_exp_f32 v99, v99
    v_mfma_f32_16x16x32_bf16 v[148:151], a[100:103], v[36:39], v[148:151]
    ds_read_b64_tr_b16 a[96:97], v10 offset:0
    ds_read_b64_tr_b16 a[98:99], v10 offset:512
    v_mfma_f32_16x16x32_bf16 v[152:155], a[100:103], v[40:43], v[152:155]
    buffer_load_dwordx4 v3, s[12:15], s46 offen offset:0 lds
    v_mfma_f32_16x16x32_bf16 v[156:159], a[100:103], v[44:47], v[156:159]
    s_add_u32 m0, s44, 1824
    ds_read_b64_tr_b16 a[100:101], v10 offset:32
    v_mfma_f32_16x16x32_bf16 v[160:163], a[104:107], v[32:35], v[160:163]
    v_exp_f32 v112, v112
    v_mfma_f32_16x16x32_bf16 v[164:167], a[104:107], v[36:39], v[164:167]
    v_exp_f32 v113, v113
    v_mfma_f32_16x16x32_bf16 v[168:171], a[104:107], v[40:43], v[168:171]
    v_exp_f32 v114, v114
    v_mfma_f32_16x16x32_bf16 v[172:175], a[104:107], v[44:47], v[172:175]
    buffer_load_dwordx4 v3, s[12:15], s46 offen offset:256 lds
    v_mfma_f32_16x16x32_bf16 v[176:179], a[108:111], v[32:35], v[176:179]
    s_add_u32 m0, s44, 3648
    ds_read_b64_tr_b16 a[102:103], v10 offset:544
    v_mfma_f32_16x16x32_bf16 v[180:183], a[108:111], v[36:39], v[180:183]
    v_exp_f32 v115, v115
    v_mfma_f32_16x16x32_bf16 v[184:187], a[108:111], v[40:43], v[184:187]
    v_cvt_pk_bf16_f32 v49, v98, v99
    v_cvt_pk_bf16_f32 v50, v112, v113
    v_mfma_f32_16x16x32_bf16 v[188:191], a[108:111], v[44:47], v[188:191]
    v_cvt_pk_bf16_f32 v51, v114, v115
    ds_read_b64_tr_b16 a[104:105], v10 offset:64
    v_mfma_f32_16x16x32_bf16 v[192:195], a[112:115], v[32:35], v[192:195]
    buffer_load_dwordx4 v3, s[12:15], s46 offen offset:512 lds
    v_mfma_f32_16x16x32_bf16 v[196:199], a[112:115], v[36:39], v[196:199]
    s_add_u32 m0, s44, 5472
    ds_read_b64_tr_b16 a[106:107], v10 offset:576
    v_mfma_f32_16x16x32_bf16 v[200:203], a[112:115], v[40:43], v[200:203]
    v_exp_f32 v100, v100
    v_mfma_f32_16x16x32_bf16 v[204:207], a[112:115], v[44:47], v[204:207]
    v_exp_f32 v101, v101
    v_mfma_f32_16x16x32_bf16 v[208:211], a[116:119], v[32:35], v[208:211]
    v_exp_f32 v102, v102
    v_mfma_f32_16x16x32_bf16 v[212:215], a[116:119], v[36:39], v[212:215]
    buffer_load_dwordx4 v3, s[12:15], s46 offen offset:768 lds
    v_mfma_f32_16x16x32_bf16 v[216:219], a[116:119], v[40:43], v[216:219]
    s_add_u32 m0, s45, 0
    v_cvt_pk_bf16_f32 v52, v100, v101
    v_mfma_f32_16x16x32_bf16 v[220:223], a[116:119], v[44:47], v[220:223]
    v_exp_f32 v103, v103
    v_mfma_f32_16x16x32_bf16 v[224:227], a[120:123], v[32:35], v[224:227]
    v_exp_f32 v116, v116
    v_mfma_f32_16x16x32_bf16 v[228:231], a[120:123], v[36:39], v[228:231]
    v_exp_f32 v117, v117
    v_mfma_f32_16x16x32_bf16 v[232:235], a[120:123], v[40:43], v[232:235]
    buffer_load_dwordx4 v4, s[16:19], s47 offen offset:0 lds
    v_mfma_f32_16x16x32_bf16 v[236:239], a[120:123], v[44:47], v[236:239]
    s_add_u32 m0, s45, 800
    v_cvt_pk_bf16_f32 v53, v102, v103
    v_mfma_f32_16x16x32_bf16 v[240:243], a[124:127], v[32:35], v[240:243]
    v_exp_f32 v118, v118
    v_mfma_f32_16x16x32_bf16 v[244:247], a[124:127], v[36:39], v[244:247]
    v_exp_f32 v119, v119
    v_mfma_f32_16x16x32_bf16 v[248:251], a[124:127], v[40:43], v[248:251]
    v_cvt_pk_bf16_f32 v54, v116, v117
    v_cvt_pk_bf16_f32 v55, v118, v119
    v_mfma_f32_16x16x32_bf16 v[252:255], a[124:127], v[44:47], v[252:255]
    buffer_load_dwordx4 v4, s[16:19], s47 offen offset:256 lds
    v_mfma_f32_16x16x32_bf16 a[240:243], v[12:15], v[32:35], a[240:243]
    s_add_u32 m0, s45, 8448
    ds_read_b64_tr_b16 a[108:109], v10 offset:96
    v_mfma_f32_16x16x32_bf16 a[244:247], v[12:15], v[36:39], a[244:247]
    v_exp_f32 v104, v104
    v_mfma_f32_16x16x32_bf16 a[248:251], v[12:15], v[40:43], a[248:251]
    v_exp_f32 v105, v105
    v_mfma_f32_16x16x32_bf16 a[252:255], v[12:15], v[44:47], a[252:255]
    v_exp_f32 v106, v106
    s_waitcnt lgkmcnt(1)
    v_mfma_f32_16x16x32_bf16 v[64:67], a[64:67], a[0:3], v[16:19]
    buffer_load_dwordx4 v4, s[16:19], s46 offen offset:0 lds
    v_mfma_f32_16x16x32_bf16 v[64:67], a[68:71], a[4:7], v[64:67]
    s_add_u32 m0, s45, 9248
    v_cvt_pk_bf16_f32 v56, v104, v105
    v_mfma_f32_16x16x32_bf16 v[64:67], a[72:75], a[8:11], v[64:67]
    v_exp_f32 v107, v107
    v_mfma_f32_16x16x32_bf16 v[64:67], a[76:79], a[12:15], v[64:67]
    v_exp_f32 v120, v120
    v_mfma_f32_16x16x32_bf16 v[80:83], a[80:83], a[0:3], v[16:19]
    v_exp_f32 v121, v121
    v_mfma_f32_16x16x32_bf16 v[80:83], a[84:87], a[4:7], v[80:83]
    buffer_load_dwordx4 v4, s[16:19], s46 offen offset:256 lds
    v_mfma_f32_16x16x32_bf16 v[80:83], a[88:91], a[8:11], v[80:83]
    v_exp_f32 v122, v122
    v_mfma_f32_16x16x32_bf16 v[80:83], a[92:95], a[12:15], v[80:83]
    v_exp_f32 v123, v123
    v_mfma_f32_16x16x32_bf16 v[68:71], a[64:67], a[16:19], v[20:23]
    v_cvt_pk_bf16_f32 v57, v106, v107
    v_cvt_pk_bf16_f32 v58, v120, v121
    v_mfma_f32_16x16x32_bf16 v[68:71], a[68:71], a[20:23], v[68:71]
    v_cvt_pk_bf16_f32 v59, v122, v123
    ds_read_b64_tr_b16 a[110:111], v10 offset:608
    v_mfma_f32_16x16x32_bf16 v[68:71], a[72:75], a[24:27], v[68:71]
    v_exp_f32 v108, v108
    v_mfma_f32_16x16x32_bf16 v[68:71], a[76:79], a[28:31], v[68:71]
    v_exp_f32 v109, v109
    v_mfma_f32_16x16x32_bf16 v[84:87], a[80:83], a[16:19], v[20:23]
    v_exp_f32 v110, v110
    v_mfma_f32_16x16x32_bf16 v[84:87], a[84:87], a[20:23], v[84:87]
    v_exp_f32 v111, v111
    v_mfma_f32_16x16x32_bf16 v[84:87], a[88:91], a[24:27], v[84:87]
    v_exp_f32 v124, v124
    v_mfma_f32_16x16x32_bf16 v[84:87], a[92:95], a[28:31], v[84:87]
    v_exp_f32 v125, v125
    v_mfma_f32_16x16x32_bf16 v[72:75], a[64:67], a[32:35], v[24:27]
    v_exp_f32 v126, v126
    v_mfma_f32_16x16x32_bf16 v[72:75], a[68:71], a[36:39], v[72:75]
    v_exp_f32 v127, v127
    v_mfma_f32_16x16x32_bf16 v[72:75], a[72:75], a[40:43], v[72:75]
    v_cvt_pk_bf16_f32 v60, v108, v109
    v_cvt_pk_bf16_f32 v61, v110, v111
    v_mfma_f32_16x16x32_bf16 v[72:75], a[76:79], a[44:47], v[72:75]
    v_cvt_pk_bf16_f32 v62, v124, v125
    v_cvt_pk_bf16_f32 v63, v126, v127
    v_mfma_f32_16x16x32_bf16 v[88:91], a[80:83], a[32:35], v[24:27]
    ds_read_b64_tr_b16 a[112:113], v10 offset:128
    ds_read_b64_tr_b16 a[114:115], v10 offset:640
    v_mfma_f32_16x16x32_bf16 v[88:91], a[84:87], a[36:39], v[88:91]
    ds_read_b64_tr_b16 a[116:117], v10 offset:160
    s_add_u32 m0, s33, 142592
    v_mfma_f32_16x16x32_bf16 v[88:91], a[88:91], a[40:43], v[88:91]
    ds_read_b64_tr_b16 a[118:119], v10 offset:672
    ds_read_b64_tr_b16 a[120:121], v10 offset:192
    v_mfma_f32_16x16x32_bf16 v[88:91], a[92:95], a[44:47], v[88:91]
    ds_read_b64_tr_b16 a[122:123], v10 offset:704
    s_add_u32 s47, s46, 8192
    v_mfma_f32_16x16x32_bf16 v[76:79], a[64:67], a[48:51], v[28:31]
    ds_read_b64_tr_b16 a[124:125], v10 offset:224
    ds_read_b64_tr_b16 a[126:127], v10 offset:736
    v_mfma_f32_16x16x32_bf16 v[76:79], a[68:71], a[52:55], v[76:79]
    ds_read_b128 a[64:67], v9 offset:512
    s_add_u32 s46, s46, 16384
    v_mfma_f32_16x16x32_bf16 v[76:79], a[72:75], a[56:59], v[76:79]
    ds_read_b128 a[68:71], v9 offset:576
    s_and_b32 s46, s46, 0x1ffff
    v_mfma_f32_16x16x32_bf16 v[76:79], a[76:79], a[60:63], v[76:79]
    s_cmp_eq_u32 s2, 0
    s_cbranch_scc1 L_hk2
L_hk2b:
    v_mfma_f32_16x16x32_bf16 v[92:95], a[80:83], a[48:51], v[28:31]
    ds_read_b128 a[72:75], v9 offset:640
    v_mfma_f32_16x16x32_bf16 v[92:95], a[84:87], a[52:55], v[92:95]
    ds_read_b128 a[76:79], v9 offset:704
    v_mfma_f32_16x16x32_bf16 v[92:95], a[88:91], a[56:59], v[92:95]
    ds_read_b128 a[80:83], v9 offset:768
    v_mfma_f32_16x16x32_bf16 v[92:95], a[92:95], a[60:63], v[92:95]
    v_exp_f32 v64, v64
    v_mfma_f32_16x16x32_bf16 v[128:131], a[96:99], v[48:51], v[128:131]
    ds_read_b128 a[84:87], v9 offset:832
    v_mfma_f32_16x16x32_bf16 v[132:135], a[96:99], v[52:55], v[132:135]
    ds_read_b128 a[88:91], v9 offset:896
    v_mfma_f32_16x16x32_bf16 v[136:139], a[96:99], v[56:59], v[136:139]
    ds_read_b128 a[92:95], v9 offset:960
    v_mfma_f32_16x16x32_bf16 v[140:143], a[96:99], v[60:63], v[140:143]
    v_exp_f32 v65, v65
    v_mfma_f32_16x16x32_bf16 v[144:147], a[100:103], v[48:51], v[144:147]
    ds_read_b64_tr_b16 a[96:97], v10 offset:8448
    ds_read_b64_tr_b16 a[98:99], v10 offset:8960
    v_mfma_f32_16x16x32_bf16 v[148:151], a[100:103], v[52:55], v[148:151]
    v_exp_f32 v66, v66
    v_mfma_f32_16x16x32_bf16 v[152:155], a[100:103], v[56:59], v[152:155]
    v_exp_f32 v67, v67
    v_mfma_f32_16x16x32_bf16 v[156:159], a[100:103], v[60:63], v[156:159]
    ds_read_b64_tr_b16 a[100:101], v10 offset:8480
    ds_read_b64_tr_b16 a[102:103], v10 offset:8992
    v_mfma_f32_16x16x32_bf16 v[160:163], a[104:107], v[48:51], v[160:163]
    v_exp_f32 v80, v80
    v_mfma_f32_16x16x32_bf16 v[164:167], a[104:107], v[52:55], v[164:167]
    v_exp_f32 v81, v81
    v_mfma_f32_16x16x32_bf16 v[168:171], a[104:107], v[56:59], v[168:171]
    v_exp_f32 v82, v82
    v_mfma_f32_16x16x32_bf16 v[172:175], a[104:107], v[60:63], v[172:175]
    ds_read_b64_tr_b16 a[104:105], v10 offset:8512
    ds_read_b64_tr_b16 a[106:107], v10 offset:9024
    s_waitcnt lgkmcnt(6)
    v_mfma_f32_16x16x32_bf16 v[176:179], a[108:111], v[48:51], v[176:179]
    v_exp_f32 v83, v83
    v_mfma_f32_16x16x32_bf16 v[180:183], a[108:111], v[52:55], v[180:183]
    v_cvt_pk_bf16_f32 v32, v64, v65
    v_cvt_pk_bf16_f32 v33, v66, v67
    v_mfma_f32_16x16x32_bf16 v[184:187], a[108:111], v[56:59], v[184:187]
    v_cvt_pk_bf16_f32 v34, v80, v81
    v_cvt_pk_bf16_f32 v35, v82, v83
    v_mfma_f32_16x16x32_bf16 v[188:191], a[108:111], v[60:63], v[188:191]
    ds_read_b64_tr_b16 a[108:109], v10 offset:8544
    ds_read_b64_tr_b16 a[110:111], v10 offset:9056
    v_mfma_f32_16x16x32_bf16 v[192:195], a[112:115], v[48:51], v[192:195]
    v_exp_f32 v68, v68
    v_mfma_f32_16x16x32_bf16 v[196:199], a[112:115], v[52:55], v[196:199]
    v_exp_f32 v69, v69
    v_mfma_f32_16x16x32_bf16 v[200:203], a[112:115], v[56:59], v[200:203]
    v_exp_f32 v70, v70
    v_mfma_f32_16x16x32_bf16 v[204:207], a[112:115], v[60:63], v[204:207]
    ds_read_b64_tr_b16 a[112:113], v10 offset:8576
    ds_read_b64_tr_b16 a[114:115], v10 offset:9088
    v_mfma_f32_16x16x32_bf16 v[208:211], a[116:119], v[48:51], v[208:211]
    v_exp_f32 v71, v71
    v_mfma_f32_16x16x32_bf16 v[212:215], a[116:119], v[52:55], v[212:215]
    v_exp_f32 v84, v84
    v_mfma_f32_16x16x32_bf16 v[216:219], a[116:119], v[56:59], v[216:219]
    v_exp_f32 v85, v85
    v_mfma_f32_16x16x32_bf16 v[220:223], a[116:119], v[60:63], v[220:223]
    ds_read_b64_tr_b16 a[116:117], v10 offset:8608
    ds_read_b64_tr_b16 a[118:119], v10 offset:9120
    v_mfma_f32_16x16x32_bf16 v[224:227], a[120:123], v[48:51], v[224:227]
    v_exp_f32 v86, v86
    v_mfma_f32_16x16x32_bf16 v[228:231], a[120:123], v[52:55], v[228:231]
    v_exp_f32 v87, v87
    v_mfma_f32_16x16x32_bf16 v[232:235], a[120:123], v[56:59], v[232:235]
    v_cvt_pk_bf16_f32 v36, v68, v69
    v_cvt_pk_bf16_f32 v37, v70, v71
    v_mfma_f32_16x16x32_bf16 v[236:239], a[120:123], v[60:63], v[236:239]
    ds_read_b64_tr_b16 a[120:121], v10 offset:8640
    ds_read_b64_tr_b16 a[122:123], v10 offset:9152
    v_mfma_f32_16x16x32_bf16 v[240:243], a[124:127], v[48:51], v[240:243]
    v_cvt_pk_bf16_f32 v38, v84, v85
    v_cvt_pk_bf16_f32 v39, v86, v87
    v_mfma_f32_16x16x32_bf16 v[244:247], a[124:127], v[52:55], v[244:247]
    v_exp_f32 v72, v72
    v_mfma_f32_16x16x32_bf16 v[248:251], a[124:127], v[56:59], v[248:251]
    v_exp_f32 v73, v73
    v_mfma_f32_16x16x32_bf16 v[252:255], a[124:127], v[60:63], v[252:255]
    ds_read_b64_tr_b16 a[124:125], v10 offset:8672
    ds_read_b64_tr_b16 a[126:127], v10 offset:9184
    v_mfma_f32_16x16x32_bf16 a[240:243], v[12:15], v[48:51], a[240:243]
    v_exp_f32 v74, v74
    v_mfma_f32_16x16x32_bf16 a[244:247], v[12:15], v[52:55], a[244:247]
    v_exp_f32 v75, v75
    v_mfma_f32_16x16x32_bf16 a[248:251], v[12:15], v[56:59], a[248:251]
    v_exp_f32 v88, v88
    v_mfma_f32_16x16x32_bf16 a[252:255], v[12:15], v[60:63], a[252:255]
    v_exp_f32 v89, v89
    v_mfma_f32_16x16x32_bf16 v[96:99], a[64:67], a[0:3], v[16:19]
    v_exp_f32 v90, v90
    v_mfma_f32_16x16x32_bf16 v[96:99], a[68:71], a[4:7], v[96:99]
    v_exp_f32 v91, v91
    v_mfma_f32_16x16x32_bf16 v[96:99], a[72:75], a[8:11], v[96:99]
    v_cvt_pk_bf16_f32 v40, v72, v73
    v_cvt_pk_bf16_f32 v41, v74, v75
    v_mfma_f32_16x16x32_bf16 v[96:99], a[76:79], a[12:15], v[96:99]
    v_cvt_pk_bf16_f32 v42, v88, v89
    v_cvt_pk_bf16_f32 v43, v90, v91
    v_mfma_f32_16x16x32_bf16 v[112:115], a[80:83], a[0:3], v[16:19]
    s_waitcnt lgkmcnt(0)
    s_waitcnt vmcnt(8)
    s_barrier
    v_mfma_f32_16x16x32_bf16 v[112:115], a[84:87], a[4:7], v[112:115]
    ds_read_b64_tr_b16 a[144:145], v6 offset:41984
    ds_read_b64_tr_b16 a[146:147], v6 offset:42496
    v_mfma_f32_16x16x32_bf16 v[112:115], a[88:91], a[8:11], v[112:115]
    ds_read_b64_tr_b16 a[148:149], v6 offset:42016
    v_mfma_f32_16x16x32_bf16 v[112:115], a[92:95], a[12:15], v[112:115]
    ds_read_b64_tr_b16 a[150:151], v6 offset:42528
    ds_read_b64_tr_b16 a[152:153], v6 offset:42048
    v_mfma_f32_16x16x32_bf16 v[100:103], a[64:67], a[16:19], v[20:23]
    ds_read_b64_tr_b16 a[154:155], v6 offset:42560
    v_mfma_f32_16x16x32_bf16 v[100:103], a[68:71], a[20:23], v[100:103]
    ds_read_b64_tr_b16 a[156:157], v6 offset:42080
    ds_read_b64_tr_b16 a[158:159], v6 offset:42592
    v_mfma_f32_16x16x32_bf16 v[100:103], a[72:75], a[24:27], v[100:103]
    v_exp_f32 v76, v76
    v_mfma_f32_16x16x32_bf16 v[100:103], a[76:79], a[28:31], v[100:103]
    v_exp_f32 v77, v77
    v_mfma_f32_16x16x32_bf16 v[116:119], a[80:83], a[16:19], v[20:23]
    v_exp_f32 v78, v78
    v_mfma_f32_16x16x32_bf16 v[116:119], a[84:87], a[20:23], v[116:119]
    v_exp_f32 v79, v79
    v_mfma_f32_16x16x32_bf16 v[116:119], a[88:91], a[24:27], v[116:119]
    v_exp_f32 v92, v92
    v_mfma_f32_16x16x32_bf16 v[116:119], a[92:95], a[28:31], v[116:119]
    v_exp_f32 v93, v93
    v_mfma_f32_16x16x32_bf16 v[104:107], a[64:67], a[32:35], v[24:27]
    v_exp_f32 v94, v94
    v_mfma_f32_16x16x32_bf16 v[104:107], a[68:71], a[36:39], v[104:107]
    v_exp_f32 v95, v95
    v_mfma_f32_16x16x32_bf16 v[104:107], a[72:75], a[40:43], v[104:107]
    s_waitcnt lgkmcnt(0)
    buffer_load_dwordx4 v5, s[8:11], s41 offen offset:0 lds
    v_mfma_f32_16x16x32_bf16 v[104:107], a[76:79], a[44:47], v[104:107]
    s_add_u32 m0, s33, 142624
    v_cvt_pk_bf16_f32 v44, v76, v77
    v_mfma_f32_16x16x32_bf16 v[120:123], a[80:83], a[32:35], v[24:27]
    v_cvt_pk_bf16_f32 v45, v78, v79
    v_cvt_pk_bf16_f32 v46, v92, v93
    v_mfma_f32_16x16x32_bf16 v[120:123], a[84:87], a[36:39], v[120:123]
    v_cvt_pk_bf16_f32 v47, v94, v95
    v_mfma_f32_16x16x32_bf16 v[120:123], a[88:91], a[40:43], v[120:123]
    v_exp_f32 v96, v96
    v_mfma_f32_16x16x32_bf16 v[120:123], a[92:95], a[44:47], v[120:123]
    buffer_load_dwordx4 v5, s[8:11], s41 offen offset:1024 lds
    v_mfma_f32_16x16x32_bf16 v[108:111], a[64:67], a[48:51], v[28:31]
    s_add_u32 m0, s33, 142656
    ds_read_b128 a[64:67], v9 offset:33536
    v_mfma_f32_16x16x32_bf16 v[108:111], a[68:71], a[52:55], v[108:111]
    ds_read_b128 a[68:71], v9 offset:33600
    v_mfma_f32_16x16x32_bf16 v[108:111], a[72:75], a[56:59], v[108:111]
    v_exp_f32 v97, v97
    v_mfma_f32_16x16x32_bf16 v[108:111], a[76:79], a[60:63], v[108:111]
    ds_read_b128 a[72:75], v9 offset:33664
    v_cvt_pk_bf16_f32 v48, v96, v97
    v_mfma_f32_16x16x32_bf16 v[124:127], a[80:83], a[48:51], v[28:31]
    buffer_load_dwordx4 v5, s[8:11], s41 offen offset:2048 lds
    v_mfma_f32_16x16x32_bf16 v[124:127], a[84:87], a[52:55], v[124:127]
    s_add_u32 m0, s33, 142688
    ds_read_b128 a[76:79], v9 offset:33728
    v_mfma_f32_16x16x32_bf16 v[124:127], a[88:91], a[56:59], v[124:127]
    ds_read_b128 a[80:83], v9 offset:33792
    v_mfma_f32_16x16x32_bf16 v[124:127], a[92:95], a[60:63], v[124:127]
    v_exp_f32 v98, v98
    v_mfma_f32_16x16x32_bf16 v[128:131], a[96:99], v[32:35], v[128:131]
    ds_read_b128 a[84:87], v9 offset:33856
    v_mfma_f32_16x16x32_bf16 v[132:135], a[96:99], v[36:39], v[132:135]
    buffer_load_dwordx4 v5, s[8:11], s41 offen offset:3072 lds
    v_mfma_f32_16x16x32_bf16 v[136:139], a[96:99], v[40:43], v[136:139]
    s_add_u32 m0, s44, 33536
    ds_read_b128 a[88:91], v9 offset:33920
    v_mfma_f32_16x16x32_bf16 v[140:143], a[96:99], v[44:47], v[140:143]
    ds_read_b128 a[92:95], v9 offset:33984
    s_xor_b32 s41, s32, 98304
    v_mfma_f32_16x16x32_bf16 v[144:147], a[100:103], v[32:35], v[144:147]
    v_exp_f32 v99, v99
    v_mfma_f32_16x16x32_bf16 v[148:151], a[100:103], v[36:39], v[148:151]
    ds_read_b64_tr_b16 a[96:97], v10 offset:33536
    ds_read_b64_tr_b16 a[98:99], v10 offset:34048
    v_mfma_f32_16x16x32_bf16 v[152:155], a[100:103], v[40:43], v[152:155]
    buffer_load_dwordx4 v3, s[12:15], s46 offen offset:0 lds
    v_mfma_f32_16x16x32_bf16 v[156:159], a[100:103], v[44:47], v[156:159]
    s_add_u32 m0, s44, 35360
    ds_read_b64_tr_b16 a[100:101], v10 offset:33568
    v_mfma_f32_16x16x32_bf16 v[160:163], a[104:107], v[32:35], v[160:163]
    v_exp_f32 v112, v112
    v_mfma_f32_16x16x32_bf16 v[164:167], a[104:107], v[36:39], v[164:167]
    v_exp_f32 v113, v113
    v_mfma_f32_16x16x32_bf16 v[168:171], a[104:107], v[40:43], v[168:171]
    v_exp_f32 v114, v114
    v_mfma_f32_16x16x32_bf16 v[172:175], a[104:107], v[44:47], v[172:175]
    buffer_load_dwordx4 v3, s[12:15], s46 offen offset:256 lds
    v_mfma_f32_16x16x32_bf16 v[176:179], a[108:111], v[32:35], v[176:179]
    s_add_u32 m0, s44, 37184
    ds_read_b64_tr_b16 a[102:103], v10 offset:34080
    v_mfma_f32_16x16x32_bf16 v[180:183], a[108:111], v[36:39], v[180:183]
    v_exp_f32 v115, v115
    v_mfma_f32_16x16x32_bf16 v[184:187], a[108:111], v[40:43], v[184:187]
    v_cvt_pk_bf16_f32 v49, v98, v99
    v_cvt_pk_bf16_f32 v50, v112, v113
    v_mfma_f32_16x16x32_bf16 v[188:191], a[108:111], v[44:47], v[188:191]
    v_cvt_pk_bf16_f32 v51, v114, v115
    ds_read_b64_tr_b16 a[104:105], v10 offset:33600
    v_mfma_f32_16x16x32_bf16 v[192:195], a[112:115], v[32:35], v[192:195]
    buffer_load_dwordx4 v3, s[12:15], s46 offen offset:512 lds
    v_mfma_f32_16x16x32_bf16 v[196:199], a[112:115], v[36:39], v[196:199]
    s_add_u32 m0, s44, 39008
    ds_read_b64_tr_b16 a[106:107], v10 offset:34112
    v_mfma_f32_16x16x32_bf16 v[200:203], a[112:115], v[40:43], v[200:203]
    v_exp_f32 v100, v100
    v_mfma_f32_16x16x32_bf16 v[204:207], a[112:115], v[44:47], v[204:207]
    v_exp_f32 v101, v101
    v_mfma_f32_16x16x32_bf16 v[208:211], a[116:119], v[32:35], v[208:211]
    v_exp_f32 v102, v102
    v_mfma_f32_16x16x32_bf16 v[212:215], a[116:119], v[36:39], v[212:215]
    buffer_load_dwordx4 v3, s[12:15], s46 offen offset:768 lds
    v_mfma_f32_16x16x32_bf16 v[216:219], a[116:119], v[40:43], v[216:219]
    s_add_u32 m0, s45, 33536
    v_cvt_pk_bf16_f32 v52, v100, v101
    v_mfma_f32_16x16x32_bf16 v[220:223], a[116:119], v[44:47], v[220:223]
    v_exp_f32 v103, v103
    v_mfma_f32_16x16x32_bf16 v[224:227], a[120:123], v[32:35], v[224:227]
    v_exp_f32 v116, v116
    v_mfma_f32_16x16x32_bf16 v[228:231], a[120:123], v[36:39], v[228:231]
    v_exp_f32 v117, v117
    v_mfma_f32_16x16x32_bf16 v[232:235], a[120:123], v[40:43], v[232:235]
    buffer_load_dwordx4 v4, s[16:19], s47 offen offset:0 lds
    v_mfma_f32_16x16x32_bf16 v[236:239], a[120:123], v[44:47], v[236:239]
    s_add_u32 m0, s45, 34336
    v_cvt_pk_bf16_f32 v53, v102, v103
    v_mfma_f32_16x16x32_bf16 v[240:243], a[124:127], v[32:35], v[240:243]
    v_exp_f32 v118, v118
    v_mfma_f32_16x16x32_bf16 v[244:247], a[124:127], v[36:39], v[244:247]
    v_exp_f32 v119, v119
    v_mfma_f32_16x16x32_bf16 v[248:251], a[124:127], v[40:43], v[248:251]
    v_cvt_pk_bf16_f32 v54, v116, v117
    v_cvt_pk_bf16_f32 v55, v118, v119
    v_mfma_f32_16x16x32_bf16 v[252:255], a[124:127], v[44:47], v[252:255]
    buffer_load_dwordx4 v4, s[16:19], s47 offen offset:256 lds
    v_mfma_f32_16x16x32_bf16 a[240:243], v[12:15], v[32:35], a[240:243]
    s_add_u32 m0, s45, 41984
    ds_read_b64_tr_b16 a[108:109], v10 offset:33632
    v_mfma_f32_16x16x32_bf16 a[244:247], v[12:15], v[36:39], a[244:247]
    v_exp_f32 v104, v104
    v_mfma_f32_16x16x32_bf16 a[248:251], v[12:15], v[40:43], a[248:251]
    v_exp_f32 v105, v105
    v_mfma_f32_16x16x32_bf16 a[252:255], v[12:15], v[44:47], a[252:255]
    v_exp_f32 v106, v106
    s_waitcnt lgkmcnt(1)
    v_mfma_f32_16x16x32_bf16 v[64:67], a[64:67], a[0:3], v[16:19]
    buffer_load_dwordx4 v4, s[16:19], s46 offen offset:0 lds
    v_mfma_f32_16x16x32_bf16 v[64:67], a[68:71], a[4:7], v[64:67]
    s_add_u32 m0, s45, 42784
    v_cvt_pk_bf16_f32 v56, v104, v105
    v_mfma_f32_16x16x32_bf16 v[64:67], a[72:75], a[8:11], v[64:67]
    v_exp_f32 v107, v107
    v_mfma_f32_16x16x32_bf16 v[64:67], a[76:79], a[12:15], v[64:67]
    v_exp_f32 v120, v120
    v_mfma_f32_16x16x32_bf16 v[80:83], a[80:83], a[0:3], v[16:19]
    v_exp_f32 v121, v121
    v_mfma_f32_16x16x32_bf16 v[80:83], a[84:87], a[4:7], v[80:83]
    buffer_load_dwordx4 v4, s[16:19], s46 offen offset:256 lds
    v_mfma_f32_16x16x32_bf16 v[80:83], a[88:91], a[8:11], v[80:83]
    v_exp_f32 v122, v122
    v_mfma_f32_16x16x32_bf16 v[80:83], a[92:95], a[12:15], v[80:83]
    v_exp_f32 v123, v123
    v_mfma_f32_16x16x32_bf16 v[68:71], a[64:67], a[16:19], v[20:23]
    v_cvt_pk_bf16_f32 v57, v106, v107
    v_cvt_pk_bf16_f32 v58, v120, v121
    v_mfma_f32_16x16x32_bf16 v[68:71], a[68:71], a[20:23], v[68:71]
    v_cvt_pk_bf16_f32 v59, v122, v123
    ds_read_b64_tr_b16 a[110:111], v10 offset:34144
    v_mfma_f32_16x16x32_bf16 v[68:71], a[72:75], a[24:27], v[68:71]
    v_exp_f32 v108, v108
    v_mfma_f32_16x16x32_bf16 v[68:71], a[76:79], a[28:31], v[68:71]
    v_exp_f32 v109, v109
    v_mfma_f32_16x16x32_bf16 v[84:87], a[80:83], a[16:19], v[20:23]
    v_exp_f32 v110, v110
    v_mfma_f32_16x16x32_bf16 v[84:87], a[84:87], a[20:23], v[84:87]
    v_exp_f32 v111, v111
    v_mfma_f32_16x16x32_bf16 v[84:87], a[88:91], a[24:27], v[84:87]
    v_exp_f32 v124, v124
    v_mfma_f32_16x16x32_bf16 v[84:87], a[92:95], a[28:31], v[84:87]
    v_exp_f32 v125, v125
    v_mfma_f32_16x16x32_bf16 v[72:75], a[64:67], a[32:35], v[24:27]
    v_exp_f32 v126, v126
    v_mfma_f32_16x16x32_bf16 v[72:75], a[68:71], a[36:39], v[72:75]
    v_exp_f32 v127, v127
    v_mfma_f32_16x16x32_bf16 v[72:75], a[72:75], a[40:43], v[72:75]
    v_cvt_pk_bf16_f32 v60, v108, v109
    v_cvt_pk_bf16_f32 v61, v110, v111
    v_mfma_f32_16x16x32_bf16 v[72:75], a[76:79], a[44:47], v[72:75]
    v_cvt_pk_bf16_f32 v62, v124, v125
    v_cvt_pk_bf16_f32 v63, v126, v127
    v_mfma_f32_16x16x32_bf16 v[88:91], a[80:83], a[32:35], v[24:27]
    ds_read_b64_tr_b16 a[112:113], v10 offset:33664
    ds_read_b64_tr_b16 a[114:115], v10 offset:34176
    v_mfma_f32_16x16x32_bf16 v[88:91], a[84:87], a[36:39], v[88:91]
    ds_read_b64_tr_b16 a[116:117], v10 offset:33696
    s_add_u32 m0, s33, 142592
    v_mfma_f32_16x16x32_bf16 v[88:91], a[88:91], a[40:43], v[88:91]
    ds_read_b64_tr_b16 a[118:119], v10 offset:34208
    ds_read_b64_tr_b16 a[120:121], v10 offset:33728
    v_mfma_f32_16x16x32_bf16 v[88:91], a[92:95], a[44:47], v[88:91]
    ds_read_b64_tr_b16 a[122:123], v10 offset:34240
    s_add_u32 s47, s46, 8192
    v_mfma_f32_16x16x32_bf16 v[76:79], a[64:67], a[48:51], v[28:31]
    ds_read_b64_tr_b16 a[124:125], v10 offset:33760
    ds_read_b64_tr_b16 a[126:127], v10 offset:34272
    v_mfma_f32_16x16x32_bf16 v[76:79], a[68:71], a[52:55], v[76:79]
    ds_read_b128 a[64:67], v9 offset:34048
    s_add_u32 s46, s46, 16384
    v_mfma_f32_16x16x32_bf16 v[76:79], a[72:75], a[56:59], v[76:79]
    ds_read_b128 a[68:71], v9 offset:34112
    s_and_b32 s46, s46, 0x1ffff
    v_mfma_f32_16x16x32_bf16 v[76:79], a[76:79], a[60:63], v[76:79]
    buffer_load_dword v2, v1, s[8:11], s54 offen
    v_mfma_f32_16x16x32_bf16 v[92:95], a[80:83], a[48:51], v[28:31]
    ds_read_b128 a[72:75], v9 offset:34176
    s_xor_b32 s54, s54, 131072
    v_mfma_f32_16x16x32_bf16 v[92:95], a[84:87], a[52:55], v[92:95]
    ds_read_b128 a[76:79], v9 offset:34240
    v_mfma_f32_16x16x32_bf16 v[92:95], a[88:91], a[56:59], v[92:95]
    ds_read_b128 a[80:83], v9 offset:34304
    v_mfma_f32_16x16x32_bf16 v[92:95], a[92:95], a[60:63], v[92:95]
    s_cmp_eq_u32 s2, 0
    s_cbranch_scc1 L_hk3
L_hk3b:
    v_mfma_f32_16x16x32_bf16 v[128:131], a[96:99], v[48:51], v[128:131]
    ds_read_b128 a[84:87], v9 offset:34368
    v_mfma_f32_16x16x32_bf16 v[132:135], a[96:99], v[52:55], v[132:135]
    ds_read_b128 a[88:91], v9 offset:34432
    v_mfma_f32_16x16x32_bf16 v[136:139], a[96:99], v[56:59], v[136:139]
    ds_read_b128 a[92:95], v9 offset:34496
    v_mfma_f32_16x16x32_bf16 v[140:143], a[96:99], v[60:63], v[140:143]
    v_exp_f32 v64, v64
    v_mfma_f32_16x16x32_bf16 v[144:147], a[100:103], v[48:51], v[144:147]
    ds_read_b64_tr_b16 a[96:97], v10 offset:41984
    ds_read_b64_tr_b16 a[98:99], v10 offset:42496
    v_mfma_f32_16x16x32_bf16 v[148:151], a[100:103], v[52:55], v[148:151]
    v_exp_f32 v65, v65
    v_mfma_f32_16x16x32_bf16 v[152:155], a[100:103], v[56:59], v[152:155]
    v_exp_f32 v66, v66
    v_mfma_f32_16x16x32_bf16 v[156:159], a[100:103], v[60:63], v[156:159]
    ds_read_b64_tr_b16 a[100:101], v10 offset:42016
    ds_read_b64_tr_b16 a[102:103], v10 offset:42528
    v_mfma_f32_16x16x32_bf16 v[160:163], a[104:107], v[48:51], v[160:163]
    v_exp_f32 v67, v67
    v_mfma_f32_16x16x32_bf16 v[164:167], a[104:107], v[52:55], v[164:167]
    v_exp_f32 v80, v80
    v_mfma_f32_16x16x32_bf16 v[168:171], a[104:107], v[56:59], v[168:171]
    v_exp_f32 v81, v81
    v_mfma_f32_16x16x32_bf16 v[172:175], a[104:107], v[60:63], v[172:175]
    ds_read_b64_tr_b16 a[104:105], v10 offset:42048
    ds_read_b64_tr_b16 a[106:107], v10 offset:42560
    s_waitcnt lgkmcnt(6)
    v_mfma_f32_16x16x32_bf16 v[176:179], a[108:111], v[48:51], v[176:179]
    v_exp_f32 v82, v82
    v_mfma_f32_16x16x32_bf16 v[180:183], a[108:111], v[52:55], v[180:183]
    v_exp_f32 v83, v83
    v_mfma_f32_16x16x32_bf16 v[184:187], a[108:111], v[56:59], v[184:187]
    v_cvt_pk_bf16_f32 v32, v64, v65
    v_cvt_pk_bf16_f32 v33, v66, v67
    v_mfma_f32_16x16x32_bf16 v[188:191], a[108:111], v[60:63], v[188:191]
    ds_read_b64_tr_b16 a[108:109], v10 offset:42080
    ds_read_b64_tr_b16 a[110:111], v10 offset:42592
    v_mfma_f32_16x16x32_bf16 v[192:195], a[112:115], v[48:51], v[192:195]
    v_cvt_pk_bf16_f32 v34, v80, v81
    v_cvt_pk_bf16_f32 v35, v82, v83
    v_mfma_f32_16x16x32_bf16 v[196:199], a[112:115], v[52:55], v[196:199]
    v_exp_f32 v68, v68
    v_mfma_f32_16x16x32_bf16 v[200:203], a[112:115], v[56:59], v[200:203]
    v_exp_f32 v69, v69
    v_mfma_f32_16x16x32_bf16 v[204:207], a[112:115], v[60:63], v[204:207]
    ds_read_b64_tr_b16 a[112:113], v10 offset:42112
    ds_read_b64_tr_b16 a[114:115], v10 offset:42624
    v_mfma_f32_16x16x32_bf16 v[208:211], a[116:119], v[48:51], v[208:211]
    v_exp_f32 v70, v70
    v_mfma_f32_16x16x32_bf16 v[212:215], a[116:119], v[52:55], v[212:215]
    v_exp_f32 v71, v71
    v_mfma_f32_16x16x32_bf16 v[216:219], a[116:119], v[56:59], v[216:219]
    v_exp_f32 v84, v84
    v_mfma_f32_16x16x32_bf16 v[220:223], a[116:119], v[60:63], v[220:223]
    ds_read_b64_tr_b16 a[116:117], v10 offset:42144
    ds_read_b64_tr_b16 a[118:119], v10 offset:42656
    v_mfma_f32_16x16x32_bf16 v[224:227], a[120:123], v[48:51], v[224:227]
    v_exp_f32 v85, v85
    v_mfma_f32_16x16x32_bf16 v[228:231], a[120:123], v[52:55], v[228:231]
    v_exp_f32 v86, v86
    v_mfma_f32_16x16x32_bf16 v[232:235], a[120:123], v[56:59], v[232:235]
    v_exp_f32 v87, v87
    v_mfma_f32_16x16x32_bf16 v[236:239], a[120:123], v[60:63], v[236:239]
    ds_read_b64_tr_b16 a[120:121], v10 offset:42176
    ds_read_b64_tr_b16 a[122:123], v10 offset:42688
    v_mfma_f32_16x16x32_bf16 v[240:243], a[124:127], v[48:51], v[240:243]
    v_cvt_pk_bf16_f32 v36, v68, v69
    v_cvt_pk_bf16_f32 v37, v70, v71
    v_mfma_f32_16x16x32_bf16 v[244:247], a[124:127], v[52:55], v[244:247]
    v_cvt_pk_bf16_f32 v38, v84, v85
    v_cvt_pk_bf16_f32 v39, v86, v87
    v_mfma_f32_16x16x32_bf16 v[248:251], a[124:127], v[56:59], v[248:251]
    v_exp_f32 v72, v72
    v_mfma_f32_16x16x32_bf16 v[252:255], a[124:127], v[60:63], v[252:255]
    ds_read_b64_tr_b16 a[124:125], v10 offset:42208
    ds_read_b64_tr_b16 a[126:127], v10 offset:42720
    v_mfma_f32_16x16x32_bf16 a[240:243], v[12:15], v[48:51], a[240:243]
    v_exp_f32 v73, v73
    v_mfma_f32_16x16x32_bf16 a[244:247], v[12:15], v[52:55], a[244:247]
    v_exp_f32 v74, v74
    v_mfma_f32_16x16x32_bf16 a[248:251], v[12:15], v[56:59], a[248:251]
    v_exp_f32 v75, v75
    v_mfma_f32_16x16x32_bf16 a[252:255], v[12:15], v[60:63], a[252:255]
    v_exp_f32 v88, v88
    v_mfma_f32_16x16x32_bf16 v[96:99], a[64:67], a[0:3], v[16:19]
    v_exp_f32 v89, v89
    v_mfma_f32_16x16x32_bf16 v[96:99], a[68:71], a[4:7], v[96:99]
    v_exp_f32 v90, v90
    v_mfma_f32_16x16x32_bf16 v[96:99], a[72:75], a[8:11], v[96:99]
    v_exp_f32 v91, v91
    v_mfma_f32_16x16x32_bf16 v[96:99], a[76:79], a[12:15], v[96:99]
    v_cvt_pk_bf16_f32 v40, v72, v73
    v_cvt_pk_bf16_f32 v41, v74, v75
    v_mfma_f32_16x16x32_bf16 v[112:115], a[80:83], a[0:3], v[16:19]
    s_waitcnt lgkmcnt(0)
    s_waitcnt vmcnt(9)
    s_barrier
    v_mfma_f32_16x16x32_bf16 v[112:115], a[84:87], a[4:7], v[112:115]
    ds_read_b64_tr_b16 a[160:161], v6 offset:41984
    ds_read_b64_tr_b16 a[162:163], v6 offset:42496
    v_mfma_f32_16x16x32_bf16 v[112:115], a[88:91], a[8:11], v[112:115]
    ds_read_b64_tr_b16 a[164:165], v6 offset:42016
    v_cvt_pk_bf16_f32 v42, v88, v89
    v_mfma_f32_16x16x32_bf16 v[112:115], a[92:95], a[12:15], v[112:115]
    ds_read_b64_tr_b16 a[166:167], v6 offset:42528
    ds_read_b64_tr_b16 a[168:169], v6 offset:42048
    v_mfma_f32_16x16x32_bf16 v[100:103], a[64:67], a[16:19], v[20:23]
    ds_read_b64_tr_b16 a[170:171], v6 offset:42560
    v_cvt_pk_bf16_f32 v43, v90, v91
    v_mfma_f32_16x16x32_bf16 v[100:103], a[68:71], a[20:23], v[100:103]
    ds_read_b64_tr_b16 a[172:173], v6 offset:42080
    ds_read_b64_tr_b16 a[174:175], v6 offset:42592
    v_mfma_f32_16x16x32_bf16 v[100:103], a[72:75], a[24:27], v[100:103]
    v_exp_f32 v76, v76
    v_mfma_f32_16x16x32_bf16 v[100:103], a[76:79], a[28:31], v[100:103]
    v_exp_f32 v77, v77
    v_mfma_f32_16x16x32_bf16 v[116:119], a[80:83], a[16:19], v[20:23]
    v_exp_f32 v78, v78
    v_mfma_f32_16x16x32_bf16 v[116:119], a[84:87], a[20:23], v[116:119]
    v_exp_f32 v79, v79
    v_mfma_f32_16x16x32_bf16 v[116:119], a[88:91], a[24:27], v[116:119]
    v_exp_f32 v92, v92
    v_mfma_f32_16x16x32_bf16 v[116:119], a[92:95], a[28:31], v[116:119]
    v_exp_f32 v93, v93
    v_mfma_f32_16x16x32_bf16 v[104:107], a[64:67], a[32:35], v[24:27]
    v_exp_f32 v94, v94
    v_mfma_f32_16x16x32_bf16 v[104:107], a[68:71], a[36:39], v[104:107]
    v_exp_f32 v95, v95
    v_mfma_f32_16x16x32_bf16 v[104:107], a[72:75], a[40:43], v[104:107]
    s_waitcnt lgkmcnt(0)
    buffer_load_dwordx4 v5, s[8:11], s41 offen offset:0 lds
    v_mfma_f32_16x16x32_bf16 v[104:107], a[76:79], a[44:47], v[104:107]
    s_add_u32 m0, s33, 142624
    v_cvt_pk_bf16_f32 v44, v76, v77
    v_mfma_f32_16x16x32_bf16 v[120:123], a[80:83], a[32:35], v[24:27]
    v_cvt_pk_bf16_f32 v45, v78, v79
    v_cvt_pk_bf16_f32 v46, v92, v93
    v_mfma_f32_16x16x32_bf16 v[120:123], a[84:87], a[36:39], v[120:123]
    v_cvt_pk_bf16_f32 v47, v94, v95
    v_accvgpr_read_b32 v11, a190
    v_mfma_f32_16x16x32_bf16 v[120:123], a[88:91], a[40:43], v[120:123]
    v_exp_f32 v96, v96
    v_mfma_f32_16x16x32_bf16 v[120:123], a[92:95], a[44:47], v[120:123]
    buffer_load_dwordx4 v5, s[8:11], s41 offen offset:1024 lds
    v_mfma_f32_16x16x32_bf16 v[108:111], a[64:67], a[48:51], v[28:31]
    s_add_u32 m0, s33, 142656
    ds_read_b128 a[64:67], v7 offset:0
    v_mfma_f32_16x16x32_bf16 v[108:111], a[68:71], a[52:55], v[108:111]
    ds_read_b128 a[68:71], v7 offset:64
    v_mfma_f32_16x16x32_bf16 v[108:111], a[72:75], a[56:59], v[108:111]
    v_exp_f32 v97, v97
    v_mfma_f32_16x16x32_bf16 v[108:111], a[76:79], a[60:63], v[108:111]
    ds_read_b128 a[72:75], v7 offset:128
    v_cvt_pk_bf16_f32 v48, v96, v97
    v_mfma_f32_16x16x32_bf16 v[124:127], a[80:83], a[48:51], v[28:31]
    buffer_load_dwordx4 v5, s[8:11], s41 offen offset:2048 lds
    v_mfma_f32_16x16x32_bf16 v[124:127], a[84:87], a[52:55], v[124:127]
    s_add_u32 m0, s33, 142688
    ds_read_b128 a[76:79], v7 offset:192
    v_mfma_f32_16x16x32_bf16 v[124:127], a[88:91], a[56:59], v[124:127]
    ds_read_b128 a[80:83], v7 offset:256
    v_mfma_f32_16x16x32_bf16 v[124:127], a[92:95], a[60:63], v[124:127]
    v_exp_f32 v98, v98
    v_mfma_f32_16x16x32_bf16 v[128:131], a[96:99], v[32:35], v[128:131]
    ds_read_b128 a[84:87], v7 offset:320
    v_mfma_f32_16x16x32_bf16 v[132:135], a[96:99], v[36:39], v[132:135]
    buffer_load_dwordx4 v5, s[8:11], s41 offen offset:3072 lds
    v_mfma_f32_16x16x32_bf16 v[136:139], a[96:99], v[40:43], v[136:139]
    s_add_u32 m0, s44, 67072
    ds_read_b128 a[88:91], v7 offset:384
    v_mfma_f32_16x16x32_bf16 v[140:143], a[96:99], v[44:47], v[140:143]
    ds_read_b128 a[92:95], v7 offset:448
    s_xor_b32 s41, s32, 131072
    v_mfma_f32_16x16x32_bf16 v[144:147], a[100:103], v[32:35], v[144:147]
    v_exp_f32 v99, v99
    v_mfma_f32_16x16x32_bf16 v[148:151], a[100:103], v[36:39], v[148:151]
    ds_read_b64_tr_b16 a[96:97], v8 offset:0
    ds_read_b64_tr_b16 a[98:99], v8 offset:512
    v_mfma_f32_16x16x32_bf16 v[152:155], a[100:103], v[40:43], v[152:155]
    buffer_load_dwordx4 v3, s[12:15], s46 offen offset:0 lds
    v_mfma_f32_16x16x32_bf16 v[156:159], a[100:103], v[44:47], v[156:159]
    s_add_u32 m0, s44, 68896
    ds_read_b64_tr_b16 a[100:101], v8 offset:32
    v_mfma_f32_16x16x32_bf16 v[160:163], a[104:107], v[32:35], v[160:163]
    v_exp_f32 v112, v112
    v_mfma_f32_16x16x32_bf16 v[164:167], a[104:107], v[36:39], v[164:167]
    v_exp_f32 v113, v113
    v_mfma_f32_16x16x32_bf16 v[168:171], a[104:107], v[40:43], v[168:171]
    v_exp_f32 v114, v114
    v_mfma_f32_16x16x32_bf16 v[172:175], a[104:107], v[44:47], v[172:175]
    buffer_load_dwordx4 v3, s[12:15], s46 offen offset:256 lds
    v_mfma_f32_16x16x32_bf16 v[176:179], a[108:111], v[32:35], v[176:179]
    s_add_u32 m0, s44, 70720
    ds_read_b64_tr_b16 a[102:103], v8 offset:544
    v_mfma_f32_16x16x32_bf16 v[180:183], a[108:111], v[36:39], v[180:183]
    v_exp_f32 v115, v115
    v_mfma_f32_16x16x32_bf16 v[184:187], a[108:111], v[40:43], v[184:187]
    v_cvt_pk_bf16_f32 v49, v98, v99
    v_cvt_pk_bf16_f32 v50, v112, v113
    v_mfma_f32_16x16x32_bf16 v[188:191], a[108:111], v[44:47], v[188:191]
    v_cvt_pk_bf16_f32 v51, v114, v115
    ds_read_b64_tr_b16 a[104:105], v8 offset:64
    v_mfma_f32_16x16x32_bf16 v[192:195], a[112:115], v[32:35], v[192:195]
    buffer_load_dwordx4 v3, s[12:15], s46 offen offset:512 lds
    v_mfma_f32_16x16x32_bf16 v[196:199], a[112:115], v[36:39], v[196:199]
    s_add_u32 m0, s44, 72544
    ds_read_b64_tr_b16 a[106:107], v8 offset:576
    v_mfma_f32_16x16x32_bf16 v[200:203], a[112:115], v[40:43], v[200:203]
    v_exp_f32 v100, v100
    v_mfma_f32_16x16x32_bf16 v[204:207], a[112:115], v[44:47], v[204:207]
    v_exp_f32 v101, v101
    v_mfma_f32_16x16x32_bf16 v[208:211], a[116:119], v[32:35], v[208:211]
    v_exp_f32 v102, v102
    v_mfma_f32_16x16x32_bf16 v[212:215], a[116:119], v[36:39], v[212:215]
    buffer_load_dwordx4 v3, s[12:15], s46 offen offset:768 lds
    v_mfma_f32_16x16x32_bf16 v[216:219], a[116:119], v[40:43], v[216:219]
    s_add_u32 m0, s45, 67072
    v_cvt_pk_bf16_f32 v52, v100, v101
    v_mfma_f32_16x16x32_bf16 v[220:223], a[116:119], v[44:47], v[220:223]
    v_exp_f32 v103, v103
    v_mfma_f32_16x16x32_bf16 v[224:227], a[120:123], v[32:35], v[224:227]
    v_exp_f32 v116, v116
    v_mfma_f32_16x16x32_bf16 v[228:231], a[120:123], v[36:39], v[228:231]
    v_exp_f32 v117, v117
    v_mfma_f32_16x16x32_bf16 v[232:235], a[120:123], v[40:43], v[232:235]
    buffer_load_dwordx4 v4, s[16:19], s47 offen offset:0 lds
    v_mfma_f32_16x16x32_bf16 v[236:239], a[120:123], v[44:47], v[236:239]
    s_add_u32 m0, s45, 67872
    v_cvt_pk_bf16_f32 v53, v102, v103
    v_mfma_f32_16x16x32_bf16 v[240:243], a[124:127], v[32:35], v[240:243]
    v_exp_f32 v118, v118
    v_mfma_f32_16x16x32_bf16 v[244:247], a[124:127], v[36:39], v[244:247]
    v_exp_f32 v119, v119
    v_mfma_f32_16x16x32_bf16 v[248:251], a[124:127], v[40:43], v[248:251]
    v_cvt_pk_bf16_f32 v54, v116, v117
    v_cvt_pk_bf16_f32 v55, v118, v119
    v_mfma_f32_16x16x32_bf16 v[252:255], a[124:127], v[44:47], v[252:255]
    buffer_load_dwordx4 v4, s[16:19], s47 offen offset:256 lds
    v_mfma_f32_16x16x32_bf16 a[240:243], v[12:15], v[32:35], a[240:243]
    s_add_u32 m0, s45, 75520
    ds_read_b64_tr_b16 a[108:109], v8 offset:96
    v_mfma_f32_16x16x32_bf16 a[244:247], v[12:15], v[36:39], a[244:247]
    v_exp_f32 v104, v104
    v_mfma_f32_16x16x32_bf16 a[248:251], v[12:15], v[40:43], a[248:251]
    v_exp_f32 v105, v105
    v_mfma_f32_16x16x32_bf16 a[252:255], v[12:15], v[44:47], a[252:255]
    v_exp_f32 v106, v106
    s_waitcnt lgkmcnt(1)
    v_mfma_f32_16x16x32_bf16 v[64:67], a[64:67], a[0:3], v[16:19]
    buffer_load_dwordx4 v4, s[16:19], s46 offen offset:0 lds
    v_mfma_f32_16x16x32_bf16 v[64:67], a[68:71], a[4:7], v[64:67]
    s_add_u32 m0, s45, 76320
    v_cvt_pk_bf16_f32 v56, v104, v105
    v_mfma_f32_16x16x32_bf16 v[64:67], a[72:75], a[8:11], v[64:67]
    v_exp_f32 v107, v107
    v_mfma_f32_16x16x32_bf16 v[64:67], a[76:79], a[12:15], v[64:67]
    v_exp_f32 v120, v120
    v_mfma_f32_16x16x32_bf16 v[80:83], a[80:83], a[0:3], v[16:19]
    v_exp_f32 v121, v121
    v_mfma_f32_16x16x32_bf16 v[80:83], a[84:87], a[4:7], v[80:83]
    buffer_load_dwordx4 v4, s[16:19], s46 offen offset:256 lds
    v_mfma_f32_16x16x32_bf16 v[80:83], a[88:91], a[8:11], v[80:83]
    v_exp_f32 v122, v122
    v_mfma_f32_16x16x32_bf16 v[80:83], a[92:95], a[12:15], v[80:83]
    v_exp_f32 v123, v123
    v_mfma_f32_16x16x32_bf16 v[68:71], a[64:67], a[16:19], v[20:23]
    v_cvt_pk_bf16_f32 v57, v106, v107
    v_cvt_pk_bf16_f32 v58, v120, v121
    v_mfma_f32_16x16x32_bf16 v[68:71], a[68:71], a[20:23], v[68:71]
    v_cvt_pk_bf16_f32 v59, v122, v123
    ds_read_b64_tr_b16 a[110:111], v8 offset:608
    v_mfma_f32_16x16x32_bf16 v[68:71], a[72:75], a[24:27], v[68:71]
    v_exp_f32 v108, v108
    v_mfma_f32_16x16x32_bf16 v[68:71], a[76:79], a[28:31], v[68:71]
    v_exp_f32 v109, v109
    v_mfma_f32_16x16x32_bf16 v[84:87], a[80:83], a[16:19], v[20:23]
    v_exp_f32 v110, v110
    v_mfma_f32_16x16x32_bf16 v[84:87], a[84:87], a[20:23], v[84:87]
    v_exp_f32 v111, v111
    v_mfma_f32_16x16x32_bf16 v[84:87], a[88:91], a[24:27], v[84:87]
    v_exp_f32 v124, v124
    v_mfma_f32_16x16x32_bf16 v[84:87], a[92:95], a[28:31], v[84:87]
    v_exp_f32 v125, v125
    v_mfma_f32_16x16x32_bf16 v[72:75], a[64:67], a[32:35], v[24:27]
    v_exp_f32 v126, v126
    v_mfma_f32_16x16x32_bf16 v[72:75], a[68:71], a[36:39], v[72:75]
    v_exp_f32 v127, v127
    v_mfma_f32_16x16x32_bf16 v[72:75], a[72:75], a[40:43], v[72:75]
    v_cvt_pk_bf16_f32 v60, v108, v109
    v_cvt_pk_bf16_f32 v61, v110, v111
    v_mfma_f32_16x16x32_bf16 v[72:75], a[76:79], a[44:47], v[72:75]
    v_cvt_pk_bf16_f32 v62, v124, v125
    v_cvt_pk_bf16_f32 v63, v126, v127
    v_mfma_f32_16x16x32_bf16 v[88:91], a[80:83], a[32:35], v[24:27]
    ds_read_b64_tr_b16 a[112:113], v8 offset:128
    ds_read_b64_tr_b16 a[114:115], v8 offset:640
    v_mfma_f32_16x16x32_bf16 v[88:91], a[84:87], a[36:39], v[88:91]
    ds_read_b64_tr_b16 a[116:117], v8 offset:160
    s_add_u32 m0, s33, 142592
    v_mfma_f32_16x16x32_bf16 v[88:91], a[88:91], a[40:43], v[88:91]
    ds_read_b64_tr_b16 a[118:119], v8 offset:672
    ds_read_b64_tr_b16 a[120:121], v8 offset:192
    v_mfma_f32_16x16x32_bf16 v[88:91], a[92:95], a[44:47], v[88:91]
    ds_read_b64_tr_b16 a[122:123], v8 offset:704
    s_add_u32 s47, s46, 8192
    v_mfma_f32_16x16x32_bf16 v[76:79], a[64:67], a[48:51], v[28:31]
    ds_read_b64_tr_b16 a[124:125], v8 offset:224
    ds_read_b64_tr_b16 a[126:127], v8 offset:736
    v_mfma_f32_16x16x32_bf16 v[76:79], a[68:71], a[52:55], v[76:79]
    ds_read_b128 a[64:67], v7 offset:512
    s_add_u32 s46, s46, 16384
    v_mfma_f32_16x16x32_bf16 v[76:79], a[72:75], a[56:59], v[76:79]
    ds_read_b128 a[68:71], v7 offset:576
    s_and_b32 s46, s46, 0x1ffff
    v_mfma_f32_16x16x32_bf16 v[76:79], a[76:79], a[60:63], v[76:79]
    buffer_load_dword v2, v11, s[56:59], 0 offen
    v_mfma_f32_16x16x32_bf16 v[92:95], a[80:83], a[48:51], v[28:31]
    ds_read_b128 a[72:75], v7 offset:640
    s_mov_b32 s56, s82
    v_mfma_f32_16x16x32_bf16 v[92:95], a[84:87], a[52:55], v[92:95]
    ds_read_b128 a[76:79], v7 offset:704
    s_mov_b32 s57, s83
    v_mfma_f32_16x16x32_bf16 v[92:95], a[88:91], a[56:59], v[92:95]
    ds_read_b128 a[80:83], v7 offset:768
    s_mov_b32 s59, 0x20000
    v_mfma_f32_16x16x32_bf16 v[92:95], a[92:95], a[60:63], v[92:95]
    v_exp_f32 v64, v64
    v_mfma_f32_16x16x32_bf16 v[128:131], a[96:99], v[48:51], v[128:131]
    ds_read_b128 a[84:87], v7 offset:832
    v_mfma_f32_16x16x32_bf16 v[132:135], a[96:99], v[52:55], v[132:135]
    ds_read_b128 a[88:91], v7 offset:896
    v_mfma_f32_16x16x32_bf16 v[136:139], a[96:99], v[56:59], v[136:139]
    ds_read_b128 a[92:95], v7 offset:960
    v_mfma_f32_16x16x32_bf16 v[140:143], a[96:99], v[60:63], v[140:143]
    v_exp_f32 v65, v65
    v_mfma_f32_16x16x32_bf16 v[144:147], a[100:103], v[48:51], v[144:147]
    ds_read_b64_tr_b16 a[96:97], v8 offset:8448
    ds_read_b64_tr_b16 a[98:99], v8 offset:8960
    v_mfma_f32_16x16x32_bf16 v[148:151], a[100:103], v[52:55], v[148:151]
    v_exp_f32 v66, v66
    v_mfma_f32_16x16x32_bf16 v[152:155], a[100:103], v[56:59], v[152:155]
    v_exp_f32 v67, v67
    v_mfma_f32_16x16x32_bf16 v[156:159], a[100:103], v[60:63], v[156:159]
    ds_read_b64_tr_b16 a[100:101], v8 offset:8480
    ds_read_b64_tr_b16 a[102:103], v8 offset:8992
    v_mfma_f32_16x16x32_bf16 v[160:163], a[104:107], v[48:51], v[160:163]
    v_exp_f32 v80, v80
    v_mfma_f32_16x16x32_bf16 v[164:167], a[104:107], v[52:55], v[164:167]
    v_exp_f32 v81, v81
    v_mfma_f32_16x16x32_bf16 v[168:171], a[104:107], v[56:59], v[168:171]
    v_exp_f32 v82, v82
    v_mfma_f32_16x16x32_bf16 v[172:175], a[104:107], v[60:63], v[172:175]
    ds_read_b64_tr_b16 a[104:105], v8 offset:8512
    ds_read_b64_tr_b16 a[106:107], v8 offset:9024
    s_waitcnt lgkmcnt(6)
    v_mfma_f32_16x16x32_bf16 v[176:179], a[108:111], v[48:51], v[176:179]
    v_exp_f32 v83, v83
    v_mfma_f32_16x16x32_bf16 v[180:183], a[108:111], v[52:55], v[180:183]
    v_cvt_pk_bf16_f32 v32, v64, v65
    v_cvt_pk_bf16_f32 v33, v66, v67
    v_mfma_f32_16x16x32_bf16 v[184:187], a[108:111], v[56:59], v[184:187]
    v_cvt_pk_bf16_f32 v34, v80, v81
    v_cvt_pk_bf16_f32 v35, v82, v83
    v_mfma_f32_16x16x32_bf16 v[188:191], a[108:111], v[60:63], v[188:191]
    ds_read_b64_tr_b16 a[108:109], v8 offset:8544
    ds_read_b64_tr_b16 a[110:111], v8 offset:9056
    v_mfma_f32_16x16x32_bf16 v[192:195], a[112:115], v[48:51], v[192:195]
    v_exp_f32 v68, v68
    v_mfma_f32_16x16x32_bf16 v[196:199], a[112:115], v[52:55], v[196:199]
    v_exp_f32 v69, v69
    v_mfma_f32_16x16x32_bf16 v[200:203], a[112:115], v[56:59], v[200:203]
    v_exp_f32 v70, v70
    v_mfma_f32_16x16x32_bf16 v[204:207], a[112:115], v[60:63], v[204:207]
    ds_read_b64_tr_b16 a[112:113], v8 offset:8576
    ds_read_b64_tr_b16 a[114:115], v8 offset:9088
    v_mfma_f32_16x16x32_bf16 v[208:211], a[116:119], v[48:51], v[208:211]
    v_exp_f32 v71, v71
    v_mfma_f32_16x16x32_bf16 v[212:215], a[116:119], v[52:55], v[212:215]
    v_exp_f32 v84, v84
    v_mfma_f32_16x16x32_bf16 v[216:219], a[116:119], v[56:59], v[216:219]
    v_exp_f32 v85, v85
    v_mfma_f32_16x16x32_bf16 v[220:223], a[116:119], v[60:63], v[220:223]
    ds_read_b64_tr_b16 a[116:117], v8 offset:8608
    ds_read_b64_tr_b16 a[118:119], v8 offset:9120
    v_mfma_f32_16x16x32_bf16 v[224:227], a[120:123], v[48:51], v[224:227]
    v_exp_f32 v86, v86
    v_mfma_f32_16x16x32_bf16 v[228:231], a[120:123], v[52:55], v[228:231]
    v_exp_f32 v87, v87
    v_mfma_f32_16x16x32_bf16 v[232:235], a[120:123], v[56:59], v[232:235]
    v_cvt_pk_bf16_f32 v36, v68, v69
    v_cvt_pk_bf16_f32 v37, v70, v71
    v_mfma_f32_16x16x32_bf16 v[236:239], a[120:123], v[60:63], v[236:239]
    ds_read_b64_tr_b16 a[120:121], v8 offset:8640
    ds_read_b64_tr_b16 a[122:123], v8 offset:9152
    v_mfma_f32_16x16x32_bf16 v[240:243], a[124:127], v[48:51], v[240:243]
    v_cvt_pk_bf16_f32 v38, v84, v85
    v_cvt_pk_bf16_f32 v39, v86, v87
    v_mfma_f32_16x16x32_bf16 v[244:247], a[124:127], v[52:55], v[244:247]
    v_exp_f32 v72, v72
    v_mfma_f32_16x16x32_bf16 v[248:251], a[124:127], v[56:59], v[248:251]
    v_exp_f32 v73, v73
    v_mfma_f32_16x16x32_bf16 v[252:255], a[124:127], v[60:63], v[252:255]
    ds_read_b64_tr_b16 a[124:125], v8 offset:8672
    ds_read_b64_tr_b16 a[126:127], v8 offset:9184
    v_mfma_f32_16x16x32_bf16 a[240:243], v[12:15], v[48:51], a[240:243]
    v_exp_f32 v74, v74
    v_mfma_f32_16x16x32_bf16 a[244:247], v[12:15], v[52:55], a[244:247]
    v_exp_f32 v75, v75
    v_mfma_f32_16x16x32_bf16 a[248:251], v[12:15], v[56:59], a[248:251]
    v_exp_f32 v88, v88
    v_mfma_f32_16x16x32_bf16 a[252:255], v[12:15], v[60:63], a[252:255]
    v_exp_f32 v89, v89
    v_mfma_f32_16x16x32_bf16 v[96:99], a[64:67], a[0:3], v[16:19]
    v_exp_f32 v90, v90
    v_mfma_f32_16x16x32_bf16 v[96:99], a[68:71], a[4:7], v[96:99]
    v_exp_f32 v91, v91
    v_mfma_f32_16x16x32_bf16 v[96:99], a[72:75], a[8:11], v[96:99]
    v_cvt_pk_bf16_f32 v40, v72, v73
    v_cvt_pk_bf16_f32 v41, v74, v75
    v_mfma_f32_16x16x32_bf16 v[96:99], a[76:79], a[12:15], v[96:99]
    v_cvt_pk_bf16_f32 v42, v88, v89
    v_cvt_pk_bf16_f32 v43, v90, v91
    v_mfma_f32_16x16x32_bf16 v[112:115], a[80:83], a[0:3], v[16:19]
    s_waitcnt lgkmcnt(0)
    s_waitcnt vmcnt(9)
    s_barrier
    v_mfma_f32_16x16x32_bf16 v[112:115], a[84:87], a[4:7], v[112:115]
    ds_read_b64_tr_b16 a[176:177], v6 offset:41984
    ds_read_b64_tr_b16 a[178:179], v6 offset:42496
    v_mfma_f32_16x16x32_bf16 v[112:115], a[88:91], a[8:11], v[112:115]
    ds_read_b64_tr_b16 a[180:181], v6 offset:42016
    v_mfma_f32_16x16x32_bf16 v[112:115], a[92:95], a[12:15], v[112:115]
    ds_read_b64_tr_b16 a[182:183], v6 offset:42528
    ds_read_b64_tr_b16 a[184:185], v6 offset:42048
    v_mfma_f32_16x16x32_bf16 v[100:103], a[64:67], a[16:19], v[20:23]
    ds_read_b64_tr_b16 a[186:187], v6 offset:42560
    v_mfma_f32_16x16x32_bf16 v[100:103], a[68:71], a[20:23], v[100:103]
    ds_read_b64_tr_b16 a[188:189], v6 offset:42080
    ds_read_b64_tr_b16 a[190:191], v6 offset:42592
    v_mfma_f32_16x16x32_bf16 v[100:103], a[72:75], a[24:27], v[100:103]
    v_exp_f32 v76, v76
    v_mfma_f32_16x16x32_bf16 v[100:103], a[76:79], a[28:31], v[100:103]
    v_exp_f32 v77, v77
    v_mfma_f32_16x16x32_bf16 v[116:119], a[80:83], a[16:19], v[20:23]
    v_exp_f32 v78, v78
    v_mfma_f32_16x16x32_bf16 v[116:119], a[84:87], a[20:23], v[116:119]
    v_exp_f32 v79, v79
    v_mfma_f32_16x16x32_bf16 v[116:119], a[88:91], a[24:27], v[116:119]
    v_exp_f32 v92, v92
    v_mfma_f32_16x16x32_bf16 v[116:119], a[92:95], a[28:31], v[116:119]
    v_exp_f32 v93, v93
    v_mfma_f32_16x16x32_bf16 v[104:107], a[64:67], a[32:35], v[24:27]
    v_exp_f32 v94, v94
    v_mfma_f32_16x16x32_bf16 v[104:107], a[68:71], a[36:39], v[104:107]
    v_exp_f32 v95, v95
    v_mfma_f32_16x16x32_bf16 v[104:107], a[72:75], a[40:43], v[104:107]
    s_waitcnt lgkmcnt(0)
    buffer_load_dwordx4 v5, s[8:11], s41 offen offset:0 lds
    v_mfma_f32_16x16x32_bf16 v[104:107], a[76:79], a[44:47], v[104:107]
    s_add_u32 m0, s33, 142624
    v_cvt_pk_bf16_f32 v44, v76, v77
    v_mfma_f32_16x16x32_bf16 v[120:123], a[80:83], a[32:35], v[24:27]
    v_cvt_pk_bf16_f32 v45, v78, v79
    v_cvt_pk_bf16_f32 v46, v92, v93
    v_mfma_f32_16x16x32_bf16 v[120:123], a[84:87], a[36:39], v[120:123]
    v_cvt_pk_bf16_f32 v47, v94, v95
    v_mfma_f32_16x16x32_bf16 v[120:123], a[88:91], a[40:43], v[120:123]
    v_exp_f32 v96, v96
    v_mfma_f32_16x16x32_bf16 v[120:123], a[92:95], a[44:47], v[120:123]
    buffer_load_dwordx4 v5, s[8:11], s41 offen offset:1024 lds
    v_mfma_f32_16x16x32_bf16 v[108:111], a[64:67], a[48:51], v[28:31]
    s_add_u32 m0, s33, 142656
    ds_read_b128 a[64:67], v7 offset:33536
    v_mfma_f32_16x16x32_bf16 v[108:111], a[68:71], a[52:55], v[108:111]
    ds_read_b128 a[68:71], v7 offset:33600
    v_mfma_f32_16x16x32_bf16 v[108:111], a[72:75], a[56:59], v[108:111]
    v_exp_f32 v97, v97
    v_mfma_f32_16x16x32_bf16 v[108:111], a[76:79], a[60:63], v[108:111]
    ds_read_b128 a[72:75], v7 offset:33664
    v_cvt_pk_bf16_f32 v48, v96, v97
    v_mfma_f32_16x16x32_bf16 v[124:127], a[80:83], a[48:51], v[28:31]
    buffer_load_dwordx4 v5, s[8:11], s41 offen offset:2048 lds
    v_mfma_f32_16x16x32_bf16 v[124:127], a[84:87], a[52:55], v[124:127]
    s_add_u32 m0, s33, 142688
    ds_read_b128 a[76:79], v7 offset:33728
    v_mfma_f32_16x16x32_bf16 v[124:127], a[88:91], a[56:59], v[124:127]
    ds_read_b128 a[80:83], v7 offset:33792
    v_mfma_f32_16x16x32_bf16 v[124:127], a[92:95], a[60:63], v[124:127]
    v_exp_f32 v98, v98
    v_mfma_f32_16x16x32_bf16 v[128:131], a[96:99], v[32:35], v[128:131]
    ds_read_b128 a[84:87], v7 offset:33856
    v_mfma_f32_16x16x32_bf16 v[132:135], a[96:99], v[36:39], v[132:135]
    buffer_load_dwordx4 v5, s[8:11], s41 offen offset:3072 lds
    v_mfma_f32_16x16x32_bf16 v[136:139], a[96:99], v[40:43], v[136:139]
    s_add_u32 m0, s44, 100608
    ds_read_b128 a[88:91], v7 offset:33920
    v_mfma_f32_16x16x32_bf16 v[140:143], a[96:99], v[44:47], v[140:143]
    ds_read_b128 a[92:95], v7 offset:33984
    s_xor_b32 s41, s32, 163840
    v_mfma_f32_16x16x32_bf16 v[144:147], a[100:103], v[32:35], v[144:147]
    v_exp_f32 v99, v99
    v_mfma_f32_16x16x32_bf16 v[148:151], a[100:103], v[36:39], v[148:151]
    ds_read_b64_tr_b16 a[96:97], v8 offset:33536
    ds_read_b64_tr_b16 a[98:99], v8 offset:34048
    v_mfma_f32_16x16x32_bf16 v[152:155], a[100:103], v[40:43], v[152:155]
    buffer_load_dwordx4 v3, s[12:15], s46 offen offset:0 lds
    v_mfma_f32_16x16x32_bf16 v[156:159], a[100:103], v[44:47], v[156:159]
    s_add_u32 m0, s44, 102432
    ds_read_b64_tr_b16 a[100:101], v8 offset:33568
    v_mfma_f32_16x16x32_bf16 v[160:163], a[104:107], v[32:35], v[160:163]
    v_exp_f32 v112, v112
    v_mfma_f32_16x16x32_bf16 v[164:167], a[104:107], v[36:39], v[164:167]
    v_exp_f32 v113, v113
    v_mfma_f32_16x16x32_bf16 v[168:171], a[104:107], v[40:43], v[168:171]
    v_exp_f32 v114, v114
    v_mfma_f32_16x16x32_bf16 v[172:175], a[104:107], v[44:47], v[172:175]
    buffer_load_dwordx4 v3, s[12:15], s46 offen offset:256 lds
    v_mfma_f32_16x16x32_bf16 v[176:179], a[108:111], v[32:35], v[176:179]
    s_add_u32 m0, s44, 104256
    ds_read_b64_tr_b16 a[102:103], v8 offset:34080
    v_mfma_f32_16x16x32_bf16 v[180:183], a[108:111], v[36:39], v[180:183]
    v_exp_f32 v115, v115
    v_mfma_f32_16x16x32_bf16 v[184:187], a[108:111], v[40:43], v[184:187]
    v_cvt_pk_bf16_f32 v49, v98, v99
    v_cvt_pk_bf16_f32 v50, v112, v113
    v_mfma_f32_16x16x32_bf16 v[188:191], a[108:111], v[44:47], v[188:191]
    v_cvt_pk_bf16_f32 v51, v114, v115
    ds_read_b64_tr_b16 a[104:105], v8 offset:33600
    v_mfma_f32_16x16x32_bf16 v[192:195], a[112:115], v[32:35], v[192:195]
    buffer_load_dwordx4 v3, s[12:15], s46 offen offset:512 lds
    v_mfma_f32_16x16x32_bf16 v[196:199], a[112:115], v[36:39], v[196:199]
    s_add_u32 m0, s44, 106080
    ds_read_b64_tr_b16 a[106:107], v8 offset:34112
    v_mfma_f32_16x16x32_bf16 v[200:203], a[112:115], v[40:43], v[200:203]
    v_exp_f32 v100, v100
    v_mfma_f32_16x16x32_bf16 v[204:207], a[112:115], v[44:47], v[204:207]
    v_exp_f32 v101, v101
    v_mfma_f32_16x16x32_bf16 v[208:211], a[116:119], v[32:35], v[208:211]
    v_exp_f32 v102, v102
    v_mfma_f32_16x16x32_bf16 v[212:215], a[116:119], v[36:39], v[212:215]
    buffer_load_dwordx4 v3, s[12:15], s46 offen offset:768 lds
    v_mfma_f32_16x16x32_bf16 v[216:219], a[116:119], v[40:43], v[216:219]
    s_add_u32 m0, s45, 100608
    v_cvt_pk_bf16_f32 v52, v100, v101
    v_mfma_f32_16x16x32_bf16 v[220:223], a[116:119], v[44:47], v[220:223]
    v_exp_f32 v103, v103
    v_mfma_f32_16x16x32_bf16 v[224:227], a[120:123], v[32:35], v[224:227]
    v_exp_f32 v116, v116
    v_mfma_f32_16x16x32_bf16 v[228:231], a[120:123], v[36:39], v[228:231]
    v_exp_f32 v117, v117
    v_mfma_f32_16x16x32_bf16 v[232:235], a[120:123], v[40:43], v[232:235]
    buffer_load_dwordx4 v4, s[16:19], s47 offen offset:0 lds
    v_mfma_f32_16x16x32_bf16 v[236:239], a[120:123], v[44:47], v[236:239]
    s_add_u32 m0, s45, 101408
    v_cvt_pk_bf16_f32 v53, v102, v103
    v_mfma_f32_16x16x32_bf16 v[240:243], a[124:127], v[32:35], v[240:243]
    v_exp_f32 v118, v118
    v_mfma_f32_16x16x32_bf16 v[244:247], a[124:127], v[36:39], v[244:247]
    v_exp_f32 v119, v119
    v_mfma_f32_16x16x32_bf16 v[248:251], a[124:127], v[40:43], v[248:251]
    v_cvt_pk_bf16_f32 v54, v116, v117
    v_cvt_pk_bf16_f32 v55, v118, v119
    v_mfma_f32_16x16x32_bf16 v[252:255], a[124:127], v[44:47], v[252:255]
    buffer_load_dwordx4 v4, s[16:19], s47 offen offset:256 lds
    v_mfma_f32_16x16x32_bf16 a[240:243], v[12:15], v[32:35], a[240:243]
    s_add_u32 m0, s45, 109056
    s_add_u32 s47, s46, 8192
    v_mfma_f32_16x16x32_bf16 a[244:247], v[12:15], v[36:39], a[244:247]
    v_exp_f32 v104, v104
    v_mfma_f32_16x16x32_bf16 a[248:251], v[12:15], v[40:43], a[248:251]
    v_exp_f32 v105, v105
    v_mfma_f32_16x16x32_bf16 a[252:255], v[12:15], v[44:47], a[252:255]
    v_exp_f32 v106, v106
    s_waitcnt lgkmcnt(0)
    v_mfma_f32_16x16x32_bf16 v[64:67], a[64:67], a[0:3], v[16:19]
    buffer_load_dwordx4 v4, s[16:19], s46 offen offset:0 lds
    v_mfma_f32_16x16x32_bf16 v[64:67], a[68:71], a[4:7], v[64:67]
    s_add_u32 m0, s45, 109856
    v_cvt_pk_bf16_f32 v56, v104, v105
    v_mfma_f32_16x16x32_bf16 v[64:67], a[72:75], a[8:11], v[64:67]
    v_exp_f32 v107, v107
    v_mfma_f32_16x16x32_bf16 v[64:67], a[76:79], a[12:15], v[64:67]
    v_exp_f32 v120, v120
    v_mfma_f32_16x16x32_bf16 v[80:83], a[80:83], a[0:3], v[16:19]
    v_exp_f32 v121, v121
    v_mfma_f32_16x16x32_bf16 v[80:83], a[84:87], a[4:7], v[80:83]
    buffer_load_dwordx4 v4, s[16:19], s46 offen offset:256 lds
    v_mfma_f32_16x16x32_bf16 v[80:83], a[88:91], a[8:11], v[80:83]
    s_add_u32 m0, s45, 117504
    v_cvt_pk_bf16_f32 v57, v106, v107
    v_mfma_f32_16x16x32_bf16 v[80:83], a[92:95], a[12:15], v[80:83]
    v_exp_f32 v122, v122
    v_mfma_f32_16x16x32_bf16 v[68:71], a[64:67], a[16:19], v[20:23]
    v_exp_f32 v123, v123
    v_mfma_f32_16x16x32_bf16 v[68:71], a[68:71], a[20:23], v[68:71]
    v_cvt_pk_bf16_f32 v58, v120, v121
    v_cvt_pk_bf16_f32 v59, v122, v123
    v_mfma_f32_16x16x32_bf16 v[68:71], a[72:75], a[24:27], v[68:71]
    buffer_load_dwordx4 v4, s[16:19], s47 offen offset:0 lds
    v_mfma_f32_16x16x32_bf16 v[68:71], a[76:79], a[28:31], v[68:71]
    s_add_u32 m0, s45, 118304
    ds_read_b64_tr_b16 a[108:109], v8 offset:33632
    v_mfma_f32_16x16x32_bf16 v[84:87], a[80:83], a[16:19], v[20:23]
    v_exp_f32 v108, v108
    v_mfma_f32_16x16x32_bf16 v[84:87], a[84:87], a[20:23], v[84:87]
    v_exp_f32 v109, v109
    v_mfma_f32_16x16x32_bf16 v[84:87], a[88:91], a[24:27], v[84:87]
    v_exp_f32 v110, v110
    v_mfma_f32_16x16x32_bf16 v[84:87], a[92:95], a[28:31], v[84:87]
    buffer_load_dwordx4 v4, s[16:19], s47 offen offset:256 lds
    v_mfma_f32_16x16x32_bf16 v[72:75], a[64:67], a[32:35], v[24:27]
    v_exp_f32 v111, v111
    v_mfma_f32_16x16x32_bf16 v[72:75], a[68:71], a[36:39], v[72:75]
    v_exp_f32 v124, v124
    v_mfma_f32_16x16x32_bf16 v[72:75], a[72:75], a[40:43], v[72:75]
    v_exp_f32 v125, v125
    v_mfma_f32_16x16x32_bf16 v[72:75], a[76:79], a[44:47], v[72:75]
    v_exp_f32 v126, v126
    v_mfma_f32_16x16x32_bf16 v[88:91], a[80:83], a[32:35], v[24:27]
    v_exp_f32 v127, v127
    v_mfma_f32_16x16x32_bf16 v[88:91], a[84:87], a[36:39], v[88:91]
    v_cvt_pk_bf16_f32 v60, v108, v109
    v_cvt_pk_bf16_f32 v61, v110, v111
    v_mfma_f32_16x16x32_bf16 v[88:91], a[88:91], a[40:43], v[88:91]
    v_cvt_pk_bf16_f32 v62, v124, v125
    v_cvt_pk_bf16_f32 v63, v126, v127
    v_mfma_f32_16x16x32_bf16 v[88:91], a[92:95], a[44:47], v[88:91]
    ds_read_b64_tr_b16 a[110:111], v8 offset:34144
    ds_read_b64_tr_b16 a[112:113], v8 offset:33664
    v_mfma_f32_16x16x32_bf16 v[76:79], a[64:67], a[48:51], v[28:31]
    ds_read_b64_tr_b16 a[114:115], v8 offset:34176
    s_add_u32 m0, s33, 142592
    v_mfma_f32_16x16x32_bf16 v[76:79], a[68:71], a[52:55], v[76:79]
    ds_read_b64_tr_b16 a[116:117], v8 offset:33696
    ds_read_b64_tr_b16 a[118:119], v8 offset:34208
    v_mfma_f32_16x16x32_bf16 v[76:79], a[72:75], a[56:59], v[76:79]
    ds_read_b64_tr_b16 a[120:121], v8 offset:33728
    v_mbcnt_lo_u32_b32 v3, -1, 0
    v_mfma_f32_16x16x32_bf16 v[76:79], a[76:79], a[60:63], v[76:79]
    ds_read_b64_tr_b16 a[122:123], v8 offset:34240
    ds_read_b64_tr_b16 a[124:125], v8 offset:33760
    v_mfma_f32_16x16x32_bf16 v[92:95], a[80:83], a[48:51], v[28:31]
    ds_read_b64_tr_b16 a[126:127], v8 offset:34272
    v_mbcnt_hi_u32_b32 v3, -1, v3
    v_mfma_f32_16x16x32_bf16 v[92:95], a[84:87], a[52:55], v[92:95]
    ds_read_b128 a[64:67], v7 offset:34048
    v_lshrrev_b32 v4, 1, v3
    v_mfma_f32_16x16x32_bf16 v[92:95], a[88:91], a[56:59], v[92:95]
    ds_read_b128 a[68:71], v7 offset:34112
    v_and_b32 v11, 1, v3
    v_mfma_f32_16x16x32_bf16 v[92:95], a[92:95], a[60:63], v[92:95]
    ds_read_b128 a[72:75], v7 offset:34176
    v_lshlrev_b32 v3, 4, v3
    v_mfma_f32_16x16x32_bf16 v[128:131], a[96:99], v[48:51], v[128:131]
    buffer_load_dword v2, v1, s[8:11], s54 offen
    v_mfma_f32_16x16x32_bf16 v[132:135], a[96:99], v[52:55], v[132:135]
    ds_read_b128 a[76:79], v7 offset:34240
    v_mul_u32_u24 v4, 2752, v4
    v_mfma_f32_16x16x32_bf16 v[136:139], a[96:99], v[56:59], v[136:139]
    ds_read_b128 a[80:83], v7 offset:34304
    v_lshl_add_u32 v4, v11, 4, v4
    v_mfma_f32_16x16x32_bf16 v[140:143], a[96:99], v[60:63], v[140:143]
    ds_read_b128 a[84:87], v7 offset:34368
    v_mfma_f32_16x16x32_bf16 v[144:147], a[100:103], v[48:51], v[144:147]
    s_cmp_lt_u32 s24, 86
    s_cselect_b32 s58, 1409024, 0
    v_mfma_f32_16x16x32_bf16 v[148:151], a[100:103], v[52:55], v[148:151]
    ds_read_b128 a[88:91], v7 offset:34432
    v_mfma_f32_16x16x32_bf16 v[152:155], a[100:103], v[56:59], v[152:155]
    ds_read_b128 a[92:95], v7 offset:34496
    v_mfma_f32_16x16x32_bf16 v[156:159], a[100:103], v[60:63], v[156:159]
    ds_read_b64_tr_b16 a[96:97], v8 offset:41984
    v_mfma_f32_16x16x32_bf16 v[160:163], a[104:107], v[48:51], v[160:163]
    ds_read_b64_tr_b16 a[98:99], v8 offset:42496
    ds_read_b64_tr_b16 a[100:101], v8 offset:42016
    v_mfma_f32_16x16x32_bf16 v[164:167], a[104:107], v[52:55], v[164:167]
    ds_read_b64_tr_b16 a[102:103], v8 offset:42528
    v_mfma_f32_16x16x32_bf16 v[168:171], a[104:107], v[56:59], v[168:171]
    v_exp_f32 v64, v64
    v_mfma_f32_16x16x32_bf16 v[172:175], a[104:107], v[60:63], v[172:175]
    ds_read_b64_tr_b16 a[104:105], v8 offset:42048
    ds_read_b64_tr_b16 a[106:107], v8 offset:42560
    s_waitcnt lgkmcnt(8)
    v_mfma_f32_16x16x32_bf16 v[176:179], a[108:111], v[48:51], v[176:179]
    v_exp_f32 v65, v65
    v_mfma_f32_16x16x32_bf16 v[180:183], a[108:111], v[52:55], v[180:183]
    v_exp_f32 v66, v66
    v_mfma_f32_16x16x32_bf16 v[184:187], a[108:111], v[56:59], v[184:187]
    v_exp_f32 v67, v67
    v_mfma_f32_16x16x32_bf16 v[188:191], a[108:111], v[60:63], v[188:191]
    ds_read_b64_tr_b16 a[108:109], v8 offset:42080
    ds_read_b64_tr_b16 a[110:111], v8 offset:42592
    v_mfma_f32_16x16x32_bf16 v[192:195], a[112:115], v[48:51], v[192:195]
    v_exp_f32 v80, v80
    v_mfma_f32_16x16x32_bf16 v[196:199], a[112:115], v[52:55], v[196:199]
    v_exp_f32 v81, v81
    v_mfma_f32_16x16x32_bf16 v[200:203], a[112:115], v[56:59], v[200:203]
    v_exp_f32 v82, v82
    v_mfma_f32_16x16x32_bf16 v[204:207], a[112:115], v[60:63], v[204:207]
    ds_read_b64_tr_b16 a[112:113], v8 offset:42112
    ds_read_b64_tr_b16 a[114:115], v8 offset:42624
    v_mfma_f32_16x16x32_bf16 v[208:211], a[116:119], v[48:51], v[208:211]
    v_exp_f32 v83, v83
    v_mfma_f32_16x16x32_bf16 v[212:215], a[116:119], v[52:55], v[212:215]
    v_cvt_pk_bf16_f32 v32, v64, v65
    v_cvt_pk_bf16_f32 v33, v66, v67
    v_mfma_f32_16x16x32_bf16 v[216:219], a[116:119], v[56:59], v[216:219]
    v_cvt_pk_bf16_f32 v34, v80, v81
    v_cvt_pk_bf16_f32 v35, v82, v83
    v_mfma_f32_16x16x32_bf16 v[220:223], a[116:119], v[60:63], v[220:223]
    ds_read_b64_tr_b16 a[116:117], v8 offset:42144
    ds_read_b64_tr_b16 a[118:119], v8 offset:42656
    v_mfma_f32_16x16x32_bf16 v[224:227], a[120:123], v[48:51], v[224:227]
    v_exp_f32 v68, v68
    v_mfma_f32_16x16x32_bf16 v[228:231], a[120:123], v[52:55], v[228:231]
    v_exp_f32 v69, v69
    v_mfma_f32_16x16x32_bf16 v[232:235], a[120:123], v[56:59], v[232:235]
    v_exp_f32 v70, v70
    v_mfma_f32_16x16x32_bf16 v[236:239], a[120:123], v[60:63], v[236:239]
    ds_read_b64_tr_b16 a[120:121], v8 offset:42176
    ds_read_b64_tr_b16 a[122:123], v8 offset:42688
    v_mfma_f32_16x16x32_bf16 v[240:243], a[124:127], v[48:51], v[240:243]
    v_exp_f32 v71, v71
    v_mfma_f32_16x16x32_bf16 v[244:247], a[124:127], v[52:55], v[244:247]
    v_exp_f32 v84, v84
    v_mfma_f32_16x16x32_bf16 v[248:251], a[124:127], v[56:59], v[248:251]
    v_exp_f32 v85, v85
    v_mfma_f32_16x16x32_bf16 v[252:255], a[124:127], v[60:63], v[252:255]
    ds_read_b64_tr_b16 a[124:125], v8 offset:42208
    ds_read_b64_tr_b16 a[126:127], v8 offset:42720
    v_mfma_f32_16x16x32_bf16 a[240:243], v[12:15], v[48:51], a[240:243]
    v_exp_f32 v86, v86
    v_mfma_f32_16x16x32_bf16 a[244:247], v[12:15], v[52:55], a[244:247]
    v_exp_f32 v87, v87
    v_mfma_f32_16x16x32_bf16 a[248:251], v[12:15], v[56:59], a[248:251]
    v_cvt_pk_bf16_f32 v36, v68, v69
    v_cvt_pk_bf16_f32 v37, v70, v71
    v_mfma_f32_16x16x32_bf16 a[252:255], v[12:15], v[60:63], a[252:255]
    v_cvt_pk_bf16_f32 v38, v84, v85
    v_cvt_pk_bf16_f32 v39, v86, v87
    v_mfma_f32_16x16x32_bf16 v[96:99], a[64:67], a[0:3], v[16:19]
    v_exp_f32 v72, v72
    v_mfma_f32_16x16x32_bf16 v[96:99], a[68:71], a[4:7], v[96:99]
    v_exp_f32 v73, v73
    v_mfma_f32_16x16x32_bf16 v[96:99], a[72:75], a[8:11], v[96:99]
    v_exp_f32 v74, v74
    v_mfma_f32_16x16x32_bf16 v[96:99], a[76:79], a[12:15], v[96:99]
    v_exp_f32 v75, v75
    v_mfma_f32_16x16x32_bf16 v[112:115], a[80:83], a[0:3], v[16:19]
    s_waitcnt lgkmcnt(0)
    s_waitcnt vmcnt(11)
    s_barrier
    v_mfma_f32_16x16x32_bf16 v[112:115], a[84:87], a[4:7], v[112:115]
    ds_read_b64_tr_b16 a[192:193], v6 offset:41984
    ds_read_b64_tr_b16 a[194:195], v6 offset:42496
    v_mfma_f32_16x16x32_bf16 v[112:115], a[88:91], a[8:11], v[112:115]
    ds_read_b64_tr_b16 a[196:197], v6 offset:42016
    v_cvt_pk_bf16_f32 v40, v72, v73
    v_mfma_f32_16x16x32_bf16 v[112:115], a[92:95], a[12:15], v[112:115]
    ds_read_b64_tr_b16 a[198:199], v6 offset:42528
    ds_read_b64_tr_b16 a[200:201], v6 offset:42048
    v_mfma_f32_16x16x32_bf16 v[100:103], a[64:67], a[16:19], v[20:23]
    ds_read_b64_tr_b16 a[202:203], v6 offset:42560
    v_cvt_pk_bf16_f32 v41, v74, v75
    v_mfma_f32_16x16x32_bf16 v[100:103], a[68:71], a[20:23], v[100:103]
    ds_read_b64_tr_b16 a[204:205], v6 offset:42080
    ds_read_b64_tr_b16 a[206:207], v6 offset:42592
    v_mfma_f32_16x16x32_bf16 v[100:103], a[72:75], a[24:27], v[100:103]
    v_exp_f32 v88, v88
    v_mfma_f32_16x16x32_bf16 v[100:103], a[76:79], a[28:31], v[100:103]
    v_exp_f32 v89, v89
    v_mfma_f32_16x16x32_bf16 v[116:119], a[80:83], a[16:19], v[20:23]
    v_exp_f32 v90, v90
    v_mfma_f32_16x16x32_bf16 v[116:119], a[84:87], a[20:23], v[116:119]
    v_exp_f32 v91, v91
    v_mfma_f32_16x16x32_bf16 v[116:119], a[88:91], a[24:27], v[116:119]
    v_cvt_pk_bf16_f32 v42, v88, v89
    v_cvt_pk_bf16_f32 v43, v90, v91
    v_mfma_f32_16x16x32_bf16 v[116:119], a[92:95], a[28:31], v[116:119]
    v_exp_f32 v76, v76
    v_mfma_f32_16x16x32_bf16 v[104:107], a[64:67], a[32:35], v[24:27]
    v_exp_f32 v77, v77
    v_mfma_f32_16x16x32_bf16 v[104:107], a[68:71], a[36:39], v[104:107]
    v_exp_f32 v78, v78
    v_mfma_f32_16x16x32_bf16 v[104:107], a[72:75], a[40:43], v[104:107]
    s_waitcnt lgkmcnt(0)
    buffer_load_dwordx4 v5, s[8:11], s41 offen offset:0 lds
    v_mfma_f32_16x16x32_bf16 v[104:107], a[76:79], a[44:47], v[104:107]
    s_add_u32 m0, s33, 142624
    v_cvt_pk_bf16_f32 v44, v76, v77
    v_mfma_f32_16x16x32_bf16 v[120:123], a[80:83], a[32:35], v[24:27]
    v_exp_f32 v79, v79
    v_mfma_f32_16x16x32_bf16 v[120:123], a[84:87], a[36:39], v[120:123]
    v_exp_f32 v92, v92
    v_mfma_f32_16x16x32_bf16 v[120:123], a[88:91], a[40:43], v[120:123]
    v_exp_f32 v93, v93
    v_mfma_f32_16x16x32_bf16 v[120:123], a[92:95], a[44:47], v[120:123]
    buffer_load_dwordx4 v5, s[8:11], s41 offen offset:1024 lds
    v_mfma_f32_16x16x32_bf16 v[108:111], a[64:67], a[48:51], v[28:31]
    s_add_u32 m0, s33, 142656
    v_cvt_pk_bf16_f32 v45, v78, v79
    v_mfma_f32_16x16x32_bf16 v[108:111], a[68:71], a[52:55], v[108:111]
    v_exp_f32 v94, v94
    v_mfma_f32_16x16x32_bf16 v[108:111], a[72:75], a[56:59], v[108:111]
    v_exp_f32 v95, v95
    v_mfma_f32_16x16x32_bf16 v[108:111], a[76:79], a[60:63], v[108:111]
    v_cvt_pk_bf16_f32 v46, v92, v93
    v_cvt_pk_bf16_f32 v47, v94, v95
    v_mfma_f32_16x16x32_bf16 v[124:127], a[80:83], a[48:51], v[28:31]
    buffer_load_dwordx4 v5, s[8:11], s41 offen offset:2048 lds
    v_mfma_f32_16x16x32_bf16 v[124:127], a[84:87], a[52:55], v[124:127]
    s_add_u32 m0, s33, 142688
    ds_read_b128 a[64:67], v9 offset:0
    v_mfma_f32_16x16x32_bf16 v[124:127], a[88:91], a[56:59], v[124:127]
    ds_read_b128 a[68:71], v9 offset:64
    v_mfma_f32_16x16x32_bf16 v[124:127], a[92:95], a[60:63], v[124:127]
    v_exp_f32 v96, v96
    v_mfma_f32_16x16x32_bf16 v[128:131], a[96:99], v[32:35], v[128:131]
    ds_read_b128 a[72:75], v9 offset:128
    v_mfma_f32_16x16x32_bf16 v[132:135], a[96:99], v[36:39], v[132:135]
    buffer_load_dwordx4 v5, s[8:11], s41 offen offset:3072 lds
    v_mfma_f32_16x16x32_bf16 v[136:139], a[96:99], v[40:43], v[136:139]
    s_add_u32 m0, s33, 0
    s_xor_b32 s41, s32, 196608
    v_mfma_f32_16x16x32_bf16 v[140:143], a[96:99], v[44:47], v[140:143]
    ds_read_b128 a[76:79], v9 offset:192
    v_mfma_f32_16x16x32_bf16 v[144:147], a[100:103], v[32:35], v[144:147]
    ds_read_b128 a[80:83], v9 offset:256
    v_mfma_f32_16x16x32_bf16 v[148:151], a[100:103], v[36:39], v[148:151]
    ds_read_b128 a[84:87], v9 offset:320
    v_mfma_f32_16x16x32_bf16 v[152:155], a[100:103], v[40:43], v[152:155]
    buffer_load_dwordx4 v5, s[8:11], s41 offen offset:0 lds
    v_mfma_f32_16x16x32_bf16 v[156:159], a[100:103], v[44:47], v[156:159]
    s_add_u32 m0, s33, 32
    ds_read_b128 a[88:91], v9 offset:384
    v_mfma_f32_16x16x32_bf16 v[160:163], a[104:107], v[32:35], v[160:163]
    ds_read_b128 a[92:95], v9 offset:448
    v_mfma_f32_16x16x32_bf16 v[164:167], a[104:107], v[36:39], v[164:167]
    v_exp_f32 v97, v97
    v_mfma_f32_16x16x32_bf16 v[168:171], a[104:107], v[40:43], v[168:171]
    ds_read_b64_tr_b16 a[96:97], v10 offset:0
    ds_read_b64_tr_b16 a[98:99], v10 offset:512
    v_mfma_f32_16x16x32_bf16 v[172:175], a[104:107], v[44:47], v[172:175]
    buffer_load_dwordx4 v5, s[8:11], s41 offen offset:1024 lds
    v_mfma_f32_16x16x32_bf16 v[176:179], a[108:111], v[32:35], v[176:179]
    s_add_u32 m0, s33, 64
    ds_read_b64_tr_b16 a[100:101], v10 offset:32
    v_mfma_f32_16x16x32_bf16 v[180:183], a[108:111], v[36:39], v[180:183]
    v_exp_f32 v98, v98
    v_mfma_f32_16x16x32_bf16 v[184:187], a[108:111], v[40:43], v[184:187]
    v_exp_f32 v99, v99
    v_mfma_f32_16x16x32_bf16 v[188:191], a[108:111], v[44:47], v[188:191]
    v_exp_f32 v112, v112
    v_mfma_f32_16x16x32_bf16 v[192:195], a[112:115], v[32:35], v[192:195]
    buffer_load_dwordx4 v5, s[8:11], s41 offen offset:2048 lds
    v_mfma_f32_16x16x32_bf16 v[196:199], a[112:115], v[36:39], v[196:199]
    s_add_u32 m0, s33, 96
    ds_read_b64_tr_b16 a[102:103], v10 offset:544
    v_mfma_f32_16x16x32_bf16 v[200:203], a[112:115], v[40:43], v[200:203]
    v_exp_f32 v113, v113
    v_mfma_f32_16x16x32_bf16 v[204:207], a[112:115], v[44:47], v[204:207]
    v_exp_f32 v114, v114
    v_mfma_f32_16x16x32_bf16 v[208:211], a[116:119], v[32:35], v[208:211]
    v_exp_f32 v115, v115
    v_mfma_f32_16x16x32_bf16 v[212:215], a[116:119], v[36:39], v[212:215]
    buffer_load_dwordx4 v5, s[8:11], s41 offen offset:3072 lds
    v_mfma_f32_16x16x32_bf16 v[216:219], a[116:119], v[40:43], v[216:219]
    s_add_u32 m0, s33, 16768
    s_xor_b32 s41, s32, 229376
    v_mfma_f32_16x16x32_bf16 v[220:223], a[116:119], v[44:47], v[220:223]
    v_cvt_pk_bf16_f32 v48, v96, v97
    v_cvt_pk_bf16_f32 v49, v98, v99
    v_mfma_f32_16x16x32_bf16 v[224:227], a[120:123], v[32:35], v[224:227]
    v_cvt_pk_bf16_f32 v50, v112, v113
    v_cvt_pk_bf16_f32 v51, v114, v115
    v_mfma_f32_16x16x32_bf16 v[228:231], a[120:123], v[36:39], v[228:231]
    v_exp_f32 v100, v100
    v_mfma_f32_16x16x32_bf16 v[232:235], a[120:123], v[40:43], v[232:235]
    buffer_load_dwordx4 v5, s[8:11], s41 offen offset:0 lds
    v_mfma_f32_16x16x32_bf16 v[236:239], a[120:123], v[44:47], v[236:239]
    s_add_u32 m0, s33, 16800
    ds_read_b64_tr_b16 a[104:105], v10 offset:64
    v_mfma_f32_16x16x32_bf16 v[240:243], a[124:127], v[32:35], v[240:243]
    v_exp_f32 v101, v101
    v_mfma_f32_16x16x32_bf16 v[244:247], a[124:127], v[36:39], v[244:247]
    v_exp_f32 v102, v102
    v_mfma_f32_16x16x32_bf16 v[248:251], a[124:127], v[40:43], v[248:251]
    v_exp_f32 v103, v103
    v_mfma_f32_16x16x32_bf16 v[252:255], a[124:127], v[44:47], v[252:255]
    buffer_load_dwordx4 v5, s[8:11], s41 offen offset:1024 lds
    v_mfma_f32_16x16x32_bf16 a[240:243], v[12:15], v[32:35], a[240:243]
    s_add_u32 m0, s33, 16832
    v_cvt_pk_bf16_f32 v52, v100, v101
    v_mfma_f32_16x16x32_bf16 a[244:247], v[12:15], v[36:39], a[244:247]
    v_exp_f32 v116, v116
    v_mfma_f32_16x16x32_bf16 a[248:251], v[12:15], v[40:43], a[248:251]
    v_exp_f32 v117, v117
    v_mfma_f32_16x16x32_bf16 a[252:255], v[12:15], v[44:47], a[252:255]
    v_exp_f32 v118, v118
    s_waitcnt lgkmcnt(0)
    v_mfma_f32_16x16x32_bf16 v[64:67], a[64:67], a[0:3], v[16:19]
    buffer_load_dwordx4 v5, s[8:11], s41 offen offset:2048 lds
    v_mfma_f32_16x16x32_bf16 v[64:67], a[68:71], a[4:7], v[64:67]
    s_add_u32 m0, s33, 16864
    v_cvt_pk_bf16_f32 v53, v102, v103
    v_mfma_f32_16x16x32_bf16 v[64:67], a[72:75], a[8:11], v[64:67]
    v_exp_f32 v119, v119
    v_mfma_f32_16x16x32_bf16 v[64:67], a[76:79], a[12:15], v[64:67]
    v_cvt_pk_bf16_f32 v54, v116, v117
    v_cvt_pk_bf16_f32 v55, v118, v119
    v_mfma_f32_16x16x32_bf16 v[80:83], a[80:83], a[0:3], v[16:19]
    v_exp_f32 v104, v104
    v_mfma_f32_16x16x32_bf16 v[80:83], a[84:87], a[4:7], v[80:83]
    buffer_load_dwordx4 v5, s[8:11], s41 offen offset:3072 lds
    v_mfma_f32_16x16x32_bf16 v[80:83], a[88:91], a[8:11], v[80:83]
    s_add_u32 m0, s38, 50304
    ds_read_b64_tr_b16 a[106:107], v10 offset:576
    v_mfma_f32_16x16x32_bf16 v[80:83], a[92:95], a[12:15], v[80:83]
    v_exp_f32 v105, v105
    v_mfma_f32_16x16x32_bf16 v[68:71], a[64:67], a[16:19], v[20:23]
    v_exp_f32 v106, v106
    v_mfma_f32_16x16x32_bf16 v[68:71], a[68:71], a[20:23], v[68:71]
    v_exp_f32 v107, v107
    v_mfma_f32_16x16x32_bf16 v[68:71], a[72:75], a[24:27], v[68:71]
    buffer_load_dwordx4 v3, s[56:59], s36 offen offset:0 lds
    v_mfma_f32_16x16x32_bf16 v[68:71], a[76:79], a[28:31], v[68:71]
    s_add_u32 m0, s38, 50320
    v_cvt_pk_bf16_f32 v56, v104, v105
    v_mfma_f32_16x16x32_bf16 v[84:87], a[80:83], a[16:19], v[20:23]
    v_exp_f32 v120, v120
    v_mfma_f32_16x16x32_bf16 v[84:87], a[84:87], a[20:23], v[84:87]
    v_exp_f32 v121, v121
    v_mfma_f32_16x16x32_bf16 v[84:87], a[88:91], a[24:27], v[84:87]
    v_exp_f32 v122, v122
    v_mfma_f32_16x16x32_bf16 v[84:87], a[92:95], a[28:31], v[84:87]
    buffer_load_dwordx4 v3, s[56:59], s36 offen offset:1024 lds
    v_mfma_f32_16x16x32_bf16 v[72:75], a[64:67], a[32:35], v[24:27]
    s_add_u32 m0, s38, 50336
    v_cvt_pk_bf16_f32 v57, v106, v107
    v_mfma_f32_16x16x32_bf16 v[72:75], a[68:71], a[36:39], v[72:75]
    v_exp_f32 v123, v123
    v_mfma_f32_16x16x32_bf16 v[72:75], a[72:75], a[40:43], v[72:75]
    v_cvt_pk_bf16_f32 v58, v120, v121
    v_cvt_pk_bf16_f32 v59, v122, v123
    v_mfma_f32_16x16x32_bf16 v[72:75], a[76:79], a[44:47], v[72:75]
    v_exp_f32 v108, v108
    v_mfma_f32_16x16x32_bf16 v[88:91], a[80:83], a[32:35], v[24:27]
    buffer_load_dwordx4 v3, s[56:59], s36 offen offset:2048 lds
    v_mfma_f32_16x16x32_bf16 v[88:91], a[84:87], a[36:39], v[88:91]
    s_add_u32 m0, s38, 50352
    ds_read_b64_tr_b16 a[108:109], v10 offset:96
    v_mfma_f32_16x16x32_bf16 v[88:91], a[88:91], a[40:43], v[88:91]
    v_exp_f32 v109, v109
    v_mfma_f32_16x16x32_bf16 v[88:91], a[92:95], a[44:47], v[88:91]
    v_exp_f32 v110, v110
    v_mfma_f32_16x16x32_bf16 v[76:79], a[64:67], a[48:51], v[28:31]
    v_exp_f32 v111, v111
    v_mfma_f32_16x16x32_bf16 v[76:79], a[68:71], a[52:55], v[76:79]
    buffer_load_dwordx4 v3, s[56:59], s36 offen offset:3072 lds
    v_mfma_f32_16x16x32_bf16 v[76:79], a[72:75], a[56:59], v[76:79]
    v_exp_f32 v124, v124
    v_mfma_f32_16x16x32_bf16 v[76:79], a[76:79], a[60:63], v[76:79]
    v_exp_f32 v125, v125
    v_mfma_f32_16x16x32_bf16 v[92:95], a[80:83], a[48:51], v[28:31]
    v_exp_f32 v126, v126
    v_mfma_f32_16x16x32_bf16 v[92:95], a[84:87], a[52:55], v[92:95]
    v_exp_f32 v127, v127
    v_mfma_f32_16x16x32_bf16 v[92:95], a[88:91], a[56:59], v[92:95]
    v_cvt_pk_bf16_f32 v60, v108, v109
    v_cvt_pk_bf16_f32 v61, v110, v111
    v_mfma_f32_16x16x32_bf16 v[92:95], a[92:95], a[60:63], v[92:95]
    v_cvt_pk_bf16_f32 v62, v124, v125
    v_cvt_pk_bf16_f32 v63, v126, v127
    v_mfma_f32_16x16x32_bf16 v[128:131], a[96:99], v[48:51], v[128:131]
    ds_read_b64_tr_b16 a[110:111], v10 offset:608
    ds_read_b64_tr_b16 a[112:113], v10 offset:128
    v_mfma_f32_16x16x32_bf16 v[132:135], a[96:99], v[52:55], v[132:135]
    ds_read_b64_tr_b16 a[114:115], v10 offset:640
    s_and_b32 s36, s3, 1
    v_mfma_f32_16x16x32_bf16 v[136:139], a[96:99], v[56:59], v[136:139]
    ds_read_b64_tr_b16 a[116:117], v10 offset:160
    ds_read_b64_tr_b16 a[118:119], v10 offset:672
    v_mfma_f32_16x16x32_bf16 v[140:143], a[96:99], v[60:63], v[140:143]
    ds_read_b64_tr_b16 a[120:121], v10 offset:192
    s_mul_i32 s38, s3, 8320
    v_mfma_f32_16x16x32_bf16 v[144:147], a[100:103], v[48:51], v[144:147]
    ds_read_b64_tr_b16 a[122:123], v10 offset:704
    ds_read_b64_tr_b16 a[124:125], v10 offset:224
    v_mfma_f32_16x16x32_bf16 v[148:151], a[100:103], v[52:55], v[148:151]
    ds_read_b64_tr_b16 a[126:127], v10 offset:736
    s_mul_i32 s36, s36, 704512
    v_mfma_f32_16x16x32_bf16 v[152:155], a[100:103], v[56:59], v[152:155]
    ds_read_b128 a[64:67], v9 offset:512
    s_add_u32 m0, s38, 67072
    v_mfma_f32_16x16x32_bf16 v[156:159], a[100:103], v[60:63], v[156:159]
    ds_read_b128 a[68:71], v9 offset:576
    s_add_u32 s36, s36, s37
    s_waitcnt lgkmcnt(11)
    v_mfma_f32_16x16x32_bf16 v[160:163], a[104:107], v[48:51], v[160:163]
    ds_read_b128 a[72:75], v9 offset:640
    v_mfma_f32_16x16x32_bf16 v[164:167], a[104:107], v[52:55], v[164:167]
    s_cmp_lt_u32 s3, 2
    s_cselect_b32 s56, s78, s80
    v_mfma_f32_16x16x32_bf16 v[168:171], a[104:107], v[56:59], v[168:171]
    ds_read_b128 a[76:79], v9 offset:704
    v_mfma_f32_16x16x32_bf16 v[172:175], a[104:107], v[60:63], v[172:175]
    ds_read_b128 a[80:83], v9 offset:768
    s_waitcnt lgkmcnt(8)
    v_mfma_f32_16x16x32_bf16 v[176:179], a[108:111], v[48:51], v[176:179]
    ds_read_b128 a[84:87], v9 offset:832
    v_mfma_f32_16x16x32_bf16 v[180:183], a[108:111], v[52:55], v[180:183]
    s_cmp_lt_u32 s3, 2
    s_cselect_b32 s57, s79, s81
    v_mfma_f32_16x16x32_bf16 v[184:187], a[108:111], v[56:59], v[184:187]
    ds_read_b128 a[88:91], v9 offset:896
    v_exp_f32 v64, v64
    v_mfma_f32_16x16x32_bf16 v[188:191], a[108:111], v[60:63], v[188:191]
    ds_read_b128 a[92:95], v9 offset:960
    v_exp_f32 v65, v65
    v_mfma_f32_16x16x32_bf16 v[192:195], a[112:115], v[48:51], v[192:195]
    ds_read_b64_tr_b16 a[96:97], v10 offset:8448
    ds_read_b64_tr_b16 a[98:99], v10 offset:8960
    v_mfma_f32_16x16x32_bf16 v[196:199], a[112:115], v[52:55], v[196:199]
    ds_read_b64_tr_b16 a[100:101], v10 offset:8480
    v_cvt_pk_bf16_f32 v32, v64, v65
    v_mfma_f32_16x16x32_bf16 v[200:203], a[112:115], v[56:59], v[200:203]
    ds_read_b64_tr_b16 a[102:103], v10 offset:8992
    ds_read_b64_tr_b16 a[104:105], v10 offset:8512
    v_mfma_f32_16x16x32_bf16 v[204:207], a[112:115], v[60:63], v[204:207]
    ds_read_b64_tr_b16 a[106:107], v10 offset:9024
    v_mfma_f32_16x16x32_bf16 v[208:211], a[116:119], v[48:51], v[208:211]
    ds_read_b64_tr_b16 a[108:109], v10 offset:8544
    ds_read_b64_tr_b16 a[110:111], v10 offset:9056
    v_mfma_f32_16x16x32_bf16 v[212:215], a[116:119], v[52:55], v[212:215]
    ds_read_b64_tr_b16 a[112:113], v10 offset:8576
    v_mfma_f32_16x16x32_bf16 v[216:219], a[116:119], v[56:59], v[216:219]
    ds_read_b64_tr_b16 a[114:115], v10 offset:9088
    v_mfma_f32_16x16x32_bf16 v[220:223], a[116:119], v[60:63], v[220:223]
    ds_read_b64_tr_b16 a[116:117], v10 offset:8608
    ds_read_b64_tr_b16 a[118:119], v10 offset:9120
    s_waitcnt lgkmcnt(12)
    v_mfma_f32_16x16x32_bf16 v[224:227], a[120:123], v[48:51], v[224:227]
    v_exp_f32 v66, v66
    v_mfma_f32_16x16x32_bf16 v[228:231], a[120:123], v[52:55], v[228:231]
    v_exp_f32 v67, v67
    v_mfma_f32_16x16x32_bf16 v[232:235], a[120:123], v[56:59], v[232:235]
    v_exp_f32 v80, v80
    v_mfma_f32_16x16x32_bf16 v[236:239], a[120:123], v[60:63], v[236:239]
    ds_read_b64_tr_b16 a[120:121], v10 offset:8640
    ds_read_b64_tr_b16 a[122:123], v10 offset:9152
    v_mfma_f32_16x16x32_bf16 v[240:243], a[124:127], v[48:51], v[240:243]
    v_exp_f32 v81, v81
    v_mfma_f32_16x16x32_bf16 v[244:247], a[124:127], v[52:55], v[244:247]
    v_exp_f32 v82, v82
    v_mfma_f32_16x16x32_bf16 v[248:251], a[124:127], v[56:59], v[248:251]
    v_exp_f32 v83, v83
    v_mfma_f32_16x16x32_bf16 v[252:255], a[124:127], v[60:63], v[252:255]
    ds_read_b64_tr_b16 a[124:125], v10 offset:8672
    ds_read_b64_tr_b16 a[126:127], v10 offset:9184
    v_mfma_f32_16x16x32_bf16 a[240:243], v[12:15], v[48:51], a[240:243]
    v_cvt_pk_bf16_f32 v33, v66, v67
    v_cvt_pk_bf16_f32 v34, v80, v81
    v_mfma_f32_16x16x32_bf16 a[244:247], v[12:15], v[52:55], a[244:247]
    v_cvt_pk_bf16_f32 v35, v82, v83
    v_mfma_f32_16x16x32_bf16 a[248:251], v[12:15], v[56:59], a[248:251]
    v_exp_f32 v68, v68
    v_mfma_f32_16x16x32_bf16 a[252:255], v[12:15], v[60:63], a[252:255]
    v_exp_f32 v69, v69
    v_mfma_f32_16x16x32_bf16 v[96:99], a[64:67], a[0:3], v[16:19]
    v_exp_f32 v70, v70
    v_mfma_f32_16x16x32_bf16 v[96:99], a[68:71], a[4:7], v[96:99]
    v_exp_f32 v71, v71
    v_mfma_f32_16x16x32_bf16 v[96:99], a[72:75], a[8:11], v[96:99]
    v_exp_f32 v84, v84
    v_mfma_f32_16x16x32_bf16 v[96:99], a[76:79], a[12:15], v[96:99]
    v_exp_f32 v85, v85
    v_mfma_f32_16x16x32_bf16 v[112:115], a[80:83], a[0:3], v[16:19]
    s_waitcnt lgkmcnt(0)
    s_waitcnt vmcnt(17)
    s_barrier
    v_mfma_f32_16x16x32_bf16 v[112:115], a[84:87], a[4:7], v[112:115]
    buffer_load_dwordx4 v4, s[56:59], s36 offen lds
    v_mfma_f32_16x16x32_bf16 v[112:115], a[88:91], a[8:11], v[112:115]
    s_add_u32 m0, s38, 68112
    s_add_u32 s36, s36, 88064
    v_mfma_f32_16x16x32_bf16 v[112:115], a[92:95], a[12:15], v[112:115]
    v_exp_f32 v86, v86
    v_mfma_f32_16x16x32_bf16 v[100:103], a[64:67], a[16:19], v[20:23]
    v_exp_f32 v87, v87
    v_mfma_f32_16x16x32_bf16 v[100:103], a[68:71], a[20:23], v[100:103]
    v_cvt_pk_bf16_f32 v36, v68, v69
    v_cvt_pk_bf16_f32 v37, v70, v71
    v_mfma_f32_16x16x32_bf16 v[100:103], a[72:75], a[24:27], v[100:103]
    buffer_load_dwordx4 v4, s[56:59], s36 offen lds
    v_mfma_f32_16x16x32_bf16 v[100:103], a[76:79], a[28:31], v[100:103]
    s_add_u32 m0, s38, 69152
    s_add_u32 s36, s36, 88064
    v_mfma_f32_16x16x32_bf16 v[116:119], a[80:83], a[16:19], v[20:23]
    v_cvt_pk_bf16_f32 v38, v84, v85
    v_cvt_pk_bf16_f32 v39, v86, v87
    v_mfma_f32_16x16x32_bf16 v[116:119], a[84:87], a[20:23], v[116:119]
    v_exp_f32 v72, v72
    v_mfma_f32_16x16x32_bf16 v[116:119], a[88:91], a[24:27], v[116:119]
    v_exp_f32 v73, v73
    v_mfma_f32_16x16x32_bf16 v[116:119], a[92:95], a[28:31], v[116:119]
    buffer_load_dwordx4 v4, s[56:59], s36 offen lds
    v_mfma_f32_16x16x32_bf16 v[104:107], a[64:67], a[32:35], v[24:27]
    s_add_u32 m0, s38, 70192
    s_add_u32 s36, s36, 88064
    v_mfma_f32_16x16x32_bf16 v[104:107], a[68:71], a[36:39], v[104:107]
    v_exp_f32 v74, v74
    v_mfma_f32_16x16x32_bf16 v[104:107], a[72:75], a[40:43], v[104:107]
    v_exp_f32 v75, v75
    v_mfma_f32_16x16x32_bf16 v[104:107], a[76:79], a[44:47], v[104:107]
    v_exp_f32 v88, v88
    v_mfma_f32_16x16x32_bf16 v[120:123], a[80:83], a[32:35], v[24:27]
    buffer_load_dwordx4 v4, s[56:59], s36 offen lds
    v_mfma_f32_16x16x32_bf16 v[120:123], a[84:87], a[36:39], v[120:123]
    s_add_u32 m0, s38, 71232
    s_add_u32 s36, s36, 88064
    v_mfma_f32_16x16x32_bf16 v[120:123], a[88:91], a[40:43], v[120:123]
    v_exp_f32 v89, v89
    v_mfma_f32_16x16x32_bf16 v[120:123], a[92:95], a[44:47], v[120:123]
    v_exp_f32 v90, v90
    v_mfma_f32_16x16x32_bf16 v[108:111], a[64:67], a[48:51], v[28:31]
    v_exp_f32 v91, v91
    v_mfma_f32_16x16x32_bf16 v[108:111], a[68:71], a[52:55], v[108:111]
    buffer_load_dwordx4 v4, s[56:59], s36 offen lds
    v_mfma_f32_16x16x32_bf16 v[108:111], a[72:75], a[56:59], v[108:111]
    s_add_u32 m0, s38, 72272
    s_add_u32 s36, s36, 88064
    v_mfma_f32_16x16x32_bf16 v[108:111], a[76:79], a[60:63], v[108:111]
    v_cvt_pk_bf16_f32 v40, v72, v73
    v_cvt_pk_bf16_f32 v41, v74, v75
    v_mfma_f32_16x16x32_bf16 v[124:127], a[80:83], a[48:51], v[28:31]
    v_cvt_pk_bf16_f32 v42, v88, v89
    v_cvt_pk_bf16_f32 v43, v90, v91
    v_mfma_f32_16x16x32_bf16 v[124:127], a[84:87], a[52:55], v[124:127]
    v_exp_f32 v76, v76
    v_mfma_f32_16x16x32_bf16 v[124:127], a[88:91], a[56:59], v[124:127]
    buffer_load_dwordx4 v4, s[56:59], s36 offen lds
    v_mfma_f32_16x16x32_bf16 v[124:127], a[92:95], a[60:63], v[124:127]
    s_add_u32 m0, s38, 73312
    s_add_u32 s36, s36, 88064
    v_mfma_f32_16x16x32_bf16 v[128:131], a[96:99], v[32:35], v[128:131]
    v_exp_f32 v77, v77
    v_mfma_f32_16x16x32_bf16 v[132:135], a[96:99], v[36:39], v[132:135]
    v_exp_f32 v78, v78
    v_exp_f32 v79, v79
    v_exp_f32 v92, v92
    v_exp_f32 v93, v93
    v_exp_f32 v94, v94
    v_exp_f32 v95, v95
    v_mfma_f32_16x16x32_bf16 v[136:139], a[96:99], v[40:43], v[136:139]
    buffer_load_dwordx4 v4, s[56:59], s36 offen lds
    v_cvt_pk_bf16_f32 v44, v76, v77
    v_cvt_pk_bf16_f32 v45, v78, v79
    v_cvt_pk_bf16_f32 v46, v92, v93
    v_cvt_pk_bf16_f32 v47, v94, v95
    ds_read_b128 a[64:67], v9 offset:33536
    s_add_u32 m0, s38, 74352
    v_mfma_f32_16x16x32_bf16 v[140:143], a[96:99], v[44:47], v[140:143]
    ds_read_b128 a[68:71], v9 offset:33600
    s_add_u32 s36, s36, 88064
    v_mfma_f32_16x16x32_bf16 v[144:147], a[100:103], v[32:35], v[144:147]
    ds_read_b128 a[72:75], v9 offset:33664
    v_bfe_u32 v11, v3, 4, 3
    v_mfma_f32_16x16x32_bf16 v[148:151], a[100:103], v[36:39], v[148:151]
    v_exp_f32 v96, v96
    v_mfma_f32_16x16x32_bf16 v[152:155], a[100:103], v[40:43], v[152:155]
    ds_read_b128 a[76:79], v9 offset:33728
    v_lshlrev_b32 v11, 2, v11
    v_mfma_f32_16x16x32_bf16 v[156:159], a[100:103], v[44:47], v[156:159]
    ds_read_b128 a[80:83], v9 offset:33792
    buffer_load_dwordx4 v4, s[56:59], s36 offen lds
    v_mfma_f32_16x16x32_bf16 v[160:163], a[104:107], v[32:35], v[160:163]
    ds_read_b128 a[84:87], v9 offset:33856
    s_add_u32 s36, s36, 88064
    v_mfma_f32_16x16x32_bf16 v[164:167], a[104:107], v[36:39], v[164:167]
    ds_read_b128 a[88:91], v9 offset:33920
    v_exp_f32 v97, v97
    v_mfma_f32_16x16x32_bf16 v[168:171], a[104:107], v[40:43], v[168:171]
    ds_read_b128 a[92:95], v9 offset:33984
    v_cvt_pk_bf16_f32 v48, v96, v97
    v_mfma_f32_16x16x32_bf16 v[172:175], a[104:107], v[44:47], v[172:175]
    v_exp_f32 v98, v98
    v_mfma_f32_16x16x32_bf16 v[176:179], a[108:111], v[32:35], v[176:179]
    ds_read_b64_tr_b16 a[96:97], v10 offset:33536
    ds_read_b64_tr_b16 a[98:99], v10 offset:34048
    v_mfma_f32_16x16x32_bf16 v[180:183], a[108:111], v[36:39], v[180:183]
    ds_read_b64_tr_b16 a[100:101], v10 offset:33568
    v_exp_f32 v99, v99
    v_mfma_f32_16x16x32_bf16 v[184:187], a[108:111], v[40:43], v[184:187]
    ds_read_b64_tr_b16 a[102:103], v10 offset:34080
    ds_read_b64_tr_b16 a[104:105], v10 offset:33600
    v_mfma_f32_16x16x32_bf16 v[188:191], a[108:111], v[44:47], v[188:191]
    v_exp_f32 v112, v112
    v_mfma_f32_16x16x32_bf16 v[192:195], a[112:115], v[32:35], v[192:195]
    v_exp_f32 v113, v113
    v_mfma_f32_16x16x32_bf16 v[196:199], a[112:115], v[36:39], v[196:199]
    v_exp_f32 v114, v114
    v_mfma_f32_16x16x32_bf16 v[200:203], a[112:115], v[40:43], v[200:203]
    v_exp_f32 v115, v115
    v_mfma_f32_16x16x32_bf16 v[204:207], a[112:115], v[44:47], v[204:207]
    ds_read_b64_tr_b16 a[106:107], v10 offset:34112
    v_cvt_pk_bf16_f32 v49, v98, v99
    v_mfma_f32_16x16x32_bf16 v[208:211], a[116:119], v[32:35], v[208:211]
    v_cvt_pk_bf16_f32 v50, v112, v113
    v_cvt_pk_bf16_f32 v51, v114, v115
    v_mfma_f32_16x16x32_bf16 v[212:215], a[116:119], v[36:39], v[212:215]
    v_exp_f32 v100, v100
    v_mfma_f32_16x16x32_bf16 v[216:219], a[116:119], v[40:43], v[216:219]
    v_exp_f32 v101, v101
    v_mfma_f32_16x16x32_bf16 v[220:223], a[116:119], v[44:47], v[220:223]
    v_exp_f32 v102, v102
    v_mfma_f32_16x16x32_bf16 v[224:227], a[120:123], v[32:35], v[224:227]
    v_exp_f32 v103, v103
    v_mfma_f32_16x16x32_bf16 v[228:231], a[120:123], v[36:39], v[228:231]
    v_exp_f32 v116, v116
    v_mfma_f32_16x16x32_bf16 v[232:235], a[120:123], v[40:43], v[232:235]
    v_exp_f32 v117, v117
    v_mfma_f32_16x16x32_bf16 v[236:239], a[120:123], v[44:47], v[236:239]
    v_exp_f32 v118, v118
    v_mfma_f32_16x16x32_bf16 v[240:243], a[124:127], v[32:35], v[240:243]
    v_exp_f32 v119, v119
    v_mfma_f32_16x16x32_bf16 v[244:247], a[124:127], v[36:39], v[244:247]
    v_cvt_pk_bf16_f32 v52, v100, v101
    v_cvt_pk_bf16_f32 v53, v102, v103
    v_mfma_f32_16x16x32_bf16 v[248:251], a[124:127], v[40:43], v[248:251]
    v_cvt_pk_bf16_f32 v54, v116, v117
    v_cvt_pk_bf16_f32 v55, v118, v119
    v_mfma_f32_16x16x32_bf16 v[252:255], a[124:127], v[44:47], v[252:255]
    ds_read_b64_tr_b16 a[108:109], v10 offset:33632
    ds_read_b64_tr_b16 a[110:111], v10 offset:34144
    v_mfma_f32_16x16x32_bf16 a[240:243], v[12:15], v[32:35], a[240:243]
    ds_read_b64_tr_b16 a[112:113], v10 offset:33664
    global_load_dword v2, v11, s[86:87] offset:128 sc1
    v_mfma_f32_16x16x32_bf16 a[244:247], v[12:15], v[36:39], a[244:247]
    ds_read_b64_tr_b16 a[114:115], v10 offset:34176
    ds_read_b64_tr_b16 a[116:117], v10 offset:33696
    v_mfma_f32_16x16x32_bf16 a[248:251], v[12:15], v[40:43], a[248:251]
    ds_read_b64_tr_b16 a[118:119], v10 offset:34208
    v_exp_f32 v104, v104
    v_mfma_f32_16x16x32_bf16 a[252:255], v[12:15], v[44:47], a[252:255]
    ds_read_b64_tr_b16 a[120:121], v10 offset:33728
    ds_read_b64_tr_b16 a[122:123], v10 offset:34240
    s_waitcnt lgkmcnt(8)
    v_mfma_f32_16x16x32_bf16 v[64:67], a[64:67], a[0:3], v[16:19]
    ds_read_b64_tr_b16 a[124:125], v10 offset:33760
    v_exp_f32 v105, v105
    v_mfma_f32_16x16x32_bf16 v[64:67], a[68:71], a[4:7], v[64:67]
    ds_read_b64_tr_b16 a[126:127], v10 offset:34272
    v_cvt_pk_bf16_f32 v56, v104, v105
    v_mfma_f32_16x16x32_bf16 v[64:67], a[72:75], a[8:11], v[64:67]
    v_exp_f32 v106, v106
    v_mfma_f32_16x16x32_bf16 v[64:67], a[76:79], a[12:15], v[64:67]
    v_exp_f32 v107, v107
    v_mfma_f32_16x16x32_bf16 v[80:83], a[80:83], a[0:3], v[16:19]
    v_exp_f32 v120, v120
    v_mfma_f32_16x16x32_bf16 v[80:83], a[84:87], a[4:7], v[80:83]
    v_exp_f32 v121, v121
    v_mfma_f32_16x16x32_bf16 v[80:83], a[88:91], a[8:11], v[80:83]
    s_nop 1
    v_exp_f32 v64, v64
    v_mfma_f32_16x16x32_bf16 v[80:83], a[92:95], a[12:15], v[80:83]
    v_exp_f32 v65, v65
    v_mfma_f32_16x16x32_bf16 v[68:71], a[64:67], a[16:19], v[20:23]
    ds_read_b128 a[64:67], v9 offset:34048
    v_cvt_pk_bf16_f32 v32, v64, v65
    v_mfma_f32_16x16x32_bf16 v[68:71], a[68:71], a[20:23], v[68:71]
    ds_read_b128 a[68:71], v9 offset:34112
    v_cvt_pk_bf16_f32 v57, v106, v107
    v_mfma_f32_16x16x32_bf16 v[68:71], a[72:75], a[24:27], v[68:71]
    ds_read_b128 a[72:75], v9 offset:34176
    v_cvt_pk_bf16_f32 v58, v120, v121
    v_mfma_f32_16x16x32_bf16 v[68:71], a[76:79], a[28:31], v[68:71]
    v_exp_f32 v66, v66
    v_mfma_f32_16x16x32_bf16 v[84:87], a[80:83], a[16:19], v[20:23]
    ds_read_b128 a[76:79], v9 offset:34240
    v_exp_f32 v67, v67
    v_mfma_f32_16x16x32_bf16 v[84:87], a[84:87], a[20:23], v[84:87]
    ds_read_b128 a[80:83], v9 offset:34304
    v_cvt_pk_bf16_f32 v33, v66, v67
    v_mfma_f32_16x16x32_bf16 v[84:87], a[88:91], a[24:27], v[84:87]
    ds_read_b128 a[84:87], v9 offset:34368
    v_exp_f32 v80, v80
    v_mfma_f32_16x16x32_bf16 v[84:87], a[92:95], a[28:31], v[84:87]
    ds_read_b128 a[88:91], v9 offset:34432
    v_exp_f32 v81, v81
    v_mfma_f32_16x16x32_bf16 v[128:131], a[96:99], v[48:51], v[128:131]
    ds_read_b128 a[92:95], v9 offset:34496
    v_cvt_pk_bf16_f32 v34, v80, v81
    v_mfma_f32_16x16x32_bf16 v[132:135], a[96:99], v[52:55], v[132:135]
    ds_read_b64_tr_b16 a[96:97], v10 offset:41984
    v_exp_f32 v82, v82
    v_mfma_f32_16x16x32_bf16 v[144:147], a[100:103], v[48:51], v[144:147]
    ds_read_b64_tr_b16 a[98:99], v10 offset:42496
    v_exp_f32 v83, v83
    v_mfma_f32_16x16x32_bf16 v[148:151], a[100:103], v[52:55], v[148:151]
    ds_read_b64_tr_b16 a[100:101], v10 offset:42016
    ds_read_b64_tr_b16 a[102:103], v10 offset:42528
    v_mfma_f32_16x16x32_bf16 v[160:163], a[104:107], v[48:51], v[160:163]
    v_cvt_pk_bf16_f32 v35, v82, v83
    v_exp_f32 v68, v68
    v_mfma_f32_16x16x32_bf16 v[164:167], a[104:107], v[52:55], v[164:167]
    ds_read_b64_tr_b16 a[104:105], v10 offset:42048
    ds_read_b64_tr_b16 a[106:107], v10 offset:42560
    s_waitcnt lgkmcnt(8)
    v_mfma_f32_16x16x32_bf16 v[176:179], a[108:111], v[48:51], v[176:179]
    v_exp_f32 v69, v69
    v_mfma_f32_16x16x32_bf16 v[180:183], a[108:111], v[52:55], v[180:183]
    v_exp_f32 v70, v70
    v_mfma_f32_16x16x32_bf16 v[192:195], a[112:115], v[48:51], v[192:195]
    v_exp_f32 v71, v71
    v_mfma_f32_16x16x32_bf16 v[196:199], a[112:115], v[52:55], v[196:199]
    v_exp_f32 v84, v84
    v_mfma_f32_16x16x32_bf16 v[208:211], a[116:119], v[48:51], v[208:211]
    v_exp_f32 v85, v85
    v_mfma_f32_16x16x32_bf16 v[212:215], a[116:119], v[52:55], v[212:215]
    v_exp_f32 v86, v86
    v_mfma_f32_16x16x32_bf16 v[224:227], a[120:123], v[48:51], v[224:227]
    v_exp_f32 v87, v87
    v_mfma_f32_16x16x32_bf16 v[228:231], a[120:123], v[52:55], v[228:231]
    v_cvt_pk_bf16_f32 v36, v68, v69
    v_cvt_pk_bf16_f32 v37, v70, v71
    v_mfma_f32_16x16x32_bf16 v[240:243], a[124:127], v[48:51], v[240:243]
    v_cvt_pk_bf16_f32 v38, v84, v85
    v_cvt_pk_bf16_f32 v39, v86, v87
    v_mfma_f32_16x16x32_bf16 v[244:247], a[124:127], v[52:55], v[244:247]
    ds_read_b64_tr_b16 a[108:109], v10 offset:42080
    ds_read_b64_tr_b16 a[110:111], v10 offset:42592
    v_mfma_f32_16x16x32_bf16 a[240:243], v[12:15], v[48:51], a[240:243]
    ds_read_b64_tr_b16 a[112:113], v10 offset:42112
    v_exp_f32 v122, v122
    v_mfma_f32_16x16x32_bf16 a[244:247], v[12:15], v[52:55], a[244:247]
    ds_read_b64_tr_b16 a[114:115], v10 offset:42624
    ds_read_b64_tr_b16 a[116:117], v10 offset:42144
    v_mfma_f32_16x16x32_bf16 v[96:99], a[64:67], a[0:3], v[16:19]
    ds_read_b64_tr_b16 a[118:119], v10 offset:42656
    v_exp_f32 v123, v123
    v_mfma_f32_16x16x32_bf16 v[96:99], a[68:71], a[4:7], v[96:99]
    ds_read_b64_tr_b16 a[120:121], v10 offset:42176
    ds_read_b64_tr_b16 a[122:123], v10 offset:42688
    v_mfma_f32_16x16x32_bf16 v[96:99], a[72:75], a[8:11], v[96:99]
    ds_read_b64_tr_b16 a[124:125], v10 offset:42208
    v_cvt_pk_bf16_f32 v59, v122, v123
    v_mfma_f32_16x16x32_bf16 v[96:99], a[76:79], a[12:15], v[96:99]
    ds_read_b64_tr_b16 a[126:127], v10 offset:42720
    v_exp_f32 v108, v108
    v_mfma_f32_16x16x32_bf16 v[112:115], a[80:83], a[0:3], v[16:19]
    v_exp_f32 v109, v109
    v_mfma_f32_16x16x32_bf16 v[112:115], a[84:87], a[4:7], v[112:115]
    s_nop 2
    v_exp_f32 v96, v96
    s_waitcnt lgkmcnt(7)
    v_mfma_f32_16x16x32_bf16 v[112:115], a[88:91], a[8:11], v[112:115]
    v_exp_f32 v97, v97
    v_mfma_f32_16x16x32_bf16 v[112:115], a[92:95], a[12:15], v[112:115]
    v_exp_f32 v98, v98
    v_mfma_f32_16x16x32_bf16 v[100:103], a[64:67], a[16:19], v[20:23]
    ds_read_b64_tr_b16 a[64:65], v10 offset:50432
    ds_read_b64_tr_b16 a[66:67], v10 offset:50944
    v_mfma_f32_16x16x32_bf16 v[100:103], a[68:71], a[20:23], v[100:103]
    v_exp_f32 v99, v99
    v_mfma_f32_16x16x32_bf16 v[100:103], a[72:75], a[24:27], v[100:103]
    s_nop 0
    v_exp_f32 v112, v112
    v_mfma_f32_16x16x32_bf16 v[100:103], a[76:79], a[28:31], v[100:103]
    v_exp_f32 v113, v113
    v_mfma_f32_16x16x32_bf16 v[116:119], a[80:83], a[16:19], v[20:23]
    v_exp_f32 v114, v114
    v_mfma_f32_16x16x32_bf16 v[116:119], a[84:87], a[20:23], v[116:119]
    v_exp_f32 v115, v115
    v_mfma_f32_16x16x32_bf16 v[116:119], a[88:91], a[24:27], v[116:119]
    ds_read_b64_tr_b16 a[68:69], v10 offset:50464
    ds_read_b64_tr_b16 a[70:71], v10 offset:50976
    v_mfma_f32_16x16x32_bf16 v[116:119], a[92:95], a[28:31], v[116:119]
    v_cvt_pk_bf16_f32 v48, v96, v97
    v_cvt_pk_bf16_f32 v49, v98, v99
    v_mfma_f32_16x16x32_bf16 v[128:131], a[96:99], v[32:35], v[128:131]
    v_cvt_pk_bf16_f32 v50, v112, v113
    v_cvt_pk_bf16_f32 v51, v114, v115
    v_mfma_f32_16x16x32_bf16 v[132:135], a[96:99], v[36:39], v[132:135]
    v_exp_f32 v100, v100
    v_mfma_f32_16x16x32_bf16 v[144:147], a[100:103], v[32:35], v[144:147]
    v_exp_f32 v101, v101
    v_mfma_f32_16x16x32_bf16 v[148:151], a[100:103], v[36:39], v[148:151]
    v_exp_f32 v102, v102
    v_mfma_f32_16x16x32_bf16 v[160:163], a[104:107], v[32:35], v[160:163]
    v_exp_f32 v103, v103
    v_mfma_f32_16x16x32_bf16 v[164:167], a[104:107], v[36:39], v[164:167]
    v_exp_f32 v116, v116
    v_mfma_f32_16x16x32_bf16 v[176:179], a[108:111], v[32:35], v[176:179]
    v_exp_f32 v117, v117
    v_mfma_f32_16x16x32_bf16 v[180:183], a[108:111], v[36:39], v[180:183]
    v_exp_f32 v118, v118
    s_waitcnt lgkmcnt(0)
    v_mfma_f32_16x16x32_bf16 v[192:195], a[112:115], v[32:35], v[192:195]
    v_exp_f32 v119, v119
    v_mfma_f32_16x16x32_bf16 v[196:199], a[112:115], v[36:39], v[196:199]
    v_cvt_pk_bf16_f32 v52, v100, v101
    v_cvt_pk_bf16_f32 v53, v102, v103
    v_mfma_f32_16x16x32_bf16 v[208:211], a[116:119], v[32:35], v[208:211]
    v_cvt_pk_bf16_f32 v54, v116, v117
    v_cvt_pk_bf16_f32 v55, v118, v119
    v_mfma_f32_16x16x32_bf16 v[212:215], a[116:119], v[36:39], v[212:215]
    ds_read_b64_tr_b16 a[72:73], v10 offset:50496
    ds_read_b64_tr_b16 a[74:75], v10 offset:51008
    v_mfma_f32_16x16x32_bf16 v[224:227], a[120:123], v[32:35], v[224:227]
    ds_read_b64_tr_b16 a[76:77], v10 offset:50528
    v_cvt_pk_bf16_f32 v60, v108, v109
    v_mfma_f32_16x16x32_bf16 v[228:231], a[120:123], v[36:39], v[228:231]
    ds_read_b64_tr_b16 a[78:79], v10 offset:51040
    ds_read_b64_tr_b16 a[80:81], v10 offset:50560
    v_mfma_f32_16x16x32_bf16 v[240:243], a[124:127], v[32:35], v[240:243]
    ds_read_b64_tr_b16 a[82:83], v10 offset:51072
    v_exp_f32 v110, v110
    v_mfma_f32_16x16x32_bf16 v[244:247], a[124:127], v[36:39], v[244:247]
    ds_read_b64_tr_b16 a[84:85], v10 offset:50592
    ds_read_b64_tr_b16 a[86:87], v10 offset:51104
    v_mfma_f32_16x16x32_bf16 a[240:243], v[12:15], v[32:35], a[240:243]
    ds_read_b64_tr_b16 a[88:89], v10 offset:50624
    v_exp_f32 v111, v111
    v_mfma_f32_16x16x32_bf16 a[244:247], v[12:15], v[36:39], a[244:247]
    ds_read_b64_tr_b16 a[90:91], v10 offset:51136
    ds_read_b64_tr_b16 a[92:93], v10 offset:50656
    v_mfma_f32_16x16x32_bf16 a[240:243], v[12:15], v[48:51], a[240:243]
    ds_read_b64_tr_b16 a[94:95], v10 offset:51168
    v_cvt_pk_bf16_f32 v61, v110, v111
    v_mfma_f32_16x16x32_bf16 a[244:247], v[12:15], v[52:55], a[244:247]
    ds_read_b128 a[96:99], v9 offset:33536
    v_exp_f32 v124, v124
    v_mfma_f32_16x16x32_bf16 v[128:131], a[64:67], v[48:51], v[128:131]
    s_nop 1
    v_accvgpr_read_b32 v16, a240
    ds_read_b128 a[100:103], v9 offset:33600
    v_mfma_f32_16x16x32_bf16 v[132:135], a[64:67], v[52:55], v[132:135]
    v_rcp_f32 v20, v16
    v_mfma_f32_16x16x32_bf16 v[144:147], a[68:71], v[48:51], v[144:147]
    v_accvgpr_read_b32 v17, a244
    v_mul_f32 v128, v128, v20
    v_mfma_f32_16x16x32_bf16 v[148:151], a[68:71], v[52:55], v[148:151]
    v_mul_f32 v129, v129, v20
    v_mul_f32 v130, v130, v20
    s_waitcnt lgkmcnt(5)
    v_mfma_f32_16x16x32_bf16 v[160:163], a[72:75], v[48:51], v[160:163]
    v_mul_f32 v131, v131, v20
    v_cvt_pk_bf16_f32 v128, v128, v129
    v_mfma_f32_16x16x32_bf16 v[164:167], a[72:75], v[52:55], v[164:167]
    v_mul_f32 v144, v144, v20
    v_mul_f32 v145, v145, v20
    v_mfma_f32_16x16x32_bf16 v[176:179], a[76:79], v[48:51], v[176:179]
    v_mul_f32 v146, v146, v20
    v_mul_f32 v147, v147, v20
    v_mfma_f32_16x16x32_bf16 v[180:183], a[76:79], v[52:55], v[180:183]
    v_cvt_pk_bf16_f32 v129, v130, v131
    v_cvt_pk_bf16_f32 v130, v144, v145
    v_mfma_f32_16x16x32_bf16 v[192:195], a[80:83], v[48:51], v[192:195]
    v_cvt_pk_bf16_f32 v131, v146, v147
    v_mul_f32 v160, v160, v20
    v_mfma_f32_16x16x32_bf16 v[196:199], a[80:83], v[52:55], v[196:199]
    buffer_store_dwordx4 v[128:131], v3, s[20:23], s40 offen offset:0 sc1
    v_mfma_f32_16x16x32_bf16 v[208:211], a[84:87], v[48:51], v[208:211]
    v_mul_f32 v161, v161, v20
    v_mul_f32 v162, v162, v20
    v_mfma_f32_16x16x32_bf16 v[212:215], a[84:87], v[52:55], v[212:215]
    v_mul_f32 v163, v163, v20
    v_cvt_pk_bf16_f32 v160, v160, v161
    s_waitcnt lgkmcnt(0)
    v_mfma_f32_16x16x32_bf16 v[224:227], a[88:91], v[48:51], v[224:227]
    v_mul_f32 v176, v176, v20
    v_mul_f32 v177, v177, v20
    ds_read_b128 a[104:107], v9 offset:33664
    v_mfma_f32_16x16x32_bf16 v[228:231], a[88:91], v[52:55], v[228:231]
    v_mul_f32 v178, v178, v20
    v_mul_f32 v179, v179, v20
    ds_read_b128 a[108:111], v9 offset:33728
    v_mfma_f32_16x16x32_bf16 v[240:243], a[92:95], v[48:51], v[240:243]
    v_cvt_pk_bf16_f32 v161, v162, v163
    v_cvt_pk_bf16_f32 v162, v176, v177
    ds_read_b128 a[112:115], v9 offset:33792
    v_mfma_f32_16x16x32_bf16 v[244:247], a[92:95], v[52:55], v[244:247]
    v_cvt_pk_bf16_f32 v163, v178, v179
    v_mul_f32 v192, v192, v20
    ds_read_b128 a[116:119], v9 offset:33856
    v_mfma_f32_16x16x32_bf16 v[72:75], a[96:99], a[32:35], v[24:27]
    buffer_store_dwordx4 v[160:163], v3, s[20:23], s40 offen offset:1024 sc1
    ds_read_b128 a[120:123], v9 offset:33920
    v_mfma_f32_16x16x32_bf16 v[72:75], a[100:103], a[36:39], v[72:75]
    v_mul_f32 v193, v193, v20
    v_mul_f32 v194, v194, v20
    v_mul_f32 v195, v195, v20
    v_cvt_pk_bf16_f32 v192, v192, v193
    v_mul_f32 v208, v208, v20
    v_mul_f32 v209, v209, v20
    v_mul_f32 v210, v210, v20
    v_mul_f32 v211, v211, v20
    v_cvt_pk_bf16_f32 v193, v194, v195
    ds_read_b128 a[124:127], v9 offset:33984
    s_waitcnt lgkmcnt(5)
    v_mfma_f32_16x16x32_bf16 v[72:75], a[104:107], a[40:43], v[72:75]
    v_cvt_pk_bf16_f32 v194, v208, v209
    v_cvt_pk_bf16_f32 v195, v210, v211
    s_waitcnt lgkmcnt(4)
    v_mfma_f32_16x16x32_bf16 v[72:75], a[108:111], a[44:47], v[72:75]
    buffer_store_dwordx4 v[192:195], v3, s[20:23], s40 offen offset:2048 sc1
    v_mul_f32 v224, v224, v20
    s_waitcnt lgkmcnt(3)
    v_mfma_f32_16x16x32_bf16 v[88:91], a[112:115], a[32:35], v[24:27]
    v_mul_f32 v225, v225, v20
    v_mul_f32 v226, v226, v20
    v_mul_f32 v227, v227, v20
    s_waitcnt lgkmcnt(2)
    v_mfma_f32_16x16x32_bf16 v[88:91], a[116:119], a[36:39], v[88:91]
    v_cvt_pk_bf16_f32 v224, v224, v225
    v_mul_f32 v240, v240, v20
    v_mul_f32 v241, v241, v20
    s_waitcnt lgkmcnt(1)
    v_mfma_f32_16x16x32_bf16 v[88:91], a[120:123], a[40:43], v[88:91]
    v_mul_f32 v242, v242, v20
    v_mul_f32 v243, v243, v20
    v_cvt_pk_bf16_f32 v225, v226, v227
    v_cvt_pk_bf16_f32 v226, v240, v241
    v_cvt_pk_bf16_f32 v227, v242, v243
    buffer_store_dwordx4 v[224:227], v3, s[20:23], s40 offen offset:3072 sc1
    v_rcp_f32 v21, v17
    s_add_u32 s40, s40, 131072
    s_waitcnt lgkmcnt(0)
    v_mfma_f32_16x16x32_bf16 v[88:91], a[124:127], a[44:47], v[88:91]
    v_mul_f32 v132, v132, v21
    v_mul_f32 v133, v133, v21
    v_mfma_f32_16x16x32_bf16 v[76:79], a[96:99], a[48:51], v[28:31]
    v_mul_f32 v134, v134, v21
    v_mul_f32 v135, v135, v21
    v_mfma_f32_16x16x32_bf16 v[76:79], a[100:103], a[52:55], v[76:79]
    v_cvt_pk_bf16_f32 v132, v132, v133
    v_mul_f32 v148, v148, v21
    v_mfma_f32_16x16x32_bf16 v[76:79], a[104:107], a[56:59], v[76:79]
    v_mul_f32 v149, v149, v21
    v_mul_f32 v150, v150, v21
    ds_read_b64_tr_b16 a[64:65], v10 offset:33536
    ds_read_b64_tr_b16 a[66:67], v10 offset:34048
    v_mfma_f32_16x16x32_bf16 v[76:79], a[108:111], a[60:63], v[76:79]
    v_mul_f32 v151, v151, v21
    v_cvt_pk_bf16_f32 v133, v134, v135
    v_mfma_f32_16x16x32_bf16 v[92:95], a[112:115], a[48:51], v[28:31]
    v_cvt_pk_bf16_f32 v134, v148, v149
    v_cvt_pk_bf16_f32 v135, v150, v151
    ds_read_b64_tr_b16 a[68:69], v10 offset:33568
    ds_read_b64_tr_b16 a[70:71], v10 offset:34080
    v_mfma_f32_16x16x32_bf16 v[92:95], a[116:119], a[52:55], v[92:95]
    buffer_store_dwordx4 v[132:135], v3, s[20:23], s40 offen offset:0 sc1
    v_mfma_f32_16x16x32_bf16 v[92:95], a[120:123], a[56:59], v[92:95]
    v_mul_f32 v164, v164, v21
    v_mul_f32 v165, v165, v21
    ds_read_b64_tr_b16 a[72:73], v10 offset:33600
    ds_read_b64_tr_b16 a[74:75], v10 offset:34112
    v_mfma_f32_16x16x32_bf16 v[92:95], a[124:127], a[60:63], v[92:95]
    v_mul_f32 v166, v166, v21
    v_mul_f32 v167, v167, v21
    v_cvt_pk_bf16_f32 v164, v164, v165
    v_mul_f32 v180, v180, v21
    v_mul_f32 v181, v181, v21
    v_mul_f32 v182, v182, v21
    v_mul_f32 v183, v183, v21
    v_cvt_pk_bf16_f32 v165, v166, v167
    v_cvt_pk_bf16_f32 v166, v180, v181
    v_exp_f32 v125, v125
    v_exp_f32 v126, v126
    v_exp_f32 v127, v127
    s_waitcnt lgkmcnt(4)
    v_mfma_f32_16x16x32_bf16 v[136:139], a[64:67], v[56:59], v[136:139]
    v_cvt_pk_bf16_f32 v167, v182, v183
    buffer_store_dwordx4 v[164:167], v3, s[20:23], s40 offen offset:1024 sc1
    v_mul_f32 v196, v196, v21
    v_mul_f32 v197, v197, v21
    v_mul_f32 v198, v198, v21
    v_mul_f32 v199, v199, v21
    v_cvt_pk_bf16_f32 v196, v196, v197
    v_mul_f32 v212, v212, v21
    v_mul_f32 v213, v213, v21
    v_mul_f32 v214, v214, v21
    v_mul_f32 v215, v215, v21
    v_cvt_pk_bf16_f32 v197, v198, v199
    v_cvt_pk_bf16_f32 v198, v212, v213
    v_cvt_pk_bf16_f32 v199, v214, v215
    v_cvt_pk_bf16_f32 v62, v124, v125
    v_cvt_pk_bf16_f32 v63, v126, v127
    ds_read_b64_tr_b16 a[76:77], v10 offset:33632
    ds_read_b64_tr_b16 a[78:79], v10 offset:34144
    v_mfma_f32_16x16x32_bf16 v[140:143], a[64:67], v[60:63], v[140:143]
    buffer_store_dwordx4 v[196:199], v3, s[20:23], s40 offen offset:2048 sc1
    s_waitcnt lgkmcnt(2)
    v_mfma_f32_16x16x32_bf16 v[152:155], a[68:71], v[56:59], v[152:155]
    ds_read_b64_tr_b16 a[80:81], v10 offset:33664
    ds_read_b64_tr_b16 a[82:83], v10 offset:34176
    v_mfma_f32_16x16x32_bf16 v[156:159], a[68:71], v[60:63], v[156:159]
    ds_read_b64_tr_b16 a[84:85], v10 offset:33696
    v_mul_f32 v228, v228, v21
    v_mfma_f32_16x16x32_bf16 v[168:171], a[72:75], v[56:59], v[168:171]
    ds_read_b64_tr_b16 a[86:87], v10 offset:34208
    ds_read_b64_tr_b16 a[88:89], v10 offset:33728
    v_mfma_f32_16x16x32_bf16 v[172:175], a[72:75], v[60:63], v[172:175]
    ds_read_b64_tr_b16 a[90:91], v10 offset:34240
    v_mul_f32 v229, v229, v21
    ds_read_b64_tr_b16 a[92:93], v10 offset:33760
    v_mul_f32 v230, v230, v21
    ds_read_b64_tr_b16 a[94:95], v10 offset:34272
    v_mul_f32 v231, v231, v21
    v_cvt_pk_bf16_f32 v228, v228, v229
    ds_read_b128 a[96:99], v9 offset:34048
    v_mul_f32 v244, v244, v21
    v_mul_f32 v245, v245, v21
    v_mul_f32 v246, v246, v21
    v_mul_f32 v247, v247, v21
    ds_read_b128 a[100:103], v9 offset:34112
    s_waitcnt lgkmcnt(10)
    v_mfma_f32_16x16x32_bf16 v[184:187], a[76:79], v[56:59], v[184:187]
    v_cvt_pk_bf16_f32 v229, v230, v231
    v_cvt_pk_bf16_f32 v230, v244, v245
    v_mfma_f32_16x16x32_bf16 v[188:191], a[76:79], v[60:63], v[188:191]
    ds_read_b128 a[104:107], v9 offset:34176
    v_cvt_pk_bf16_f32 v231, v246, v247
    s_waitcnt lgkmcnt(9)
    v_mfma_f32_16x16x32_bf16 v[200:203], a[80:83], v[56:59], v[200:203]
    ds_read_b128 a[108:111], v9 offset:34240
    buffer_store_dwordx4 v[228:231], v3, s[20:23], s40 offen offset:3072 sc1
    v_mfma_f32_16x16x32_bf16 v[204:207], a[80:83], v[60:63], v[204:207]
    ds_read_b128 a[112:115], v9 offset:34304
    s_waitcnt vmcnt(8)
    s_waitcnt lgkmcnt(8)
    v_mfma_f32_16x16x32_bf16 v[216:219], a[84:87], v[56:59], v[216:219]
    ds_read_b128 a[116:119], v9 offset:34368
    s_add_u32 s40, s40, 131072
    v_mfma_f32_16x16x32_bf16 v[220:223], a[84:87], v[60:63], v[220:223]
    v_exp_f32 v72, v72
    s_waitcnt lgkmcnt(6)
    v_mfma_f32_16x16x32_bf16 v[232:235], a[88:91], v[56:59], v[232:235]
    ds_read_b128 a[120:123], v9 offset:34432
    v_exp_f32 v73, v73
    v_mfma_f32_16x16x32_bf16 v[236:239], a[88:91], v[60:63], v[236:239]
    ds_read_b128 a[124:127], v9 offset:34496
    v_cvt_pk_bf16_f32 v40, v72, v73
    v_mfma_f32_16x16x32_bf16 v[248:251], a[92:95], v[56:59], v[248:251]
    ds_read_b64_tr_b16 a[64:65], v10 offset:41984
    v_exp_f32 v74, v74
    v_mfma_f32_16x16x32_bf16 v[252:255], a[92:95], v[60:63], v[252:255]
    ds_read_b64_tr_b16 a[66:67], v10 offset:42496
    ds_read_b64_tr_b16 a[68:69], v10 offset:42016
    v_mfma_f32_16x16x32_bf16 a[248:251], v[12:15], v[56:59], a[248:251]
    ds_read_b64_tr_b16 a[70:71], v10 offset:42528
    v_exp_f32 v75, v75
    v_mfma_f32_16x16x32_bf16 a[252:255], v[12:15], v[60:63], a[252:255]
    ds_read_b64_tr_b16 a[72:73], v10 offset:42048
    ds_read_b64_tr_b16 a[74:75], v10 offset:42560
    s_waitcnt lgkmcnt(8)
    v_mfma_f32_16x16x32_bf16 v[104:107], a[96:99], a[32:35], v[24:27]
    ds_read_b64_tr_b16 a[76:77], v10 offset:42080
    v_cvt_pk_bf16_f32 v41, v74, v75
    v_mfma_f32_16x16x32_bf16 v[104:107], a[100:103], a[36:39], v[104:107]
    ds_read_b64_tr_b16 a[78:79], v10 offset:42592
    ds_read_b64_tr_b16 a[80:81], v10 offset:42112
    v_mfma_f32_16x16x32_bf16 v[104:107], a[104:107], a[40:43], v[104:107]
    v_exp_f32 v88, v88
    v_mfma_f32_16x16x32_bf16 v[104:107], a[108:111], a[44:47], v[104:107]
    v_exp_f32 v89, v89
    v_mfma_f32_16x16x32_bf16 v[120:123], a[112:115], a[32:35], v[24:27]
    v_exp_f32 v90, v90
    v_mfma_f32_16x16x32_bf16 v[120:123], a[116:119], a[36:39], v[120:123]
    v_exp_f32 v91, v91
    s_waitcnt lgkmcnt(6)
    v_mfma_f32_16x16x32_bf16 v[120:123], a[120:123], a[40:43], v[120:123]
    ds_read_b64_tr_b16 a[82:83], v10 offset:42624
    v_cvt_pk_bf16_f32 v42, v88, v89
    v_mfma_f32_16x16x32_bf16 v[120:123], a[124:127], a[44:47], v[120:123]
    v_cvt_pk_bf16_f32 v43, v90, v91
    ds_read_b64_tr_b16 a[84:85], v10 offset:42144
    v_mfma_f32_16x16x32_bf16 v[108:111], a[96:99], a[48:51], v[28:31]
    ds_read_b64_tr_b16 a[86:87], v10 offset:42656
    ds_read_b64_tr_b16 a[88:89], v10 offset:42176
    v_mfma_f32_16x16x32_bf16 v[108:111], a[100:103], a[52:55], v[108:111]
    ds_read_b64_tr_b16 a[90:91], v10 offset:42688
    v_add_f32 v24, v16, v17
    v_mfma_f32_16x16x32_bf16 v[108:111], a[104:107], a[56:59], v[108:111]
    ds_read_b64_tr_b16 a[92:93], v10 offset:42208
    ds_read_b64_tr_b16 a[94:95], v10 offset:42720
    v_mfma_f32_16x16x32_bf16 v[108:111], a[108:111], a[60:63], v[108:111]
    ds_read_b64_tr_b16 a[96:97], v10 offset:50432
    v_mov_b32 v26, 163616
    v_mfma_f32_16x16x32_bf16 v[124:127], a[112:115], a[48:51], v[28:31]
    ds_read_b64_tr_b16 a[98:99], v10 offset:50944
    ds_read_b64_tr_b16 a[100:101], v10 offset:50464
    v_mfma_f32_16x16x32_bf16 v[124:127], a[116:119], a[52:55], v[124:127]
    ds_read_b64_tr_b16 a[102:103], v10 offset:50976
    v_exp_f32 v104, v104
    v_mfma_f32_16x16x32_bf16 v[124:127], a[120:123], a[56:59], v[124:127]
    ds_read_b64_tr_b16 a[104:105], v10 offset:50496
    ds_read_b64_tr_b16 a[106:107], v10 offset:51008
    v_mfma_f32_16x16x32_bf16 v[124:127], a[124:127], a[60:63], v[124:127]
    v_exp_f32 v105, v105
    v_mfma_f32_16x16x32_bf16 v[136:139], a[64:67], v[40:43], v[136:139]
    v_exp_f32 v106, v106
    s_waitcnt lgkmcnt(9)
    v_mfma_f32_16x16x32_bf16 v[152:155], a[68:71], v[40:43], v[152:155]
    v_exp_f32 v107, v107
    v_mfma_f32_16x16x32_bf16 v[168:171], a[72:75], v[40:43], v[168:171]
    v_exp_f32 v120, v120
    v_mfma_f32_16x16x32_bf16 v[184:187], a[76:79], v[40:43], v[184:187]
    v_exp_f32 v121, v121
    v_mfma_f32_16x16x32_bf16 v[200:203], a[80:83], v[40:43], v[200:203]
    v_exp_f32 v122, v122
    v_mfma_f32_16x16x32_bf16 v[216:219], a[84:87], v[40:43], v[216:219]
    v_exp_f32 v123, v123
    s_waitcnt lgkmcnt(2)
    v_mfma_f32_16x16x32_bf16 v[232:235], a[88:91], v[40:43], v[232:235]
    ds_read_b64_tr_b16 a[108:109], v10 offset:50528
    ds_read_b64_tr_b16 a[110:111], v10 offset:51040
    v_mfma_f32_16x16x32_bf16 v[248:251], a[92:95], v[40:43], v[248:251]
    v_cvt_pk_bf16_f32 v56, v104, v105
    v_cvt_pk_bf16_f32 v57, v106, v107
    v_mfma_f32_16x16x32_bf16 a[248:251], v[12:15], v[40:43], a[248:251]
    v_cvt_pk_bf16_f32 v58, v120, v121
    v_cvt_pk_bf16_f32 v59, v122, v123
    ds_read_b64_tr_b16 a[112:113], v10 offset:50560
    ds_read_b64_tr_b16 a[114:115], v10 offset:51072
    v_mfma_f32_16x16x32_bf16 a[248:251], v[12:15], v[56:59], a[248:251]
    ds_read_b64_tr_b16 a[116:117], v10 offset:50592
    v_exp_f32 v76, v76
    ds_read_b64_tr_b16 a[118:119], v10 offset:51104
    v_mfma_f32_16x16x32_bf16 v[136:139], a[96:99], v[56:59], v[136:139]
    ds_read_b64_tr_b16 a[120:121], v10 offset:50624
    ds_read_b64_tr_b16 a[122:123], v10 offset:51136
    v_mfma_f32_16x16x32_bf16 v[152:155], a[100:103], v[56:59], v[152:155]
    ds_read_b64_tr_b16 a[124:125], v10 offset:50656
    v_accvgpr_read_b32 v18, a248
    ds_read_b64_tr_b16 a[126:127], v10 offset:51168
    s_waitcnt lgkmcnt(10)
    v_mfma_f32_16x16x32_bf16 v[168:171], a[104:107], v[56:59], v[168:171]
    v_rcp_f32 v22, v18
    v_exp_f32 v77, v77
    s_waitcnt lgkmcnt(8)
    v_mfma_f32_16x16x32_bf16 v[184:187], a[108:111], v[56:59], v[184:187]
    v_exp_f32 v78, v78
    v_exp_f32 v79, v79
    v_exp_f32 v92, v92
    v_exp_f32 v93, v93
    s_waitcnt lgkmcnt(6)
    v_mfma_f32_16x16x32_bf16 v[200:203], a[112:115], v[56:59], v[200:203]
    v_exp_f32 v94, v94
    v_exp_f32 v95, v95
    s_waitcnt lgkmcnt(4)
    v_mfma_f32_16x16x32_bf16 v[216:219], a[116:119], v[56:59], v[216:219]
    v_mul_f32 v136, v136, v22
    v_mul_f32 v137, v137, v22
    s_waitcnt lgkmcnt(2)
    v_mfma_f32_16x16x32_bf16 v[232:235], a[120:123], v[56:59], v[232:235]
    v_mul_f32 v138, v138, v22
    v_mul_f32 v139, v139, v22
    v_cvt_pk_bf16_f32 v136, v136, v137
    s_waitcnt lgkmcnt(0)
    v_mfma_f32_16x16x32_bf16 v[248:251], a[124:127], v[56:59], v[248:251]
    s_cmp_eq_u32 s50, 1
    s_cbranch_scc1 L_keys
L_nokeys:
    v_mul_f32 v152, v152, v22
    v_mul_f32 v153, v153, v22
    v_mul_f32 v154, v154, v22
    v_mul_f32 v155, v155, v22
    v_cvt_pk_bf16_f32 v137, v138, v139
    v_cvt_pk_bf16_f32 v44, v76, v77
    v_cvt_pk_bf16_f32 v45, v78, v79
    v_cvt_pk_bf16_f32 v46, v92, v93
    v_cvt_pk_bf16_f32 v47, v94, v95
    v_cvt_pk_bf16_f32 v138, v152, v153
    v_cvt_pk_bf16_f32 v139, v154, v155
    v_mfma_f32_16x16x32_bf16 v[140:143], a[64:67], v[44:47], v[140:143]
    buffer_store_dwordx4 v[136:139], v3, s[20:23], s40 offen offset:0 sc1
    v_mfma_f32_16x16x32_bf16 v[156:159], a[68:71], v[44:47], v[156:159]
    v_mul_f32 v168, v168, v22
    v_mul_f32 v169, v169, v22
    v_mfma_f32_16x16x32_bf16 v[172:175], a[72:75], v[44:47], v[172:175]
    v_mul_f32 v170, v170, v22
    v_mul_f32 v171, v171, v22
    v_cvt_pk_bf16_f32 v168, v168, v169
    v_mfma_f32_16x16x32_bf16 v[188:191], a[76:79], v[44:47], v[188:191]
    v_mul_f32 v184, v184, v22
    v_mul_f32 v185, v185, v22
    v_mul_f32 v186, v186, v22
    v_mul_f32 v187, v187, v22
    v_cvt_pk_bf16_f32 v169, v170, v171
    v_cvt_pk_bf16_f32 v170, v184, v185
    v_cvt_pk_bf16_f32 v171, v186, v187
    buffer_store_dwordx4 v[168:171], v3, s[20:23], s40 offen offset:1024 sc1
    v_mfma_f32_16x16x32_bf16 v[204:207], a[80:83], v[44:47], v[204:207]
    v_mul_f32 v200, v200, v22
    v_mul_f32 v201, v201, v22
    v_mfma_f32_16x16x32_bf16 v[220:223], a[84:87], v[44:47], v[220:223]
    v_mul_f32 v202, v202, v22
    v_mul_f32 v203, v203, v22
    v_mfma_f32_16x16x32_bf16 v[236:239], a[88:91], v[44:47], v[236:239]
    v_cvt_pk_bf16_f32 v200, v200, v201
    v_mul_f32 v216, v216, v22
    v_mul_f32 v217, v217, v22
    v_mul_f32 v218, v218, v22
    v_mul_f32 v219, v219, v22
    v_cvt_pk_bf16_f32 v201, v202, v203
    v_cvt_pk_bf16_f32 v202, v216, v217
    v_cvt_pk_bf16_f32 v203, v218, v219
    v_mfma_f32_16x16x32_bf16 v[252:255], a[92:95], v[44:47], v[252:255]
    buffer_store_dwordx4 v[200:203], v3, s[20:23], s40 offen offset:2048 sc1
    v_exp_f32 v108, v108
    v_exp_f32 v109, v109
    v_exp_f32 v110, v110
    v_exp_f32 v111, v111
    v_exp_f32 v124, v124
    v_exp_f32 v125, v125
    v_exp_f32 v126, v126
    v_exp_f32 v127, v127
    v_mfma_f32_16x16x32_bf16 a[252:255], v[12:15], v[44:47], a[252:255]
    v_cvt_pk_bf16_f32 v60, v108, v109
    v_cvt_pk_bf16_f32 v61, v110, v111
    v_cvt_pk_bf16_f32 v62, v124, v125
    v_cvt_pk_bf16_f32 v63, v126, v127
    v_mul_f32 v232, v232, v22
    v_mul_f32 v233, v233, v22
    v_mfma_f32_16x16x32_bf16 a[252:255], v[12:15], v[60:63], a[252:255]
    v_mul_f32 v234, v234, v22
    v_mul_f32 v235, v235, v22
    v_cvt_pk_bf16_f32 v232, v232, v233
    v_mfma_f32_16x16x32_bf16 v[140:143], a[96:99], v[60:63], v[140:143]
    v_mul_f32 v248, v248, v22
    v_mul_f32 v249, v249, v22
    v_mul_f32 v250, v250, v22
    v_mul_f32 v251, v251, v22
    v_cvt_pk_bf16_f32 v233, v234, v235
    v_cvt_pk_bf16_f32 v234, v248, v249
    v_cvt_pk_bf16_f32 v235, v250, v251
    buffer_store_dwordx4 v[232:235], v3, s[20:23], s40 offen offset:3072 sc1
    v_mfma_f32_16x16x32_bf16 v[156:159], a[100:103], v[60:63], v[156:159]
    v_accvgpr_read_b32 v19, a252
    s_add_u32 s40, s40, 131072
    v_rcp_f32 v23, v19
    v_mfma_f32_16x16x32_bf16 v[172:175], a[104:107], v[60:63], v[172:175]
    v_mul_f32 v140, v140, v23
    v_mul_f32 v141, v141, v23
    v_mul_f32 v142, v142, v23
    v_mul_f32 v143, v143, v23
    v_cvt_pk_bf16_f32 v140, v140, v141
    v_mul_f32 v156, v156, v23
    v_mul_f32 v157, v157, v23
    v_mul_f32 v158, v158, v23
    v_mul_f32 v159, v159, v23
    v_cvt_pk_bf16_f32 v141, v142, v143
    v_cvt_pk_bf16_f32 v142, v156, v157
    v_cvt_pk_bf16_f32 v143, v158, v159
    buffer_store_dwordx4 v[140:143], v3, s[20:23], s40 offen offset:0 sc1
    v_mfma_f32_16x16x32_bf16 v[188:191], a[108:111], v[60:63], v[188:191]
    v_mul_f32 v172, v172, v23
    v_mul_f32 v173, v173, v23
    v_mul_f32 v174, v174, v23
    v_mul_f32 v175, v175, v23
    v_cvt_pk_bf16_f32 v172, v172, v173
    v_mfma_f32_16x16x32_bf16 v[204:207], a[112:115], v[60:63], v[204:207]
    v_cvt_pk_bf16_f32 v173, v174, v175
    v_add_f32 v25, v18, v19
    v_mul_f32 v188, v188, v23
    v_mul_f32 v189, v189, v23
    v_mul_f32 v190, v190, v23
    v_mul_f32 v191, v191, v23
    v_cvt_pk_bf16_f32 v174, v188, v189
    v_cvt_pk_bf16_f32 v175, v190, v191
    buffer_store_dwordx4 v[172:175], v3, s[20:23], s40 offen offset:1024 sc1
    v_mfma_f32_16x16x32_bf16 v[220:223], a[116:119], v[60:63], v[220:223]
    v_mul_f32 v204, v204, v23
    v_mul_f32 v205, v205, v23
    v_mul_f32 v206, v206, v23
    v_mul_f32 v207, v207, v23
    v_cvt_pk_bf16_f32 v204, v204, v205
    v_mfma_f32_16x16x32_bf16 v[236:239], a[120:123], v[60:63], v[236:239]
    v_cvt_pk_bf16_f32 v205, v206, v207
    v_add_f32 v24, v24, v25
    v_mul_f32 v220, v220, v23
    v_mul_f32 v221, v221, v23
    v_mul_f32 v222, v222, v23
    v_mul_f32 v223, v223, v23
    v_cvt_pk_bf16_f32 v206, v220, v221
    v_cvt_pk_bf16_f32 v207, v222, v223
    buffer_store_dwordx4 v[204:207], v3, s[20:23], s40 offen offset:2048 sc1
    v_mfma_f32_16x16x32_bf16 v[252:255], a[124:127], v[60:63], v[252:255]
    v_mul_f32 v236, v236, v23
    v_mul_f32 v237, v237, v23
    v_mul_f32 v238, v238, v23
    v_mul_f32 v239, v239, v23
    v_cvt_pk_bf16_f32 v236, v236, v237
    v_cvt_pk_bf16_f32 v237, v238, v239
    v_cmp_nge_f32 vcc, 0x53800000, v24
    s_nop 0
    s_mov_b64 exec, vcc
    ds_write_b32 v26, v26
    s_mov_b64 exec, -1
    v_mul_f32 v252, v252, v23
    v_mul_f32 v253, v253, v23
    v_mul_f32 v254, v254, v23
    v_mul_f32 v255, v255, v23
    v_cvt_pk_bf16_f32 v238, v252, v253
    v_cvt_pk_bf16_f32 v239, v254, v255
    buffer_store_dwordx4 v[236:239], v3, s[20:23], s40 offen offset:3072 sc1
    s_waitcnt lgkmcnt(0)
    s_barrier
    ds_read_b32 v27, v26
    v_subrev_u32 v4, 100608, v6
    s_mov_b32 s4, s64
    s_mov_b32 s5, s65
    s_mov_b32 s6, 0x200000
    s_mov_b32 s7, 0x20000
    v_mov_b32 v29, v2
    v_lshrrev_b32 v2, 4, v3
    v_lshrrev_b32 v13, 4, v2
    s_lshl_b32 s31, s52, 19
    s_lshl_b32 s36, s3, 14
    s_add_u32 s31, s31, s36
    s_and_b32 s38, s52, 1
    s_lshl_b32 s36, s38, 16
    s_add_u32 s31, s31, s36
    s_lshl_b32 s36, s30, 10
    s_add_u32 s31, s31, s36
    s_lshl_b32 s46, s52, 16
    s_lshl_b32 s36, s53, 7
    s_add_u32 s46, s46, s36
    s_lshl_b32 s36, s3, 14
    s_add_u32 s46, s46, s36
    v_and_b32 v12, 15, v2
    v_lshlrev_b32 v11, 10, v12
    v_lshl_add_u32 v11, v13, 3, v11
    v_lshlrev_b32 v14, 6, v12
    s_lshl_b32 s36, s52, 12
    s_lshl_b32 s37, s3, 10
    s_add_u32 s36, s36, s37
    s_add_u32 s48, s36, 24117248
    v_lshlrev_b32 v16, 2, v2
    v_mov_b32 v17, s35
    v_lshl_add_u32 v7, s3, 17, v3
    v_xor_b32 v8, 0x20000, v7
    v_xor_b32 v9, 0x40000, v7
    v_xor_b32 v10, 0x60000, v7
    v_and_b32 v18, 7, v2
    v_lshlrev_b32 v18, 2, v18
    v_and_b32 v15, 12, v18
    v_lshlrev_b32 v1, 5, v15
    s_xor_b32 s51, s52, 1
    s_lshl_b32 s51, s51, 12
    s_lshl_b32 s37, s38, 11
    s_add_u32 s51, s51, s37
    s_lshl_b32 s37, s3, 9
    s_add_u32 s51, s51, s37
    s_add_u32 s51, s51, 24248320
    s_waitcnt lgkmcnt(0)
    v_readfirstlane_b32 s37, v27
    s_nop 0
    s_cmp_lg_u32 s37, 0
    s_cbranch_scc1 L_slow
L_slow_back:
    s_cmp_eq_u32 s50, 1
    s_cbranch_scc1 L_prod1
L_prod1b:
    ds_read_b64_tr_b16 a[208:209], v6 offset:41984
    ds_read_b64_tr_b16 a[210:211], v6 offset:42496
    ds_read_b64_tr_b16 a[212:213], v6 offset:42016
    ds_read_b64_tr_b16 a[214:215], v6 offset:42528
    ds_read_b64_tr_b16 a[216:217], v6 offset:42048
    ds_read_b64_tr_b16 a[218:219], v6 offset:42560
    ds_read_b64_tr_b16 a[220:221], v6 offset:42080
    ds_read_b64_tr_b16 a[222:223], v6 offset:42592
    ds_read_b64_tr_b16 a[64:65], v4 offset:0
    ds_read_b64_tr_b16 a[66:67], v4 offset:512
    ds_read_b64_tr_b16 a[68:69], v4 offset:32
    ds_read_b64_tr_b16 a[70:71], v4 offset:544
    ds_read_b64_tr_b16 a[72:73], v4 offset:64
    ds_read_b64_tr_b16 a[74:75], v4 offset:576
    ds_read_b64_tr_b16 a[76:77], v4 offset:96
    ds_read_b64_tr_b16 a[78:79], v4 offset:608
    ds_read_b64_tr_b16 a[80:81], v4 offset:16768
    ds_read_b64_tr_b16 a[82:83], v4 offset:17280
    ds_read_b64_tr_b16 a[84:85], v4 offset:16800
    ds_read_b64_tr_b16 a[86:87], v4 offset:17312
    ds_read_b64_tr_b16 a[88:89], v4 offset:16832
    ds_read_b64_tr_b16 a[90:91], v4 offset:17344
    ds_read_b64_tr_b16 a[92:93], v4 offset:16864
    ds_read_b64_tr_b16 a[94:95], v4 offset:17376
    s_xor_b32 s41, s32, 262144
    s_add_u32 m0, s33, 33536
    s_nop 0
    buffer_load_dwordx4 v5, s[8:11], s41 offen offset:0 lds
    s_add_u32 m0, s33, 33568
    s_nop 0
    buffer_load_dwordx4 v5, s[8:11], s41 offen offset:1024 lds
    s_add_u32 m0, s33, 33600
    s_nop 0
    buffer_load_dwordx4 v5, s[8:11], s41 offen offset:2048 lds
    s_add_u32 m0, s33, 33632
    s_nop 0
    buffer_load_dwordx4 v5, s[8:11], s41 offen offset:3072 lds
    s_xor_b32 s41, s32, 294912
    s_add_u32 m0, s33, 100608
    s_nop 0
    buffer_load_dwordx4 v5, s[8:11], s41 offen offset:0 lds
    s_add_u32 m0, s33, 100640
    s_nop 0
    buffer_load_dwordx4 v5, s[8:11], s41 offen offset:1024 lds
    s_add_u32 m0, s33, 100672
    s_nop 0
    buffer_load_dwordx4 v5, s[8:11], s41 offen offset:2048 lds
    s_add_u32 m0, s33, 100704
    s_nop 0
    buffer_load_dwordx4 v5, s[8:11], s41 offen offset:3072 lds
    s_cmp_eq_u32 s50, 1
    s_cbranch_scc1 L_noflag
    s_waitcnt vmcnt(8)
    s_mov_b32 exec_lo, 0xffffffff
    s_mov_b32 exec_hi, 0
    buffer_store_dword v17, v16, s[20:23], s25 offen sc1
    s_mov_b64 exec, -1
L_noflag:
    s_waitcnt lgkmcnt(0)
    s_xor_b32 s41, s32, 327680
    s_add_u32 m0, s33, 117376
    s_nop 0
    buffer_load_dwordx4 v5, s[8:11], s41 offen offset:0 lds
    s_add_u32 m0, s33, 117408
    s_nop 0
    buffer_load_dwordx4 v5, s[8:11], s41 offen offset:1024 lds
    s_add_u32 m0, s33, 117440
    s_nop 0
    buffer_load_dwordx4 v5, s[8:11], s41 offen offset:2048 lds
    s_add_u32 m0, s33, 117472
    s_nop 0
    buffer_load_dwordx4 v5, s[8:11], s41 offen offset:3072 lds
    s_xor_b32 s41, s32, 360448
    s_add_u32 m0, s33, 142592
    s_nop 0
    buffer_load_dwordx4 v5, s[8:11], s41 offen offset:0 lds
    s_add_u32 m0, s33, 142624
    s_nop 0
    buffer_load_dwordx4 v5, s[8:11], s41 offen offset:1024 lds
    s_add_u32 m0, s33, 142656
    s_nop 0
    buffer_load_dwordx4 v5, s[8:11], s41 offen offset:2048 lds
    s_add_u32 m0, s33, 142688
    s_nop 0
    buffer_load_dwordx4 v5, s[8:11], s41 offen offset:3072 lds
    s_xor_b32 s41, s32, 393216
    s_add_u32 m0, s33, 0
    s_nop 0
    buffer_load_dwordx4 v5, s[8:11], s41 offen offset:0 lds
    s_add_u32 m0, s33, 32
    s_nop 0
    buffer_load_dwordx4 v5, s[8:11], s41 offen offset:1024 lds
    s_add_u32 m0, s33, 64
    s_nop 0
    buffer_load_dwordx4 v5, s[8:11], s41 offen offset:2048 lds
    s_add_u32 m0, s33, 96
    s_nop 0
    buffer_load_dwordx4 v5, s[8:11], s41 offen offset:3072 lds
    s_xor_b32 s41, s32, 425984
    s_add_u32 m0, s33, 16768
    s_nop 0
    buffer_load_dwordx4 v5, s[8:11], s41 offen offset:0 lds
    s_add_u32 m0, s33, 16800
    s_nop 0
    buffer_load_dwordx4 v5, s[8:11], s41 offen offset:1024 lds
    s_add_u32 m0, s33, 16832
    s_nop 0
    buffer_load_dwordx4 v5, s[8:11], s41 offen offset:2048 lds
    s_add_u32 m0, s33, 16864
    s_nop 0
    buffer_load_dwordx4 v5, s[8:11], s41 offen offset:3072 lds
    s_branch L_g3
L_gback:
    s_cmp_eq_u32 s50, 1
    s_cbranch_scc1 L_prod
L_noprod:
    s_waitcnt vmcnt(16)
    ds_read_b64_tr_b16 a[224:225], v4 offset:33536
    ds_read_b64_tr_b16 a[226:227], v4 offset:34048
    ds_read_b64_tr_b16 a[228:229], v4 offset:33568
    ds_read_b64_tr_b16 a[230:231], v4 offset:34080
    ds_read_b64_tr_b16 a[232:233], v4 offset:33600
    ds_read_b64_tr_b16 a[234:235], v4 offset:34112
    ds_read_b64_tr_b16 a[236:237], v4 offset:33632
    ds_read_b64_tr_b16 a[238:239], v4 offset:34144
    ds_read_b64_tr_b16 a[96:97], v6 offset:0
    ds_read_b64_tr_b16 a[98:99], v6 offset:512
    ds_read_b64_tr_b16 a[100:101], v6 offset:32
    ds_read_b64_tr_b16 a[102:103], v6 offset:544
    ds_read_b64_tr_b16 a[104:105], v6 offset:64
    ds_read_b64_tr_b16 a[106:107], v6 offset:576
    ds_read_b64_tr_b16 a[108:109], v6 offset:96
    ds_read_b64_tr_b16 a[110:111], v6 offset:608
    buffer_load_dword v19, v1, s[20:23], s51 offen sc1
    s_waitcnt lgkmcnt(0)
    s_xor_b32 s41, s32, 458752
    s_add_u32 m0, s33, 33536
    s_nop 0
    buffer_load_dwordx4 v5, s[8:11], s41 offen offset:0 lds
    s_add_u32 m0, s33, 33568
    s_nop 0
    buffer_load_dwordx4 v5, s[8:11], s41 offen offset:1024 lds
    s_add_u32 m0, s33, 33600
    s_nop 0
    buffer_load_dwordx4 v5, s[8:11], s41 offen offset:2048 lds
    s_add_u32 m0, s33, 33632
    s_nop 0
    buffer_load_dwordx4 v5, s[8:11], s41 offen offset:3072 lds
    s_xor_b32 s41, s32, 491520
    s_add_u32 m0, s33, 100608
    s_nop 0
    buffer_load_dwordx4 v5, s[8:11], s41 offen offset:0 lds
    s_add_u32 m0, s33, 100640
    s_nop 0
    buffer_load_dwordx4 v5, s[8:11], s41 offen offset:1024 lds
    s_add_u32 m0, s33, 100672
    s_nop 0
    buffer_load_dwordx4 v5, s[8:11], s41 offen offset:2048 lds
    s_add_u32 m0, s33, 100704
    s_nop 0
    buffer_load_dwordx4 v5, s[8:11], s41 offen offset:3072 lds
    s_waitcnt vmcnt(8)
    v_cmp_ne_u32 vcc, s35, v19
    s_nop 0
    s_cmp_lg_u64 vcc, 0
    s_cbranch_scc1 L_fp
L_fp_ok:
    s_xor_b32 s40, s31, 524288
    buffer_load_dwordx4 v[128:131], v7, s[20:23], s40 offen sc1
    buffer_load_dwordx4 v[132:135], v8, s[20:23], s40 offen sc1
    buffer_load_dwordx4 v[136:139], v9, s[20:23], s40 offen sc1
    buffer_load_dwordx4 v[140:143], v10, s[20:23], s40 offen sc1
    ds_read_b64_tr_b16 a[112:113], v6 offset:16768
    ds_read_b64_tr_b16 a[114:115], v6 offset:17280
    ds_read_b64_tr_b16 a[116:117], v6 offset:16800
    ds_read_b64_tr_b16 a[118:119], v6 offset:17312
    ds_read_b64_tr_b16 a[120:121], v6 offset:16832
    ds_read_b64_tr_b16 a[122:123], v6 offset:17344
    ds_read_b64_tr_b16 a[124:125], v6 offset:16864
    ds_read_b64_tr_b16 a[126:127], v6 offset:17376
    s_xor_b32 s40, s31, 525312
    buffer_load_dwordx4 v[144:147], v7, s[20:23], s40 offen sc1
    buffer_load_dwordx4 v[148:151], v8, s[20:23], s40 offen sc1
    buffer_load_dwordx4 v[152:155], v9, s[20:23], s40 offen sc1
    buffer_load_dwordx4 v[156:159], v10, s[20:23], s40 offen sc1
    ds_read_b64_tr_b16 a[240:241], v6 offset:41984
    ds_read_b64_tr_b16 a[242:243], v6 offset:42496
    ds_read_b64_tr_b16 a[244:245], v6 offset:42016
    ds_read_b64_tr_b16 a[246:247], v6 offset:42528
    ds_read_b64_tr_b16 a[248:249], v6 offset:42048
    ds_read_b64_tr_b16 a[250:251], v6 offset:42560
    ds_read_b64_tr_b16 a[252:253], v6 offset:42080
    ds_read_b64_tr_b16 a[254:255], v6 offset:42592
    s_xor_b32 s40, s31, 526336
    buffer_load_dwordx4 v[160:163], v7, s[20:23], s40 offen sc1
    buffer_load_dwordx4 v[164:167], v8, s[20:23], s40 offen sc1
    buffer_load_dwordx4 v[168:171], v9, s[20:23], s40 offen sc1
    buffer_load_dwordx4 v[172:175], v10, s[20:23], s40 offen sc1
    ds_read_b64_tr_b16 a[0:1], v4 offset:0
    ds_read_b64_tr_b16 a[2:3], v4 offset:512
    ds_read_b64_tr_b16 a[4:5], v4 offset:32
    ds_read_b64_tr_b16 a[6:7], v4 offset:544
    ds_read_b64_tr_b16 a[8:9], v4 offset:64
    ds_read_b64_tr_b16 a[10:11], v4 offset:576
    ds_read_b64_tr_b16 a[12:13], v4 offset:96
    ds_read_b64_tr_b16 a[14:15], v4 offset:608
    s_xor_b32 s40, s31, 527360
    buffer_load_dwordx4 v[176:179], v7, s[20:23], s40 offen sc1
    buffer_load_dwordx4 v[180:183], v8, s[20:23], s40 offen sc1
    buffer_load_dwordx4 v[184:187], v9, s[20:23], s40 offen sc1
    buffer_load_dwordx4 v[188:191], v10, s[20:23], s40 offen sc1
    ds_read_b64_tr_b16 a[16:17], v4 offset:16768
    ds_read_b64_tr_b16 a[18:19], v4 offset:17280
    ds_read_b64_tr_b16 a[20:21], v4 offset:16800
    ds_read_b64_tr_b16 a[22:23], v4 offset:17312
    ds_read_b64_tr_b16 a[24:25], v4 offset:16832
    ds_read_b64_tr_b16 a[26:27], v4 offset:17344
    ds_read_b64_tr_b16 a[28:29], v4 offset:16864
    ds_read_b64_tr_b16 a[30:31], v4 offset:17376
    s_waitcnt lgkmcnt(0)
    s_waitcnt vmcnt(12)
    v_mfma_f32_16x16x32_bf16 v[240:243], a[128:131], v[128:131], 0
    s_xor_b32 s40, s31, 528384
    s_xor_b32 s51, s51, 4096
    v_mfma_f32_16x16x32_bf16 v[244:247], a[132:135], v[128:131], 0
    s_xor_b32 s41, s3, 1
    s_mul_i32 s41, s41, 4192
    v_mfma_f32_16x16x32_bf16 v[248:251], a[136:139], v[128:131], 0
    s_add_u32 s41, s41, 100608
    s_mul_i32 s32, s3, 6144
    v_mfma_f32_16x16x32_bf16 v[252:255], a[140:143], v[128:131], 0
    buffer_load_dwordx4 v[128:131], v7, s[20:23], s40 offen sc1
    v_mfma_f32_16x16x32_bf16 v[80:83], a[128:131], v[132:135], 0
    s_add_u32 s32, s32, 17825792
    v_mfma_f32_16x16x32_bf16 v[84:87], a[132:135], v[132:135], 0
    v_mfma_f32_16x16x32_bf16 v[88:91], a[136:139], v[132:135], 0
    v_mfma_f32_16x16x32_bf16 v[92:95], a[140:143], v[132:135], 0
    buffer_load_dwordx4 v[132:135], v8, s[20:23], s40 offen sc1
    v_mfma_f32_16x16x32_bf16 v[96:99], a[128:131], v[136:139], 0
    v_mfma_f32_16x16x32_bf16 v[100:103], a[132:135], v[136:139], 0
    v_mfma_f32_16x16x32_bf16 v[104:107], a[136:139], v[136:139], 0
    v_mfma_f32_16x16x32_bf16 v[108:111], a[140:143], v[136:139], 0
    buffer_load_dwordx4 v[136:139], v9, s[20:23], s40 offen sc1
    v_mfma_f32_16x16x32_bf16 v[112:115], a[128:131], v[140:143], 0
    v_mfma_f32_16x16x32_bf16 v[116:119], a[132:135], v[140:143], 0
    v_mfma_f32_16x16x32_bf16 v[120:123], a[136:139], v[140:143], 0
    v_mfma_f32_16x16x32_bf16 v[124:127], a[140:143], v[140:143], 0
    buffer_load_dwordx4 v[140:143], v10, s[20:23], s40 offen sc1
    s_xor_b32 s40, s31, 529408
    buffer_load_dwordx2 v[24:25], v11, s[4:7], s46 offen offset:0
    buffer_load_dwordx2 v[26:27], v11, s[4:7], s46 offen offset:32
    buffer_load_dwordx2 v[28:29], v11, s[4:7], s46 offen offset:64
    buffer_load_dwordx2 v[30:31], v11, s[4:7], s46 offen offset:96
    buffer_load_dwordx2 v[22:23], v14, s[20:23], s48 offen sc1
    s_cmp_eq_u32 s50, 1
    s_cbranch_scc1 L_psig
L_psigb:
    s_waitcnt vmcnt(17)
    v_mfma_f32_16x16x32_bf16 v[240:243], a[144:147], v[144:147], v[240:243]
    ds_read_b64_tr_b16 a[32:33], v4 offset:33536
    ds_read_b64_tr_b16 a[34:35], v4 offset:34048
    v_mfma_f32_16x16x32_bf16 v[244:247], a[148:151], v[144:147], v[244:247]
    ds_read_b64_tr_b16 a[36:37], v4 offset:33568
    v_mfma_f32_16x16x32_bf16 v[248:251], a[152:155], v[144:147], v[248:251]
    ds_read_b64_tr_b16 a[38:39], v4 offset:34080
    ds_read_b64_tr_b16 a[40:41], v4 offset:33600
    v_mfma_f32_16x16x32_bf16 v[252:255], a[156:159], v[144:147], v[252:255]
    buffer_load_dwordx4 v[144:147], v7, s[20:23], s40 offen sc1
    v_mfma_f32_16x16x32_bf16 v[80:83], a[144:147], v[148:151], v[80:83]
    ds_read_b64_tr_b16 a[42:43], v4 offset:34112
    ds_read_b64_tr_b16 a[44:45], v4 offset:33632
    v_mfma_f32_16x16x32_bf16 v[84:87], a[148:151], v[148:151], v[84:87]
    ds_read_b64_tr_b16 a[46:47], v4 offset:34144
    v_add_u32 v4, s41, v3
    v_mfma_f32_16x16x32_bf16 v[88:91], a[152:155], v[148:151], v[88:91]
    s_xor_b32 s41, s3, 2
    s_mul_i32 s41, s41, 4192
    v_mfma_f32_16x16x32_bf16 v[92:95], a[156:159], v[148:151], v[92:95]
    buffer_load_dwordx4 v[148:151], v8, s[20:23], s40 offen sc1
    v_mfma_f32_16x16x32_bf16 v[96:99], a[144:147], v[152:155], v[96:99]
    s_add_u32 s41, s41, 100608
    v_add_u32 v5, s41, v3
    v_mfma_f32_16x16x32_bf16 v[100:103], a[148:151], v[152:155], v[100:103]
    s_xor_b32 s41, s3, 3
    s_mul_i32 s41, s41, 4192
    v_mfma_f32_16x16x32_bf16 v[104:107], a[152:155], v[152:155], v[104:107]
    s_add_u32 s41, s41, 100608
    v_mfma_f32_16x16x32_bf16 v[108:111], a[156:159], v[152:155], v[108:111]
    buffer_load_dwordx4 v[152:155], v9, s[20:23], s40 offen sc1
    v_mfma_f32_16x16x32_bf16 v[112:115], a[144:147], v[156:159], v[112:115]
    v_mfma_f32_16x16x32_bf16 v[116:119], a[148:151], v[156:159], v[116:119]
    v_mfma_f32_16x16x32_bf16 v[120:123], a[152:155], v[156:159], v[120:123]
    v_mfma_f32_16x16x32_bf16 v[124:127], a[156:159], v[156:159], v[124:127]
    buffer_load_dwordx4 v[156:159], v10, s[20:23], s40 offen sc1
    s_waitcnt vmcnt(17)
    v_mfma_f32_16x16x32_bf16 v[240:243], a[160:163], v[160:163], v[240:243]
    s_xor_b32 s40, s31, 530432
    ds_read_b64_tr_b16 a[48:49], v6 offset:0
    v_mfma_f32_16x16x32_bf16 v[244:247], a[164:167], v[160:163], v[244:247]
    ds_read_b64_tr_b16 a[50:51], v6 offset:512
    ds_read_b64_tr_b16 a[52:53], v6 offset:32
    v_mfma_f32_16x16x32_bf16 v[248:251], a[168:171], v[160:163], v[248:251]
    ds_read_b64_tr_b16 a[54:55], v6 offset:544
    v_mfma_f32_16x16x32_bf16 v[252:255], a[172:175], v[160:163], v[252:255]
    buffer_load_dwordx4 v[160:163], v7, s[20:23], s40 offen sc1
    v_mfma_f32_16x16x32_bf16 v[80:83], a[160:163], v[164:167], v[80:83]
    ds_read_b64_tr_b16 a[56:57], v6 offset:64
    ds_read_b64_tr_b16 a[58:59], v6 offset:576
    v_mfma_f32_16x16x32_bf16 v[84:87], a[164:167], v[164:167], v[84:87]
    ds_read_b64_tr_b16 a[60:61], v6 offset:96
    v_mfma_f32_16x16x32_bf16 v[88:91], a[168:171], v[164:167], v[88:91]
    ds_read_b64_tr_b16 a[62:63], v6 offset:608
    v_add_u32 v6, s41, v3
    v_mfma_f32_16x16x32_bf16 v[92:95], a[172:175], v[164:167], v[92:95]
    buffer_load_dwordx4 v[164:167], v8, s[20:23], s40 offen sc1
    v_mfma_f32_16x16x32_bf16 v[96:99], a[160:163], v[168:171], v[96:99]
    s_mul_i32 s41, s2, 24576
    s_add_u32 s41, s41, s32
    v_mfma_f32_16x16x32_bf16 v[100:103], a[164:167], v[168:171], v[100:103]
    v_mfma_f32_16x16x32_bf16 v[104:107], a[168:171], v[168:171], v[104:107]
    v_mfma_f32_16x16x32_bf16 v[108:111], a[172:175], v[168:171], v[108:111]
    buffer_load_dwordx4 v[168:171], v9, s[20:23], s40 offen sc1
    v_mfma_f32_16x16x32_bf16 v[112:115], a[160:163], v[172:175], v[112:115]
    v_mfma_f32_16x16x32_bf16 v[116:119], a[164:167], v[172:175], v[116:119]
    v_mfma_f32_16x16x32_bf16 v[120:123], a[168:171], v[172:175], v[120:123]
    v_mfma_f32_16x16x32_bf16 v[124:127], a[172:175], v[172:175], v[124:127]
    buffer_load_dwordx4 v[172:175], v10, s[20:23], s40 offen sc1
    s_waitcnt vmcnt(17)
    v_mfma_f32_16x16x32_bf16 v[240:243], a[176:179], v[176:179], v[240:243]
    s_xor_b32 s40, s31, 531456
    v_mfma_f32_16x16x32_bf16 v[244:247], a[180:183], v[176:179], v[244:247]
    v_mfma_f32_16x16x32_bf16 v[248:251], a[184:187], v[176:179], v[248:251]
    v_mfma_f32_16x16x32_bf16 v[252:255], a[188:191], v[176:179], v[252:255]
    buffer_load_dwordx4 v[176:179], v7, s[20:23], s40 offen sc1
    v_mfma_f32_16x16x32_bf16 v[80:83], a[176:179], v[180:183], v[80:83]
    v_mfma_f32_16x16x32_bf16 v[84:87], a[180:183], v[180:183], v[84:87]
    v_mfma_f32_16x16x32_bf16 v[88:91], a[184:187], v[180:183], v[88:91]
    v_mfma_f32_16x16x32_bf16 v[92:95], a[188:191], v[180:183], v[92:95]
    buffer_load_dwordx4 v[180:183], v8, s[20:23], s40 offen sc1
    v_mfma_f32_16x16x32_bf16 v[96:99], a[176:179], v[184:187], v[96:99]
    v_mfma_f32_16x16x32_bf16 v[100:103], a[180:183], v[184:187], v[100:103]
    v_mfma_f32_16x16x32_bf16 v[104:107], a[184:187], v[184:187], v[104:107]
    v_mfma_f32_16x16x32_bf16 v[108:111], a[188:191], v[184:187], v[108:111]
    buffer_load_dwordx4 v[184:187], v9, s[20:23], s40 offen sc1
    v_mfma_f32_16x16x32_bf16 v[112:115], a[176:179], v[188:191], v[112:115]
    v_mfma_f32_16x16x32_bf16 v[116:119], a[180:183], v[188:191], v[116:119]
    v_mfma_f32_16x16x32_bf16 v[120:123], a[184:187], v[188:191], v[120:123]
    v_mfma_f32_16x16x32_bf16 v[124:127], a[188:191], v[188:191], v[124:127]
    buffer_load_dwordx4 v[188:191], v10, s[20:23], s40 offen sc1
    s_waitcnt vmcnt(17)
    v_mfma_f32_16x16x32_bf16 v[240:243], a[192:195], v[128:131], v[240:243]
    s_xor_b32 s40, s31, 532480
    v_mfma_f32_16x16x32_bf16 v[244:247], a[196:199], v[128:131], v[244:247]
    v_mfma_f32_16x16x32_bf16 v[248:251], a[200:203], v[128:131], v[248:251]
    v_mfma_f32_16x16x32_bf16 v[252:255], a[204:207], v[128:131], v[252:255]
    buffer_load_dwordx4 v[128:131], v7, s[20:23], s40 offen sc1
    v_mfma_f32_16x16x32_bf16 v[80:83], a[192:195], v[132:135], v[80:83]
    v_mfma_f32_16x16x32_bf16 v[84:87], a[196:199], v[132:135], v[84:87]
    v_mfma_f32_16x16x32_bf16 v[88:91], a[200:203], v[132:135], v[88:91]
    v_mfma_f32_16x16x32_bf16 v[92:95], a[204:207], v[132:135], v[92:95]
    buffer_load_dwordx4 v[132:135], v8, s[20:23], s40 offen sc1
    v_mfma_f32_16x16x32_bf16 v[96:99], a[192:195], v[136:139], v[96:99]
    v_mfma_f32_16x16x32_bf16 v[100:103], a[196:199], v[136:139], v[100:103]
    v_mfma_f32_16x16x32_bf16 v[104:107], a[200:203], v[136:139], v[104:107]
    v_mfma_f32_16x16x32_bf16 v[108:111], a[204:207], v[136:139], v[108:111]
    buffer_load_dwordx4 v[136:139], v9, s[20:23], s40 offen sc1
    v_mfma_f32_16x16x32_bf16 v[112:115], a[192:195], v[140:143], v[112:115]
    v_mfma_f32_16x16x32_bf16 v[116:119], a[196:199], v[140:143], v[116:119]
    v_mfma_f32_16x16x32_bf16 v[120:123], a[200:203], v[140:143], v[120:123]
    v_mfma_f32_16x16x32_bf16 v[124:127], a[204:207], v[140:143], v[124:127]
    buffer_load_dwordx4 v[140:143], v10, s[20:23], s40 offen sc1
    s_waitcnt vmcnt(12)
    v_mfma_f32_16x16x32_bf16 v[240:243], a[208:211], v[144:147], v[240:243]
    s_xor_b32 s40, s31, 533504
    v_mfma_f32_16x16x32_bf16 v[244:247], a[212:215], v[144:147], v[244:247]
    v_cmp_ne_u32 vcc, s35, v23
    s_nop 0
    s_cmp_lg_u64 vcc, 0
    s_cbranch_scc1 L_gx
L_gx_ok:
    v_mfma_f32_16x16x32_bf16 v[248:251], a[216:219], v[144:147], v[248:251]
    v_and_b32 v23, 0xffff0000, v22
    v_lshlrev_b32 v22, 16, v22
    v_mfma_f32_16x16x32_bf16 v[252:255], a[220:223], v[144:147], v[252:255]
    buffer_load_dwordx4 v[144:147], v7, s[20:23], s40 offen sc1
    v_mfma_f32_16x16x32_bf16 v[80:83], a[208:211], v[148:151], v[80:83]
    v_lshlrev_b32 v48, 16, v24
    v_and_b32 v49, 0xffff0000, v24
    v_mfma_f32_16x16x32_bf16 v[84:87], a[212:215], v[148:151], v[84:87]
    v_lshlrev_b32 v50, 16, v25
    v_and_b32 v51, 0xffff0000, v25
    v_mfma_f32_16x16x32_bf16 v[88:91], a[216:219], v[148:151], v[88:91]
    v_lshlrev_b32 v52, 16, v26
    v_and_b32 v53, 0xffff0000, v26
    v_mfma_f32_16x16x32_bf16 v[92:95], a[220:223], v[148:151], v[92:95]
    buffer_load_dwordx4 v[148:151], v8, s[20:23], s40 offen sc1
    v_mfma_f32_16x16x32_bf16 v[96:99], a[208:211], v[152:155], v[96:99]
    v_lshlrev_b32 v54, 16, v27
    v_and_b32 v55, 0xffff0000, v27
    v_mfma_f32_16x16x32_bf16 v[100:103], a[212:215], v[152:155], v[100:103]
    v_sub_f32 v48, v48, v22
    v_sub_f32 v49, v49, v22
    v_mfma_f32_16x16x32_bf16 v[104:107], a[216:219], v[152:155], v[104:107]
    v_sub_f32 v50, v50, v22
    v_sub_f32 v51, v51, v22
    v_mfma_f32_16x16x32_bf16 v[108:111], a[220:223], v[152:155], v[108:111]
    buffer_load_dwordx4 v[152:155], v9, s[20:23], s40 offen sc1
    v_mfma_f32_16x16x32_bf16 v[112:115], a[208:211], v[156:159], v[112:115]
    v_sub_f32 v52, v52, v22
    v_sub_f32 v53, v53, v22
    v_mfma_f32_16x16x32_bf16 v[116:119], a[212:215], v[156:159], v[116:119]
    v_sub_f32 v54, v54, v22
    v_sub_f32 v55, v55, v22
    v_mfma_f32_16x16x32_bf16 v[120:123], a[216:219], v[156:159], v[120:123]
    v_rcp_f32 v23, v23
    v_mfma_f32_16x16x32_bf16 v[124:127], a[220:223], v[156:159], v[124:127]
    buffer_load_dwordx4 v[156:159], v10, s[20:23], s40 offen sc1
    s_waitcnt vmcnt(12)
    v_mfma_f32_16x16x32_bf16 v[240:243], a[64:67], v[160:163], v[240:243]
    s_xor_b32 s40, s31, 534528
    v_cvt_pk_bf16_f32 v32, v48, v49
    v_mfma_f32_16x16x32_bf16 v[244:247], a[68:71], v[160:163], v[244:247]
    v_cvt_pk_bf16_f32 v33, v50, v51
    v_cvt_pk_bf16_f32 v34, v52, v53
    v_mfma_f32_16x16x32_bf16 v[248:251], a[72:75], v[160:163], v[248:251]
    v_cvt_pk_bf16_f32 v35, v54, v55
    v_lshlrev_b32 v48, 16, v32
    v_mfma_f32_16x16x32_bf16 v[252:255], a[76:79], v[160:163], v[252:255]
    buffer_load_dwordx4 v[160:163], v7, s[20:23], s40 offen sc1
    v_mfma_f32_16x16x32_bf16 v[80:83], a[64:67], v[164:167], v[80:83]
    v_and_b32 v49, 0xffff0000, v32
    v_lshlrev_b32 v50, 16, v33
    v_mfma_f32_16x16x32_bf16 v[84:87], a[68:71], v[164:167], v[84:87]
    v_and_b32 v51, 0xffff0000, v33
    v_lshlrev_b32 v52, 16, v34
    v_mfma_f32_16x16x32_bf16 v[88:91], a[72:75], v[164:167], v[88:91]
    v_and_b32 v53, 0xffff0000, v34
    v_lshlrev_b32 v54, 16, v35
    v_mfma_f32_16x16x32_bf16 v[92:95], a[76:79], v[164:167], v[92:95]
    buffer_load_dwordx4 v[164:167], v8, s[20:23], s40 offen sc1
    v_mfma_f32_16x16x32_bf16 v[96:99], a[64:67], v[168:171], v[96:99]
    v_and_b32 v55, 0xffff0000, v35
    v_mul_f32 v48, v48, v23
    v_mfma_f32_16x16x32_bf16 v[100:103], a[68:71], v[168:171], v[100:103]
    v_mul_f32 v49, v49, v23
    v_mul_f32 v50, v50, v23
    v_mfma_f32_16x16x32_bf16 v[104:107], a[72:75], v[168:171], v[104:107]
    v_mul_f32 v51, v51, v23
    v_mul_f32 v52, v52, v23
    v_mfma_f32_16x16x32_bf16 v[108:111], a[76:79], v[168:171], v[108:111]
    buffer_load_dwordx4 v[168:171], v9, s[20:23], s40 offen sc1
    v_mfma_f32_16x16x32_bf16 v[112:115], a[64:67], v[172:175], v[112:115]
    v_mul_f32 v53, v53, v23
    v_mul_f32 v54, v54, v23
    v_mfma_f32_16x16x32_bf16 v[116:119], a[68:71], v[172:175], v[116:119]
    v_mul_f32 v55, v55, v23
    v_cvt_pk_bf16_f32 v32, v48, v49
    v_mfma_f32_16x16x32_bf16 v[120:123], a[72:75], v[172:175], v[120:123]
    v_cvt_pk_bf16_f32 v33, v50, v51
    v_cvt_pk_bf16_f32 v34, v52, v53
    v_mfma_f32_16x16x32_bf16 v[124:127], a[76:79], v[172:175], v[124:127]
    buffer_load_dwordx4 v[172:175], v10, s[20:23], s40 offen sc1
    s_waitcnt vmcnt(12)
    v_mfma_f32_16x16x32_bf16 v[240:243], a[80:83], v[176:179], v[240:243]
    s_xor_b32 s40, s31, 535552
    v_cvt_pk_bf16_f32 v35, v54, v55
    v_mfma_f32_16x16x32_bf16 v[244:247], a[84:87], v[176:179], v[244:247]
    v_lshlrev_b32 v48, 16, v32
    v_and_b32 v49, 0xffff0000, v32
    v_mfma_f32_16x16x32_bf16 v[248:251], a[88:91], v[176:179], v[248:251]
    v_lshlrev_b32 v50, 16, v33
    v_and_b32 v51, 0xffff0000, v33
    v_mfma_f32_16x16x32_bf16 v[252:255], a[92:95], v[176:179], v[252:255]
    buffer_load_dwordx4 v[176:179], v7, s[20:23], s40 offen sc1
    v_mfma_f32_16x16x32_bf16 v[80:83], a[80:83], v[180:183], v[80:83]
    v_lshlrev_b32 v52, 16, v34
    v_and_b32 v53, 0xffff0000, v34
    v_mfma_f32_16x16x32_bf16 v[84:87], a[84:87], v[180:183], v[84:87]
    v_lshlrev_b32 v54, 16, v35
    v_and_b32 v55, 0xffff0000, v35
    v_mfma_f32_16x16x32_bf16 v[88:91], a[88:91], v[180:183], v[88:91]
    v_mul_f32 v192, 0xbfb8aa3b, v48
    v_mul_f32 v193, 0xbfb8aa3b, v49
    v_mfma_f32_16x16x32_bf16 v[92:95], a[92:95], v[180:183], v[92:95]
    buffer_load_dwordx4 v[180:183], v8, s[20:23], s40 offen sc1
    v_mfma_f32_16x16x32_bf16 v[96:99], a[80:83], v[184:187], v[96:99]
    v_mul_f32 v194, 0xbfb8aa3b, v50
    v_mul_f32 v195, 0xbfb8aa3b, v51
    v_mfma_f32_16x16x32_bf16 v[100:103], a[84:87], v[184:187], v[100:103]
    v_mul_f32 v196, 0xbfb8aa3b, v52
    v_mul_f32 v197, 0xbfb8aa3b, v53
    v_mfma_f32_16x16x32_bf16 v[104:107], a[88:91], v[184:187], v[104:107]
    v_mul_f32 v198, 0xbfb8aa3b, v54
    v_mul_f32 v199, 0xbfb8aa3b, v55
    v_mfma_f32_16x16x32_bf16 v[108:111], a[92:95], v[184:187], v[108:111]
    buffer_load_dwordx4 v[184:187], v9, s[20:23], s40 offen sc1
    v_mfma_f32_16x16x32_bf16 v[112:115], a[80:83], v[188:191], v[112:115]
    v_lshlrev_b32 v56, 16, v28
    v_and_b32 v57, 0xffff0000, v28
    v_mfma_f32_16x16x32_bf16 v[116:119], a[84:87], v[188:191], v[116:119]
    v_lshlrev_b32 v58, 16, v29
    v_and_b32 v59, 0xffff0000, v29
    v_mfma_f32_16x16x32_bf16 v[120:123], a[88:91], v[188:191], v[120:123]
    v_lshlrev_b32 v60, 16, v30
    v_and_b32 v61, 0xffff0000, v30
    v_mfma_f32_16x16x32_bf16 v[124:127], a[92:95], v[188:191], v[124:127]
    buffer_load_dwordx4 v[188:191], v10, s[20:23], s40 offen sc1
    s_xor_b32 s40, s31, 536576
    v_lshlrev_b32 v62, 16, v31
    v_and_b32 v63, 0xffff0000, v31
    v_exp_f32 v192, v192
    v_exp_f32 v193, v193
    v_exp_f32 v194, v194
    v_exp_f32 v195, v195
    v_exp_f32 v196, v196
    buffer_load_dword v19, v1, s[20:23], s51 offen sc1
    s_waitcnt vmcnt(13)
    v_mfma_f32_16x16x32_bf16 v[240:243], a[224:227], v[128:131], v[240:243]
    v_exp_f32 v197, v197
    v_mfma_f32_16x16x32_bf16 v[244:247], a[228:231], v[128:131], v[244:247]
    v_exp_f32 v198, v198
    v_mfma_f32_16x16x32_bf16 v[248:251], a[232:235], v[128:131], v[248:251]
    v_exp_f32 v199, v199
    v_mfma_f32_16x16x32_bf16 v[252:255], a[236:239], v[128:131], v[252:255]
    buffer_load_dwordx4 v[128:131], v7, s[20:23], s40 offen sc1
    v_mfma_f32_16x16x32_bf16 v[80:83], a[224:227], v[132:135], v[80:83]
    v_sub_f32 v56, v56, v22
    v_sub_f32 v57, v57, v22
    v_mfma_f32_16x16x32_bf16 v[84:87], a[228:231], v[132:135], v[84:87]
    v_sub_f32 v58, v58, v22
    v_sub_f32 v59, v59, v22
    v_mfma_f32_16x16x32_bf16 v[88:91], a[232:235], v[132:135], v[88:91]
    v_sub_f32 v60, v60, v22
    v_sub_f32 v61, v61, v22
    v_mfma_f32_16x16x32_bf16 v[92:95], a[236:239], v[132:135], v[92:95]
    buffer_load_dwordx4 v[132:135], v8, s[20:23], s40 offen sc1
    v_mfma_f32_16x16x32_bf16 v[96:99], a[224:227], v[136:139], v[96:99]
    v_sub_f32 v62, v62, v22
    v_sub_f32 v63, v63, v22
    v_mfma_f32_16x16x32_bf16 v[100:103], a[228:231], v[136:139], v[100:103]
    v_cvt_pk_bf16_f32 v36, v56, v57
    v_cvt_pk_bf16_f32 v37, v58, v59
    v_mfma_f32_16x16x32_bf16 v[104:107], a[232:235], v[136:139], v[104:107]
    v_cvt_pk_bf16_f32 v38, v60, v61
    v_cvt_pk_bf16_f32 v39, v62, v63
    v_mfma_f32_16x16x32_bf16 v[108:111], a[236:239], v[136:139], v[108:111]
    buffer_load_dwordx4 v[136:139], v9, s[20:23], s40 offen sc1
    v_mfma_f32_16x16x32_bf16 v[112:115], a[224:227], v[140:143], v[112:115]
    v_add_f32 v192, 1.0, v192
    v_add_f32 v193, 1.0, v193
    v_mfma_f32_16x16x32_bf16 v[116:119], a[228:231], v[140:143], v[116:119]
    v_add_f32 v194, 1.0, v194
    v_add_f32 v195, 1.0, v195
    v_mfma_f32_16x16x32_bf16 v[120:123], a[232:235], v[140:143], v[120:123]
    v_add_f32 v196, 1.0, v196
    v_add_f32 v197, 1.0, v197
    v_mfma_f32_16x16x32_bf16 v[124:127], a[236:239], v[140:143], v[124:127]
    buffer_load_dwordx4 v[140:143], v10, s[20:23], s40 offen sc1
    s_waitcnt vmcnt(13)
    v_mfma_f32_16x16x32_bf16 v[240:243], a[96:99], v[144:147], v[240:243]
    s_xor_b32 s40, s31, 537600
    v_add_f32 v198, 1.0, v198
    v_mfma_f32_16x16x32_bf16 v[244:247], a[100:103], v[144:147], v[244:247]
    v_add_f32 v199, 1.0, v199
    v_lshlrev_b32 v56, 16, v36
    v_mfma_f32_16x16x32_bf16 v[248:251], a[104:107], v[144:147], v[248:251]
    v_and_b32 v57, 0xffff0000, v36
    v_lshlrev_b32 v58, 16, v37
    v_mfma_f32_16x16x32_bf16 v[252:255], a[108:111], v[144:147], v[252:255]
    buffer_load_dwordx4 v[144:147], v7, s[20:23], s40 offen sc1
    v_mfma_f32_16x16x32_bf16 v[80:83], a[96:99], v[148:151], v[80:83]
    v_and_b32 v59, 0xffff0000, v37
    v_lshlrev_b32 v60, 16, v38
    v_mfma_f32_16x16x32_bf16 v[84:87], a[100:103], v[148:151], v[84:87]
    v_and_b32 v61, 0xffff0000, v38
    v_lshlrev_b32 v62, 16, v39
    v_mfma_f32_16x16x32_bf16 v[88:91], a[104:107], v[148:151], v[88:91]
    v_and_b32 v63, 0xffff0000, v39
    v_mul_f32 v56, v56, v23
    v_mfma_f32_16x16x32_bf16 v[92:95], a[108:111], v[148:151], v[92:95]
    buffer_load_dwordx4 v[148:151], v8, s[20:23], s40 offen sc1
    v_mfma_f32_16x16x32_bf16 v[96:99], a[96:99], v[152:155], v[96:99]
    v_rcp_f32 v192, v192
    v_mfma_f32_16x16x32_bf16 v[100:103], a[100:103], v[152:155], v[100:103]
    v_rcp_f32 v193, v193
    v_mfma_f32_16x16x32_bf16 v[104:107], a[104:107], v[152:155], v[104:107]
    v_rcp_f32 v194, v194
    v_mfma_f32_16x16x32_bf16 v[108:111], a[108:111], v[152:155], v[108:111]
    buffer_load_dwordx4 v[152:155], v9, s[20:23], s40 offen sc1
    v_mfma_f32_16x16x32_bf16 v[112:115], a[96:99], v[156:159], v[112:115]
    v_rcp_f32 v195, v195
    v_mfma_f32_16x16x32_bf16 v[116:119], a[100:103], v[156:159], v[116:119]
    v_rcp_f32 v196, v196
    v_mfma_f32_16x16x32_bf16 v[120:123], a[104:107], v[156:159], v[120:123]
    v_rcp_f32 v197, v197
    v_mfma_f32_16x16x32_bf16 v[124:127], a[108:111], v[156:159], v[124:127]
    buffer_load_dwordx4 v[156:159], v10, s[20:23], s40 offen sc1
    s_waitcnt vmcnt(13)
    v_mfma_f32_16x16x32_bf16 v[240:243], a[112:115], v[160:163], v[240:243]
    s_xor_b32 s40, s31, 538624
    v_mul_f32 v57, v57, v23
    v_mfma_f32_16x16x32_bf16 v[244:247], a[116:119], v[160:163], v[244:247]
    v_rcp_f32 v198, v198
    v_mfma_f32_16x16x32_bf16 v[248:251], a[120:123], v[160:163], v[248:251]
    v_rcp_f32 v199, v199
    v_mfma_f32_16x16x32_bf16 v[252:255], a[124:127], v[160:163], v[252:255]
    buffer_load_dwordx4 v[160:163], v7, s[20:23], s40 offen sc1
    v_mfma_f32_16x16x32_bf16 v[80:83], a[112:115], v[164:167], v[80:83]
    v_mul_f32 v58, v58, v23
    v_mul_f32 v59, v59, v23
    v_mfma_f32_16x16x32_bf16 v[84:87], a[116:119], v[164:167], v[84:87]
    v_mul_f32 v60, v60, v23
    v_mul_f32 v61, v61, v23
    v_mfma_f32_16x16x32_bf16 v[88:91], a[120:123], v[164:167], v[88:91]
    v_mul_f32 v62, v62, v23
    v_mul_f32 v63, v63, v23
    v_mfma_f32_16x16x32_bf16 v[92:95], a[124:127], v[164:167], v[92:95]
    buffer_load_dwordx4 v[164:167], v8, s[20:23], s40 offen sc1
    v_mfma_f32_16x16x32_bf16 v[96:99], a[112:115], v[168:171], v[96:99]
    v_cvt_pk_bf16_f32 v36, v56, v57
    v_cvt_pk_bf16_f32 v37, v58, v59
    v_mfma_f32_16x16x32_bf16 v[100:103], a[116:119], v[168:171], v[100:103]
    v_cvt_pk_bf16_f32 v38, v60, v61
    v_cvt_pk_bf16_f32 v39, v62, v63
    v_mfma_f32_16x16x32_bf16 v[104:107], a[120:123], v[168:171], v[104:107]
    v_lshlrev_b32 v56, 16, v36
    v_and_b32 v57, 0xffff0000, v36
    v_mfma_f32_16x16x32_bf16 v[108:111], a[124:127], v[168:171], v[108:111]
    buffer_load_dwordx4 v[168:171], v9, s[20:23], s40 offen sc1
    v_mfma_f32_16x16x32_bf16 v[112:115], a[112:115], v[172:175], v[112:115]
    v_lshlrev_b32 v58, 16, v37
    v_and_b32 v59, 0xffff0000, v37
    v_mfma_f32_16x16x32_bf16 v[116:119], a[116:119], v[172:175], v[116:119]
    v_lshlrev_b32 v60, 16, v38
    v_and_b32 v61, 0xffff0000, v38
    v_mfma_f32_16x16x32_bf16 v[120:123], a[120:123], v[172:175], v[120:123]
    v_lshlrev_b32 v62, 16, v39
    v_and_b32 v63, 0xffff0000, v39
    v_mfma_f32_16x16x32_bf16 v[124:127], a[124:127], v[172:175], v[124:127]
    buffer_load_dwordx4 v[172:175], v10, s[20:23], s40 offen sc1
    s_waitcnt vmcnt(13)
    v_mfma_f32_16x16x32_bf16 v[240:243], a[240:243], v[176:179], v[240:243]
    s_xor_b32 s40, s31, 539648
    v_mul_f32 v48, v48, v192
    v_mfma_f32_16x16x32_bf16 v[244:247], a[244:247], v[176:179], v[244:247]
    v_mul_f32 v49, v49, v193
    v_mul_f32 v50, v50, v194
    v_mfma_f32_16x16x32_bf16 v[248:251], a[248:251], v[176:179], v[248:251]
    v_mul_f32 v51, v51, v195
    v_mul_f32 v52, v52, v196
    v_mfma_f32_16x16x32_bf16 v[252:255], a[252:255], v[176:179], v[252:255]
    buffer_load_dwordx4 v[176:179], v7, s[20:23], s40 offen sc1
    v_mfma_f32_16x16x32_bf16 v[80:83], a[240:243], v[180:183], v[80:83]
    v_mul_f32 v53, v53, v197
    v_mul_f32 v54, v54, v198
    v_mfma_f32_16x16x32_bf16 v[84:87], a[244:247], v[180:183], v[84:87]
    v_mul_f32 v55, v55, v199
    v_mul_f32 v200, 0xbfb8aa3b, v56
    v_mfma_f32_16x16x32_bf16 v[88:91], a[248:251], v[180:183], v[88:91]
    v_mul_f32 v201, 0xbfb8aa3b, v57
    v_mul_f32 v202, 0xbfb8aa3b, v58
    v_mfma_f32_16x16x32_bf16 v[92:95], a[252:255], v[180:183], v[92:95]
    buffer_load_dwordx4 v[180:183], v8, s[20:23], s40 offen sc1
    v_mfma_f32_16x16x32_bf16 v[96:99], a[240:243], v[184:187], v[96:99]
    v_mul_f32 v203, 0xbfb8aa3b, v59
    v_mul_f32 v204, 0xbfb8aa3b, v60
    v_mfma_f32_16x16x32_bf16 v[100:103], a[244:247], v[184:187], v[100:103]
    v_mul_f32 v205, 0xbfb8aa3b, v61
    v_mul_f32 v206, 0xbfb8aa3b, v62
    v_mfma_f32_16x16x32_bf16 v[104:107], a[248:251], v[184:187], v[104:107]
    v_mul_f32 v207, 0xbfb8aa3b, v63
    v_cvt_pk_bf16_f32 v192, v48, v49
    v_mfma_f32_16x16x32_bf16 v[108:111], a[252:255], v[184:187], v[108:111]
    buffer_load_dwordx4 v[184:187], v9, s[20:23], s40 offen sc1
    v_mfma_f32_16x16x32_bf16 v[112:115], a[240:243], v[188:191], v[112:115]
    v_cvt_pk_bf16_f32 v193, v50, v51
    v_cvt_pk_bf16_f32 v194, v52, v53
    v_mfma_f32_16x16x32_bf16 v[116:119], a[244:247], v[188:191], v[116:119]
    v_cvt_pk_bf16_f32 v195, v54, v55
    v_lshlrev_b32 v48, 16, v192
    v_mfma_f32_16x16x32_bf16 v[120:123], a[248:251], v[188:191], v[120:123]
    v_exp_f32 v200, v200
    v_mfma_f32_16x16x32_bf16 v[124:127], a[252:255], v[188:191], v[124:127]
    buffer_load_dwordx4 v[188:191], v10, s[20:23], s40 offen sc1
    s_waitcnt vmcnt(12)
    v_mfma_f32_16x16x32_bf16 v[240:243], a[0:3], v[128:131], v[240:243]
    s_xor_b32 s40, s31, 0
    v_and_b32 v49, 0xffff0000, v192
    v_mfma_f32_16x16x32_bf16 v[244:247], a[4:7], v[128:131], v[244:247]
    v_exp_f32 v201, v201
    v_mfma_f32_16x16x32_bf16 v[248:251], a[8:11], v[128:131], v[248:251]
    v_exp_f32 v202, v202
    v_mfma_f32_16x16x32_bf16 v[252:255], a[12:15], v[128:131], v[252:255]
    v_exp_f32 v203, v203
    v_mfma_f32_16x16x32_bf16 v[80:83], a[0:3], v[132:135], v[80:83]
    v_exp_f32 v204, v204
    v_mfma_f32_16x16x32_bf16 v[84:87], a[4:7], v[132:135], v[84:87]
    v_exp_f32 v205, v205
    v_mfma_f32_16x16x32_bf16 v[88:91], a[8:11], v[132:135], v[88:91]
    v_exp_f32 v206, v206
    v_cmp_ne_u32 vcc, s35, v19
    s_nop 0
    s_cmp_lg_u64 vcc, 0
    s_cbranch_scc1 L_fq
L_fq_ok:
    v_mfma_f32_16x16x32_bf16 v[92:95], a[12:15], v[132:135], v[92:95]
    buffer_load_dwordx4 v[128:131], v7, s[20:23], s40 offen sc1
    v_mfma_f32_16x16x32_bf16 v[96:99], a[0:3], v[136:139], v[96:99]
    v_add_u32 v19, s33, v3
    v_add_u32 v19, 100608, v19
    v_mfma_f32_16x16x32_bf16 v[100:103], a[4:7], v[136:139], v[100:103]
    v_exp_f32 v207, v207
    v_mfma_f32_16x16x32_bf16 v[104:107], a[8:11], v[136:139], v[104:107]
    v_lshlrev_b32 v50, 16, v193
    v_and_b32 v51, 0xffff0000, v193
    buffer_load_dwordx4 v[132:135], v8, s[20:23], s40 offen sc1
    v_mfma_f32_16x16x32_bf16 v[108:111], a[12:15], v[136:139], v[108:111]
    v_lshlrev_b32 v52, 16, v194
    v_and_b32 v53, 0xffff0000, v194
    v_mfma_f32_16x16x32_bf16 v[112:115], a[0:3], v[140:143], v[112:115]
    v_lshlrev_b32 v54, 16, v195
    v_and_b32 v55, 0xffff0000, v195
    v_mfma_f32_16x16x32_bf16 v[116:119], a[4:7], v[140:143], v[116:119]
    v_add_f32 v200, 1.0, v200
    v_add_f32 v201, 1.0, v201
    buffer_load_dwordx4 v[136:139], v9, s[20:23], s40 offen sc1
    v_mfma_f32_16x16x32_bf16 v[120:123], a[8:11], v[140:143], v[120:123]
    v_add_f32 v202, 1.0, v202
    v_add_f32 v203, 1.0, v203
    v_mfma_f32_16x16x32_bf16 v[124:127], a[12:15], v[140:143], v[124:127]
    v_add_f32 v204, 1.0, v204
    v_add_f32 v205, 1.0, v205
    v_add_f32 v206, 1.0, v206
    v_add_f32 v207, 1.0, v207
    v_rcp_f32 v200, v200
    buffer_load_dwordx4 v[140:143], v10, s[20:23], s40 offen sc1
    s_waitcnt vmcnt(12)
    v_mfma_f32_16x16x32_bf16 v[240:243], a[16:19], v[144:147], v[240:243]
    s_xor_b32 s40, s31, 1024
    v_mul_f32 v56, v56, v200
    v_mfma_f32_16x16x32_bf16 v[244:247], a[20:23], v[144:147], v[244:247]
    v_rcp_f32 v201, v201
    v_mfma_f32_16x16x32_bf16 v[248:251], a[24:27], v[144:147], v[248:251]
    v_rcp_f32 v202, v202
    v_mfma_f32_16x16x32_bf16 v[252:255], a[28:31], v[144:147], v[252:255]
    buffer_load_dwordx4 v[144:147], v7, s[20:23], s40 offen sc1
    v_mfma_f32_16x16x32_bf16 v[80:83], a[16:19], v[148:151], v[80:83]
    v_rcp_f32 v203, v203
    v_mfma_f32_16x16x32_bf16 v[84:87], a[20:23], v[148:151], v[84:87]
    v_rcp_f32 v204, v204
    v_mfma_f32_16x16x32_bf16 v[88:91], a[24:27], v[148:151], v[88:91]
    v_rcp_f32 v205, v205
    v_mfma_f32_16x16x32_bf16 v[92:95], a[28:31], v[148:151], v[92:95]
    buffer_load_dwordx4 v[148:151], v8, s[20:23], s40 offen sc1
    v_mfma_f32_16x16x32_bf16 v[96:99], a[16:19], v[152:155], v[96:99]
    v_rcp_f32 v206, v206
    v_mfma_f32_16x16x32_bf16 v[100:103], a[20:23], v[152:155], v[100:103]
    v_rcp_f32 v207, v207
    v_mfma_f32_16x16x32_bf16 v[104:107], a[24:27], v[152:155], v[104:107]
    v_mul_f32 v57, v57, v201
    v_mul_f32 v58, v58, v202
    v_mfma_f32_16x16x32_bf16 v[108:111], a[28:31], v[152:155], v[108:111]
    buffer_load_dwordx4 v[152:155], v9, s[20:23], s40 offen sc1
    v_mfma_f32_16x16x32_bf16 v[112:115], a[16:19], v[156:159], v[112:115]
    v_mul_f32 v59, v59, v203
    v_mul_f32 v60, v60, v204
    v_mfma_f32_16x16x32_bf16 v[116:119], a[20:23], v[156:159], v[116:119]
    v_mul_f32 v61, v61, v205
    v_mul_f32 v62, v62, v206
    v_mfma_f32_16x16x32_bf16 v[120:123], a[24:27], v[156:159], v[120:123]
    v_mul_f32 v63, v63, v207
    v_cvt_pk_bf16_f32 v196, v56, v57
    v_mfma_f32_16x16x32_bf16 v[124:127], a[28:31], v[156:159], v[124:127]
    buffer_load_dwordx4 v[156:159], v10, s[20:23], s40 offen sc1
    s_waitcnt vmcnt(12)
    s_waitcnt lgkmcnt(0)
    v_mfma_f32_16x16x32_bf16 v[240:243], a[32:35], v[160:163], v[240:243]
    s_xor_b32 s40, s31, 2048
    v_cvt_pk_bf16_f32 v197, v58, v59
    v_mfma_f32_16x16x32_bf16 v[244:247], a[36:39], v[160:163], v[244:247]
    v_cvt_pk_bf16_f32 v198, v60, v61
    v_cvt_pk_bf16_f32 v199, v62, v63
    v_mfma_f32_16x16x32_bf16 v[248:251], a[40:43], v[160:163], v[248:251]
    v_lshlrev_b32 v56, 16, v196
    v_and_b32 v57, 0xffff0000, v196
    v_mfma_f32_16x16x32_bf16 v[252:255], a[44:47], v[160:163], v[252:255]
    buffer_load_dwordx4 v[160:163], v7, s[20:23], s40 offen sc1
    v_mfma_f32_16x16x32_bf16 v[80:83], a[32:35], v[164:167], v[80:83]
    v_lshlrev_b32 v58, 16, v197
    v_and_b32 v59, 0xffff0000, v197
    v_mfma_f32_16x16x32_bf16 v[84:87], a[36:39], v[164:167], v[84:87]
    v_lshlrev_b32 v60, 16, v198
    v_and_b32 v61, 0xffff0000, v198
    v_mfma_f32_16x16x32_bf16 v[88:91], a[40:43], v[164:167], v[88:91]
    v_lshlrev_b32 v62, 16, v199
    v_and_b32 v63, 0xffff0000, v199
    v_mfma_f32_16x16x32_bf16 v[92:95], a[44:47], v[164:167], v[92:95]
    buffer_load_dwordx4 v[164:167], v8, s[20:23], s40 offen sc1
    v_mfma_f32_16x16x32_bf16 v[96:99], a[32:35], v[168:171], v[96:99]
    s_xor_b32 s51, s2, 1
    s_mul_i32 s51, s51, 24576
    v_mfma_f32_16x16x32_bf16 v[100:103], a[36:39], v[168:171], v[100:103]
    s_add_u32 s51, s51, s32
    s_add_u32 s32, s41, 4096
    v_mfma_f32_16x16x32_bf16 v[104:107], a[40:43], v[168:171], v[104:107]
    s_add_u32 s25, s51, 4096
    v_mfma_f32_16x16x32_bf16 v[108:111], a[44:47], v[168:171], v[108:111]
    buffer_load_dwordx4 v[168:171], v9, s[20:23], s40 offen sc1
    v_mfma_f32_16x16x32_bf16 v[112:115], a[32:35], v[172:175], v[112:115]
    v_mfma_f32_16x16x32_bf16 v[116:119], a[36:39], v[172:175], v[116:119]
    v_mfma_f32_16x16x32_bf16 v[120:123], a[40:43], v[172:175], v[120:123]
    v_mfma_f32_16x16x32_bf16 v[124:127], a[44:47], v[172:175], v[124:127]
    buffer_load_dwordx4 v[172:175], v10, s[20:23], s40 offen sc1
    s_waitcnt vmcnt(12)
    v_mfma_f32_16x16x32_bf16 v[80:83], a[48:51], v[180:183], v[80:83]
    s_xor_b32 s40, s31, 3072
    v_mfma_f32_16x16x32_bf16 v[84:87], a[52:55], v[180:183], v[84:87]
    v_mfma_f32_16x16x32_bf16 v[88:91], a[56:59], v[180:183], v[88:91]
    s_nop 4
    ds_write_b128 v19, v[80:83] offset:0
    v_mfma_f32_16x16x32_bf16 v[92:95], a[60:63], v[180:183], v[92:95]
    buffer_load_dwordx4 v[180:183], v8, s[20:23], s40 offen sc1
    v_mfma_f32_16x16x32_bf16 v[96:99], a[48:51], v[184:187], v[96:99]
    ds_write_b128 v19, v[84:87] offset:1024
    v_mfma_f32_16x16x32_bf16 v[100:103], a[52:55], v[184:187], v[100:103]
    v_mfma_f32_16x16x32_bf16 v[104:107], a[56:59], v[184:187], v[104:107]
    ds_write_b128 v19, v[88:91] offset:2048
    v_mfma_f32_16x16x32_bf16 v[108:111], a[60:63], v[184:187], v[108:111]
    buffer_load_dwordx4 v[184:187], v9, s[20:23], s40 offen sc1
    v_mfma_f32_16x16x32_bf16 v[112:115], a[48:51], v[188:191], v[112:115]
    ds_write_b128 v19, v[92:95] offset:3072
    v_mfma_f32_16x16x32_bf16 v[116:119], a[52:55], v[188:191], v[116:119]
    v_mfma_f32_16x16x32_bf16 v[120:123], a[56:59], v[188:191], v[120:123]
    ds_write_b128 v19, v[96:99] offset:16768
    v_mfma_f32_16x16x32_bf16 v[124:127], a[60:63], v[188:191], v[124:127]
    buffer_load_dwordx4 v[188:191], v10, s[20:23], s40 offen sc1
    v_mfma_f32_16x16x32_bf16 v[240:243], a[48:51], v[176:179], v[240:243]
    ds_write_b128 v19, v[100:103] offset:17792
    v_mfma_f32_16x16x32_bf16 v[244:247], a[52:55], v[176:179], v[244:247]
    v_mfma_f32_16x16x32_bf16 v[248:251], a[56:59], v[176:179], v[248:251]
    ds_write_b128 v19, v[104:107] offset:18816
    v_mfma_f32_16x16x32_bf16 v[252:255], a[60:63], v[176:179], v[252:255]
    buffer_load_dwordx4 v[176:179], v7, s[20:23], s40 offen sc1
    s_waitcnt vmcnt(12)
    v_mfma_f32_16x16x32_bf16 v[64:67], a[128:131], v[128:131], 0
    s_xor_b32 s40, s31, 4096
    ds_write_b128 v19, v[108:111] offset:19840
    v_mfma_f32_16x16x32_bf16 v[68:71], a[132:135], v[128:131], 0
    v_mfma_f32_16x16x32_bf16 v[72:75], a[136:139], v[128:131], 0
    ds_write_b128 v19, v[112:115] offset:41984
    v_mfma_f32_16x16x32_bf16 v[76:79], a[140:143], v[128:131], 0
    buffer_load_dwordx4 v[128:131], v7, s[20:23], s40 offen sc1
    v_mfma_f32_16x16x32_bf16 v[80:83], a[128:131], v[132:135], 0
    ds_write_b128 v19, v[116:119] offset:43008
    v_mfma_f32_16x16x32_bf16 v[84:87], a[132:135], v[132:135], 0
    v_mfma_f32_16x16x32_bf16 v[88:91], a[136:139], v[132:135], 0
    ds_write_b128 v19, v[120:123] offset:44032
    v_mfma_f32_16x16x32_bf16 v[92:95], a[140:143], v[132:135], 0
    buffer_load_dwordx4 v[132:135], v8, s[20:23], s40 offen sc1
    v_mfma_f32_16x16x32_bf16 v[96:99], a[128:131], v[136:139], 0
    ds_write_b128 v19, v[124:127] offset:45056
    v_mfma_f32_16x16x32_bf16 v[100:103], a[132:135], v[136:139], 0
    v_mfma_f32_16x16x32_bf16 v[104:107], a[136:139], v[136:139], 0
    v_mfma_f32_16x16x32_bf16 v[108:111], a[140:143], v[136:139], 0
    buffer_load_dwordx4 v[136:139], v9, s[20:23], s40 offen sc1
    v_mfma_f32_16x16x32_bf16 v[112:115], a[128:131], v[140:143], 0
    v_mfma_f32_16x16x32_bf16 v[116:119], a[132:135], v[140:143], 0
    v_mfma_f32_16x16x32_bf16 v[120:123], a[136:139], v[140:143], 0
    v_mfma_f32_16x16x32_bf16 v[124:127], a[140:143], v[140:143], 0
    buffer_load_dwordx4 v[140:143], v10, s[20:23], s40 offen sc1
    s_cmp_lg_u32 s39, 0
    s_cbranch_scc1 L_g3b
L_g3bk:
    s_waitcnt vmcnt(12)
    v_mfma_f32_16x16x32_bf16 v[64:67], a[144:147], v[144:147], v[64:67]
    s_xor_b32 s40, s31, 5120
    v_mfma_f32_16x16x32_bf16 v[68:71], a[148:151], v[144:147], v[68:71]
    v_mfma_f32_16x16x32_bf16 v[72:75], a[152:155], v[144:147], v[72:75]
    v_mfma_f32_16x16x32_bf16 v[76:79], a[156:159], v[144:147], v[76:79]
    buffer_load_dwordx4 v[144:147], v7, s[20:23], s40 offen sc1
    v_mfma_f32_16x16x32_bf16 v[80:83], a[144:147], v[148:151], v[80:83]
    v_mfma_f32_16x16x32_bf16 v[84:87], a[148:151], v[148:151], v[84:87]
    v_mfma_f32_16x16x32_bf16 v[88:91], a[152:155], v[148:151], v[88:91]
    v_mfma_f32_16x16x32_bf16 v[92:95], a[156:159], v[148:151], v[92:95]
    buffer_load_dwordx4 v[148:151], v8, s[20:23], s40 offen sc1
    v_mfma_f32_16x16x32_bf16 v[96:99], a[144:147], v[152:155], v[96:99]
    v_mfma_f32_16x16x32_bf16 v[100:103], a[148:151], v[152:155], v[100:103]
    v_mfma_f32_16x16x32_bf16 v[104:107], a[152:155], v[152:155], v[104:107]
    v_mfma_f32_16x16x32_bf16 v[108:111], a[156:159], v[152:155], v[108:111]
    buffer_load_dwordx4 v[152:155], v9, s[20:23], s40 offen sc1
    v_mfma_f32_16x16x32_bf16 v[112:115], a[144:147], v[156:159], v[112:115]
    v_mfma_f32_16x16x32_bf16 v[116:119], a[148:151], v[156:159], v[116:119]
    v_mfma_f32_16x16x32_bf16 v[120:123], a[152:155], v[156:159], v[120:123]
    v_mfma_f32_16x16x32_bf16 v[124:127], a[156:159], v[156:159], v[124:127]
    buffer_load_dwordx4 v[156:159], v10, s[20:23], s40 offen sc1
    s_waitcnt vmcnt(12)
    v_mfma_f32_16x16x32_bf16 v[64:67], a[160:163], v[160:163], v[64:67]
    s_xor_b32 s40, s31, 6144
    v_mfma_f32_16x16x32_bf16 v[68:71], a[164:167], v[160:163], v[68:71]
    v_mfma_f32_16x16x32_bf16 v[72:75], a[168:171], v[160:163], v[72:75]
    v_mfma_f32_16x16x32_bf16 v[76:79], a[172:175], v[160:163], v[76:79]
    buffer_load_dwordx4 v[160:163], v7, s[20:23], s40 offen sc1
    v_mfma_f32_16x16x32_bf16 v[80:83], a[160:163], v[164:167], v[80:83]
    v_mfma_f32_16x16x32_bf16 v[84:87], a[164:167], v[164:167], v[84:87]
    v_mfma_f32_16x16x32_bf16 v[88:91], a[168:171], v[164:167], v[88:91]
    v_mfma_f32_16x16x32_bf16 v[92:95], a[172:175], v[164:167], v[92:95]
    buffer_load_dwordx4 v[164:167], v8, s[20:23], s40 offen sc1
    v_mfma_f32_16x16x32_bf16 v[96:99], a[160:163], v[168:171], v[96:99]
    v_mfma_f32_16x16x32_bf16 v[100:103], a[164:167], v[168:171], v[100:103]
    v_mfma_f32_16x16x32_bf16 v[104:107], a[168:171], v[168:171], v[104:107]
    v_mfma_f32_16x16x32_bf16 v[108:111], a[172:175], v[168:171], v[108:111]
    buffer_load_dwordx4 v[168:171], v9, s[20:23], s40 offen sc1
    v_mfma_f32_16x16x32_bf16 v[112:115], a[160:163], v[172:175], v[112:115]
    v_mfma_f32_16x16x32_bf16 v[116:119], a[164:167], v[172:175], v[116:119]
    v_mfma_f32_16x16x32_bf16 v[120:123], a[168:171], v[172:175], v[120:123]
    v_mfma_f32_16x16x32_bf16 v[124:127], a[172:175], v[172:175], v[124:127]
    buffer_load_dwordx4 v[172:175], v10, s[20:23], s40 offen sc1
    s_waitcnt vmcnt(12)
    v_mfma_f32_16x16x32_bf16 v[64:67], a[176:179], v[176:179], v[64:67]
    s_waitcnt lgkmcnt(0)
    s_barrier
    ds_read_b128 v[192:195], v4 offset:0
    v_mfma_f32_16x16x32_bf16 v[68:71], a[180:183], v[176:179], v[68:71]
    ds_read_b128 v[208:211], v5 offset:16768
    s_xor_b32 s40, s31, 7168
    v_mfma_f32_16x16x32_bf16 v[72:75], a[184:187], v[176:179], v[72:75]
    ds_read_b128 v[224:227], v6 offset:41984
    v_mfma_f32_16x16x32_bf16 v[76:79], a[188:191], v[176:179], v[76:79]
    buffer_load_dwordx4 v[176:179], v7, s[20:23], s40 offen sc1
    v_mfma_f32_16x16x32_bf16 v[80:83], a[176:179], v[180:183], v[80:83]
    ds_read_b128 v[196:199], v4 offset:1024
    v_mfma_f32_16x16x32_bf16 v[84:87], a[180:183], v[180:183], v[84:87]
    ds_read_b128 v[212:215], v5 offset:17792
    v_mfma_f32_16x16x32_bf16 v[88:91], a[184:187], v[180:183], v[88:91]
    ds_read_b128 v[228:231], v6 offset:43008
    v_mfma_f32_16x16x32_bf16 v[92:95], a[188:191], v[180:183], v[92:95]
    buffer_load_dwordx4 v[180:183], v8, s[20:23], s40 offen sc1
    v_mfma_f32_16x16x32_bf16 v[96:99], a[176:179], v[184:187], v[96:99]
    ds_read_b128 v[200:203], v4 offset:2048
    s_waitcnt lgkmcnt(6)
    v_add_f32 v240, v240, v192
    v_mfma_f32_16x16x32_bf16 v[100:103], a[180:183], v[184:187], v[100:103]
    ds_read_b128 v[216:219], v5 offset:18816
    v_add_f32 v241, v241, v193
    v_mfma_f32_16x16x32_bf16 v[104:107], a[184:187], v[184:187], v[104:107]
    ds_read_b128 v[232:235], v6 offset:44032
    v_add_f32 v242, v242, v194
    v_mfma_f32_16x16x32_bf16 v[108:111], a[188:191], v[184:187], v[108:111]
    buffer_load_dwordx4 v[184:187], v9, s[20:23], s40 offen sc1
    v_mfma_f32_16x16x32_bf16 v[112:115], a[176:179], v[188:191], v[112:115]
    ds_read_b128 v[204:207], v4 offset:3072
    v_add_f32 v243, v243, v195
    v_mfma_f32_16x16x32_bf16 v[116:119], a[180:183], v[188:191], v[116:119]
    ds_read_b128 v[220:223], v5 offset:19840
    s_waitcnt lgkmcnt(6)
    v_add_f32 v240, v240, v208
    v_mfma_f32_16x16x32_bf16 v[120:123], a[184:187], v[188:191], v[120:123]
    ds_read_b128 v[236:239], v6 offset:45056
    v_add_f32 v241, v241, v209
    v_mfma_f32_16x16x32_bf16 v[124:127], a[188:191], v[188:191], v[124:127]
    buffer_load_dwordx4 v[188:191], v10, s[20:23], s40 offen sc1
    s_waitcnt vmcnt(12)
    v_mfma_f32_16x16x32_bf16 v[64:67], a[192:195], v[128:131], v[64:67]
    s_xor_b32 s40, s31, 8192
    v_add_f32 v242, v242, v210
    v_mfma_f32_16x16x32_bf16 v[68:71], a[196:199], v[128:131], v[68:71]
    v_add_f32 v192, v240, v224
    v_add_f32 v193, v241, v225
    v_mfma_f32_16x16x32_bf16 v[72:75], a[200:203], v[128:131], v[72:75]
    v_add_f32 v194, v242, v226
    v_mov_b32 v195, v17
    v_mfma_f32_16x16x32_bf16 v[76:79], a[204:207], v[128:131], v[76:79]
    buffer_load_dwordx4 v[128:131], v7, s[20:23], s40 offen sc1
    v_mfma_f32_16x16x32_bf16 v[80:83], a[192:195], v[132:135], v[80:83]
    v_add_f32 v244, v244, v196
    v_add_f32 v245, v245, v197
    v_mfma_f32_16x16x32_bf16 v[84:87], a[196:199], v[132:135], v[84:87]
    v_add_f32 v246, v246, v198
    v_add_f32 v247, v247, v199
    v_mfma_f32_16x16x32_bf16 v[88:91], a[200:203], v[132:135], v[88:91]
    v_add_f32 v243, v243, v211
    v_add_f32 v244, v244, v212
    v_mfma_f32_16x16x32_bf16 v[92:95], a[204:207], v[132:135], v[92:95]
    buffer_load_dwordx4 v[132:135], v8, s[20:23], s40 offen sc1
    v_mfma_f32_16x16x32_bf16 v[96:99], a[192:195], v[136:139], v[96:99]
    v_add_f32 v245, v245, v213
    v_add_f32 v196, v243, v227
    v_mfma_f32_16x16x32_bf16 v[100:103], a[196:199], v[136:139], v[100:103]
    s_waitcnt lgkmcnt(0)
    v_add_f32 v197, v244, v228
    v_add_f32 v198, v245, v229
    v_mfma_f32_16x16x32_bf16 v[104:107], a[200:203], v[136:139], v[104:107]
    v_mov_b32 v199, v17
    v_add_f32 v248, v248, v200
    v_mfma_f32_16x16x32_bf16 v[108:111], a[204:207], v[136:139], v[108:111]
    buffer_load_dwordx4 v[136:139], v9, s[20:23], s40 offen sc1
    v_mfma_f32_16x16x32_bf16 v[112:115], a[192:195], v[140:143], v[112:115]
    v_add_f32 v249, v249, v201
    v_add_f32 v250, v250, v202
    v_mfma_f32_16x16x32_bf16 v[116:119], a[196:199], v[140:143], v[116:119]
    v_add_f32 v251, v251, v203
    v_add_f32 v246, v246, v214
    v_mfma_f32_16x16x32_bf16 v[120:123], a[200:203], v[140:143], v[120:123]
    v_add_f32 v247, v247, v215
    v_add_f32 v248, v248, v216
    v_mfma_f32_16x16x32_bf16 v[124:127], a[204:207], v[140:143], v[124:127]
    buffer_load_dwordx4 v[140:143], v10, s[20:23], s40 offen sc1
    s_waitcnt vmcnt(12)
    buffer_store_dwordx4 v[192:195], v3, s[20:23], s41 offen offset:0 sc1
    v_add_f32 v200, v246, v230
    v_add_f32 v201, v247, v231
    v_add_f32 v202, v248, v232
    v_mov_b32 v203, v17
    v_add_f32 v252, v252, v204
    v_add_f32 v253, v253, v205
    v_add_f32 v254, v254, v206
    v_add_f32 v255, v255, v207
    v_add_f32 v249, v249, v217
    v_add_f32 v250, v250, v218
    v_add_f32 v251, v251, v219
    v_add_f32 v204, v249, v233
    buffer_store_dwordx4 v[196:199], v3, s[20:23], s41 offen offset:1024 sc1
    v_add_f32 v205, v250, v234
    v_add_f32 v206, v251, v235
    v_mov_b32 v207, v17
    v_mfma_f32_16x16x32_bf16 v[64:67], a[208:211], v[144:147], v[64:67]
    v_add_f32 v252, v252, v220
    v_add_f32 v253, v253, v221
    v_mfma_f32_16x16x32_bf16 v[68:71], a[212:215], v[144:147], v[68:71]
    v_add_f32 v254, v254, v222
    v_add_f32 v208, v252, v236
    v_mfma_f32_16x16x32_bf16 v[72:75], a[216:219], v[144:147], v[72:75]
    buffer_store_dwordx4 v[200:203], v3, s[20:23], s41 offen offset:2048 sc1
    v_add_f32 v209, v253, v237
    v_add_f32 v210, v254, v238
    v_mov_b32 v211, v17
    v_mfma_f32_16x16x32_bf16 v[76:79], a[220:223], v[144:147], v[76:79]
    v_add_f32 v255, v255, v223
    v_add_f32 v212, v255, v239
    v_mfma_f32_16x16x32_bf16 v[80:83], a[208:211], v[148:151], v[80:83]
    v_mov_b32 v215, v17
    s_xor_b32 s40, s31, 9216
    v_mfma_f32_16x16x32_bf16 v[84:87], a[212:215], v[148:151], v[84:87]
    buffer_store_dwordx4 v[204:207], v3, s[20:23], s41 offen offset:3072 sc1
    v_mfma_f32_16x16x32_bf16 v[88:91], a[216:219], v[148:151], v[88:91]
    v_lshlrev_b32 v240, 16, v24
    v_and_b32 v241, 0xffff0000, v24
    v_mfma_f32_16x16x32_bf16 v[92:95], a[220:223], v[148:151], v[92:95]
    v_lshlrev_b32 v242, 16, v25
    v_and_b32 v243, 0xffff0000, v25
    v_mfma_f32_16x16x32_bf16 v[96:99], a[208:211], v[152:155], v[96:99]
    v_lshlrev_b32 v244, 16, v26
    v_and_b32 v245, 0xffff0000, v26
    buffer_store_dwordx4 v[208:211], v3, s[20:23], s32 offen offset:0 sc1
    v_mfma_f32_16x16x32_bf16 v[100:103], a[212:215], v[152:155], v[100:103]
    v_lshlrev_b32 v246, 16, v27
    v_and_b32 v247, 0xffff0000, v27
    v_mfma_f32_16x16x32_bf16 v[104:107], a[216:219], v[152:155], v[104:107]
    v_lshlrev_b32 v248, 16, v28
    v_and_b32 v249, 0xffff0000, v28
    v_mfma_f32_16x16x32_bf16 v[108:111], a[220:223], v[152:155], v[108:111]
    v_lshlrev_b32 v250, 16, v29
    v_and_b32 v251, 0xffff0000, v29
    buffer_store_dwordx4 v[212:215], v3, s[20:23], s32 offen offset:1024 sc1
    v_mfma_f32_16x16x32_bf16 v[112:115], a[208:211], v[156:159], v[112:115]
    v_lshlrev_b32 v252, 16, v30
    v_and_b32 v253, 0xffff0000, v30
    v_mfma_f32_16x16x32_bf16 v[116:119], a[212:215], v[156:159], v[116:119]
    v_lshlrev_b32 v254, 16, v31
    v_and_b32 v255, 0xffff0000, v31
    v_mfma_f32_16x16x32_bf16 v[120:123], a[216:219], v[156:159], v[120:123]
    buffer_load_dwordx4 v[144:147], v7, s[20:23], s40 offen sc1
    v_mfma_f32_16x16x32_bf16 v[124:127], a[220:223], v[156:159], v[124:127]
    buffer_load_dwordx4 v[148:151], v8, s[20:23], s40 offen sc1
    buffer_load_dwordx4 v[152:155], v9, s[20:23], s40 offen sc1
    buffer_load_dwordx4 v[156:159], v10, s[20:23], s40 offen sc1
    s_cmp_lg_u32 s39, 0
    s_cbranch_scc1 L_g4
L_g4back:
    s_waitcnt vmcnt(18)
    v_mfma_f32_16x16x32_bf16 v[64:67], a[64:67], v[160:163], v[64:67]
    s_xor_b32 s40, s31, 10240
    v_mfma_f32_16x16x32_bf16 v[68:71], a[68:71], v[160:163], v[68:71]
    v_mfma_f32_16x16x32_bf16 v[72:75], a[72:75], v[160:163], v[72:75]
    v_mfma_f32_16x16x32_bf16 v[76:79], a[76:79], v[160:163], v[76:79]
    buffer_load_dwordx4 v[160:163], v7, s[20:23], s40 offen sc1
    v_mfma_f32_16x16x32_bf16 v[80:83], a[64:67], v[164:167], v[80:83]
    v_mfma_f32_16x16x32_bf16 v[84:87], a[68:71], v[164:167], v[84:87]
    v_mfma_f32_16x16x32_bf16 v[88:91], a[72:75], v[164:167], v[88:91]
    v_mfma_f32_16x16x32_bf16 v[92:95], a[76:79], v[164:167], v[92:95]
    buffer_load_dwordx4 v[164:167], v8, s[20:23], s40 offen sc1
    v_mfma_f32_16x16x32_bf16 v[96:99], a[64:67], v[168:171], v[96:99]
    v_mfma_f32_16x16x32_bf16 v[100:103], a[68:71], v[168:171], v[100:103]
    v_mfma_f32_16x16x32_bf16 v[104:107], a[72:75], v[168:171], v[104:107]
    v_mfma_f32_16x16x32_bf16 v[108:111], a[76:79], v[168:171], v[108:111]
    buffer_load_dwordx4 v[168:171], v9, s[20:23], s40 offen sc1
    v_mfma_f32_16x16x32_bf16 v[112:115], a[64:67], v[172:175], v[112:115]
    v_mfma_f32_16x16x32_bf16 v[116:119], a[68:71], v[172:175], v[116:119]
    v_mfma_f32_16x16x32_bf16 v[120:123], a[72:75], v[172:175], v[120:123]
    v_mfma_f32_16x16x32_bf16 v[124:127], a[76:79], v[172:175], v[124:127]
    buffer_load_dwordx4 v[172:175], v10, s[20:23], s40 offen sc1
    s_waitcnt vmcnt(18)
    v_mfma_f32_16x16x32_bf16 v[64:67], a[80:83], v[176:179], v[64:67]
    s_xor_b32 s40, s31, 11264
    v_mfma_f32_16x16x32_bf16 v[68:71], a[84:87], v[176:179], v[68:71]
    v_mfma_f32_16x16x32_bf16 v[72:75], a[88:91], v[176:179], v[72:75]
    v_mfma_f32_16x16x32_bf16 v[76:79], a[92:95], v[176:179], v[76:79]
    buffer_load_dwordx4 v[176:179], v7, s[20:23], s40 offen sc1
    v_mfma_f32_16x16x32_bf16 v[80:83], a[80:83], v[180:183], v[80:83]
    v_mfma_f32_16x16x32_bf16 v[84:87], a[84:87], v[180:183], v[84:87]
    v_mfma_f32_16x16x32_bf16 v[88:91], a[88:91], v[180:183], v[88:91]
    v_mfma_f32_16x16x32_bf16 v[92:95], a[92:95], v[180:183], v[92:95]
    buffer_load_dwordx4 v[180:183], v8, s[20:23], s40 offen sc1
    v_mfma_f32_16x16x32_bf16 v[96:99], a[80:83], v[184:187], v[96:99]
    v_mfma_f32_16x16x32_bf16 v[100:103], a[84:87], v[184:187], v[100:103]
    v_mfma_f32_16x16x32_bf16 v[104:107], a[88:91], v[184:187], v[104:107]
    v_mfma_f32_16x16x32_bf16 v[108:111], a[92:95], v[184:187], v[108:111]
    buffer_load_dwordx4 v[184:187], v9, s[20:23], s40 offen sc1
    v_mfma_f32_16x16x32_bf16 v[112:115], a[80:83], v[188:191], v[112:115]
    v_mfma_f32_16x16x32_bf16 v[116:119], a[84:87], v[188:191], v[116:119]
    v_mfma_f32_16x16x32_bf16 v[120:123], a[88:91], v[188:191], v[120:123]
    v_mfma_f32_16x16x32_bf16 v[124:127], a[92:95], v[188:191], v[124:127]
    buffer_load_dwordx4 v[188:191], v10, s[20:23], s40 offen sc1
    s_waitcnt vmcnt(18)
    v_mfma_f32_16x16x32_bf16 v[64:67], a[224:227], v[128:131], v[64:67]
    s_xor_b32 s40, s31, 12288
    v_mfma_f32_16x16x32_bf16 v[68:71], a[228:231], v[128:131], v[68:71]
    v_mfma_f32_16x16x32_bf16 v[72:75], a[232:235], v[128:131], v[72:75]
    v_mfma_f32_16x16x32_bf16 v[76:79], a[236:239], v[128:131], v[76:79]
    buffer_load_dwordx4 v[128:131], v7, s[20:23], s40 offen sc1
    v_mfma_f32_16x16x32_bf16 v[80:83], a[224:227], v[132:135], v[80:83]
    v_mfma_f32_16x16x32_bf16 v[84:87], a[228:231], v[132:135], v[84:87]
    v_mfma_f32_16x16x32_bf16 v[88:91], a[232:235], v[132:135], v[88:91]
    v_mfma_f32_16x16x32_bf16 v[92:95], a[236:239], v[132:135], v[92:95]
    buffer_load_dwordx4 v[132:135], v8, s[20:23], s40 offen sc1
    v_mfma_f32_16x16x32_bf16 v[96:99], a[224:227], v[136:139], v[96:99]
    v_mfma_f32_16x16x32_bf16 v[100:103], a[228:231], v[136:139], v[100:103]
    v_mfma_f32_16x16x32_bf16 v[104:107], a[232:235], v[136:139], v[104:107]
    v_mfma_f32_16x16x32_bf16 v[108:111], a[236:239], v[136:139], v[108:111]
    buffer_load_dwordx4 v[136:139], v9, s[20:23], s40 offen sc1
    v_mfma_f32_16x16x32_bf16 v[112:115], a[224:227], v[140:143], v[112:115]
    v_mfma_f32_16x16x32_bf16 v[116:119], a[228:231], v[140:143], v[116:119]
    v_mfma_f32_16x16x32_bf16 v[120:123], a[232:235], v[140:143], v[120:123]
    v_mfma_f32_16x16x32_bf16 v[124:127], a[236:239], v[140:143], v[124:127]
    buffer_load_dwordx4 v[140:143], v10, s[20:23], s40 offen sc1
    s_waitcnt vmcnt(12)
    v_mfma_f32_16x16x32_bf16 v[64:67], a[96:99], v[144:147], v[64:67]
    s_xor_b32 s40, s31, 13312
    v_mfma_f32_16x16x32_bf16 v[68:71], a[100:103], v[144:147], v[68:71]
    v_mfma_f32_16x16x32_bf16 v[72:75], a[104:107], v[144:147], v[72:75]
    v_mfma_f32_16x16x32_bf16 v[76:79], a[108:111], v[144:147], v[76:79]
    buffer_load_dwordx4 v[144:147], v7, s[20:23], s40 offen sc1
    v_mfma_f32_16x16x32_bf16 v[80:83], a[96:99], v[148:151], v[80:83]
    v_mfma_f32_16x16x32_bf16 v[84:87], a[100:103], v[148:151], v[84:87]
    v_mfma_f32_16x16x32_bf16 v[88:91], a[104:107], v[148:151], v[88:91]
    v_mfma_f32_16x16x32_bf16 v[92:95], a[108:111], v[148:151], v[92:95]
    buffer_load_dwordx4 v[148:151], v8, s[20:23], s40 offen sc1
    v_mfma_f32_16x16x32_bf16 v[96:99], a[96:99], v[152:155], v[96:99]
    v_mfma_f32_16x16x32_bf16 v[100:103], a[100:103], v[152:155], v[100:103]
    v_mfma_f32_16x16x32_bf16 v[104:107], a[104:107], v[152:155], v[104:107]
    v_mfma_f32_16x16x32_bf16 v[108:111], a[108:111], v[152:155], v[108:111]
    buffer_load_dwordx4 v[152:155], v9, s[20:23], s40 offen sc1
    v_mfma_f32_16x16x32_bf16 v[112:115], a[96:99], v[156:159], v[112:115]
    v_mfma_f32_16x16x32_bf16 v[116:119], a[100:103], v[156:159], v[116:119]
    v_mfma_f32_16x16x32_bf16 v[120:123], a[104:107], v[156:159], v[120:123]
    v_mfma_f32_16x16x32_bf16 v[124:127], a[108:111], v[156:159], v[124:127]
    buffer_load_dwordx4 v[156:159], v10, s[20:23], s40 offen sc1
    s_cmp_lg_u32 s39, 0
    s_cbranch_scc1 L_c1
L_c1_back:
    s_waitcnt vmcnt(12)
    v_mfma_f32_16x16x32_bf16 v[64:67], a[112:115], v[160:163], v[64:67]
    s_xor_b32 s40, s31, 14336
    v_mfma_f32_16x16x32_bf16 v[68:71], a[116:119], v[160:163], v[68:71]
    v_mfma_f32_16x16x32_bf16 v[72:75], a[120:123], v[160:163], v[72:75]
    v_mfma_f32_16x16x32_bf16 v[76:79], a[124:127], v[160:163], v[76:79]
    buffer_load_dwordx4 v[160:163], v7, s[20:23], s40 offen sc1
    v_mfma_f32_16x16x32_bf16 v[80:83], a[112:115], v[164:167], v[80:83]
    v_mfma_f32_16x16x32_bf16 v[84:87], a[116:119], v[164:167], v[84:87]
    v_mfma_f32_16x16x32_bf16 v[88:91], a[120:123], v[164:167], v[88:91]
    v_mfma_f32_16x16x32_bf16 v[92:95], a[124:127], v[164:167], v[92:95]
    buffer_load_dwordx4 v[164:167], v8, s[20:23], s40 offen sc1
    v_mfma_f32_16x16x32_bf16 v[96:99], a[112:115], v[168:171], v[96:99]
    v_mfma_f32_16x16x32_bf16 v[100:103], a[116:119], v[168:171], v[100:103]
    v_mfma_f32_16x16x32_bf16 v[104:107], a[120:123], v[168:171], v[104:107]
    v_mfma_f32_16x16x32_bf16 v[108:111], a[124:127], v[168:171], v[108:111]
    buffer_load_dwordx4 v[168:171], v9, s[20:23], s40 offen sc1
    v_mfma_f32_16x16x32_bf16 v[112:115], a[112:115], v[172:175], v[112:115]
    v_mfma_f32_16x16x32_bf16 v[116:119], a[116:119], v[172:175], v[116:119]
    v_mfma_f32_16x16x32_bf16 v[120:123], a[120:123], v[172:175], v[120:123]
    v_mfma_f32_16x16x32_bf16 v[124:127], a[124:127], v[172:175], v[124:127]
    buffer_load_dwordx4 v[172:175], v10, s[20:23], s40 offen sc1
    s_waitcnt vmcnt(12)
    v_mfma_f32_16x16x32_bf16 v[64:67], a[240:243], v[176:179], v[64:67]
    s_xor_b32 s40, s31, 15360
    v_mfma_f32_16x16x32_bf16 v[68:71], a[244:247], v[176:179], v[68:71]
    v_mfma_f32_16x16x32_bf16 v[72:75], a[248:251], v[176:179], v[72:75]
    v_mfma_f32_16x16x32_bf16 v[76:79], a[252:255], v[176:179], v[76:79]
    buffer_load_dwordx4 v[176:179], v7, s[20:23], s40 offen sc1
    v_mfma_f32_16x16x32_bf16 v[80:83], a[240:243], v[180:183], v[80:83]
    v_mfma_f32_16x16x32_bf16 v[84:87], a[244:247], v[180:183], v[84:87]
    v_mfma_f32_16x16x32_bf16 v[88:91], a[248:251], v[180:183], v[88:91]
    v_mfma_f32_16x16x32_bf16 v[92:95], a[252:255], v[180:183], v[92:95]
    buffer_load_dwordx4 v[180:183], v8, s[20:23], s40 offen sc1
    v_mfma_f32_16x16x32_bf16 v[96:99], a[240:243], v[184:187], v[96:99]
    v_mfma_f32_16x16x32_bf16 v[100:103], a[244:247], v[184:187], v[100:103]
    v_mfma_f32_16x16x32_bf16 v[104:107], a[248:251], v[184:187], v[104:107]
    v_mfma_f32_16x16x32_bf16 v[108:111], a[252:255], v[184:187], v[108:111]
    buffer_load_dwordx4 v[184:187], v9, s[20:23], s40 offen sc1
    v_mfma_f32_16x16x32_bf16 v[112:115], a[240:243], v[188:191], v[112:115]
    v_mfma_f32_16x16x32_bf16 v[116:119], a[244:247], v[188:191], v[116:119]
    v_mfma_f32_16x16x32_bf16 v[120:123], a[248:251], v[188:191], v[120:123]
    v_mfma_f32_16x16x32_bf16 v[124:127], a[252:255], v[188:191], v[124:127]
    buffer_load_dwordx4 v[188:191], v10, s[20:23], s40 offen sc1
    s_cmp_lg_u32 s34, 0
    s_cbranch_scc1 L_cons
L_cons_back:
    s_waitcnt vmcnt(12)
    v_mfma_f32_16x16x32_bf16 v[64:67], a[0:3], v[128:131], v[64:67]
    v_mfma_f32_16x16x32_bf16 v[68:71], a[4:7], v[128:131], v[68:71]
    v_mfma_f32_16x16x32_bf16 v[72:75], a[8:11], v[128:131], v[72:75]
    v_mfma_f32_16x16x32_bf16 v[76:79], a[12:15], v[128:131], v[76:79]
    v_mfma_f32_16x16x32_bf16 v[80:83], a[0:3], v[132:135], v[80:83]
    v_mfma_f32_16x16x32_bf16 v[84:87], a[4:7], v[132:135], v[84:87]
    v_mfma_f32_16x16x32_bf16 v[88:91], a[8:11], v[132:135], v[88:91]
    v_mfma_f32_16x16x32_bf16 v[92:95], a[12:15], v[132:135], v[92:95]
    v_mfma_f32_16x16x32_bf16 v[96:99], a[0:3], v[136:139], v[96:99]
    v_mfma_f32_16x16x32_bf16 v[100:103], a[4:7], v[136:139], v[100:103]
    v_mfma_f32_16x16x32_bf16 v[104:107], a[8:11], v[136:139], v[104:107]
    s_waitcnt vmcnt(8)
    v_mfma_f32_16x16x32_bf16 v[108:111], a[12:15], v[136:139], v[108:111]
    v_mfma_f32_16x16x32_bf16 v[112:115], a[0:3], v[140:143], v[112:115]
    v_mfma_f32_16x16x32_bf16 v[116:119], a[4:7], v[140:143], v[116:119]
    v_mfma_f32_16x16x32_bf16 v[120:123], a[8:11], v[140:143], v[120:123]
    v_mfma_f32_16x16x32_bf16 v[124:127], a[12:15], v[140:143], v[124:127]
    v_mfma_f32_16x16x32_bf16 v[64:67], a[16:19], v[144:147], v[64:67]
    v_mfma_f32_16x16x32_bf16 v[68:71], a[20:23], v[144:147], v[68:71]
    v_mfma_f32_16x16x32_bf16 v[72:75], a[24:27], v[144:147], v[72:75]
    v_mfma_f32_16x16x32_bf16 v[76:79], a[28:31], v[144:147], v[76:79]
    v_mfma_f32_16x16x32_bf16 v[80:83], a[16:19], v[148:151], v[80:83]
    v_mfma_f32_16x16x32_bf16 v[84:87], a[20:23], v[148:151], v[84:87]
    v_mfma_f32_16x16x32_bf16 v[88:91], a[24:27], v[148:151], v[88:91]
    v_mfma_f32_16x16x32_bf16 v[92:95], a[28:31], v[148:151], v[92:95]
    v_mfma_f32_16x16x32_bf16 v[96:99], a[16:19], v[152:155], v[96:99]
    v_mfma_f32_16x16x32_bf16 v[100:103], a[20:23], v[152:155], v[100:103]
    v_mfma_f32_16x16x32_bf16 v[104:107], a[24:27], v[152:155], v[104:107]
    buffer_load_dwordx4 v[128:131], v3, s[20:23], s51 offen offset:0 sc1
    v_mfma_f32_16x16x32_bf16 v[108:111], a[28:31], v[152:155], v[108:111]
    v_mfma_f32_16x16x32_bf16 v[112:115], a[16:19], v[156:159], v[112:115]
    v_mfma_f32_16x16x32_bf16 v[116:119], a[20:23], v[156:159], v[116:119]
    buffer_load_dwordx4 v[132:135], v3, s[20:23], s51 offen offset:1024 sc1
    v_mfma_f32_16x16x32_bf16 v[120:123], a[24:27], v[156:159], v[120:123]
    v_mfma_f32_16x16x32_bf16 v[124:127], a[28:31], v[156:159], v[124:127]
    buffer_load_dwordx4 v[136:139], v3, s[20:23], s51 offen offset:2048 sc1
    buffer_load_dwordx4 v[140:143], v3, s[20:23], s51 offen offset:3072 sc1
    buffer_load_dwordx4 v[144:147], v3, s[20:23], s25 offen offset:0 sc1
    buffer_load_dwordx4 v[148:151], v3, s[20:23], s25 offen offset:1024 sc1
    s_waitcnt vmcnt(10)
    v_mfma_f32_16x16x32_bf16 v[64:67], a[32:35], v[160:163], v[64:67]
    v_mfma_f32_16x16x32_bf16 v[68:71], a[36:39], v[160:163], v[68:71]
    v_mfma_f32_16x16x32_bf16 v[72:75], a[40:43], v[160:163], v[72:75]
    v_mfma_f32_16x16x32_bf16 v[76:79], a[44:47], v[160:163], v[76:79]
    v_mfma_f32_16x16x32_bf16 v[80:83], a[32:35], v[164:167], v[80:83]
    v_mfma_f32_16x16x32_bf16 v[84:87], a[36:39], v[164:167], v[84:87]
    v_mfma_f32_16x16x32_bf16 v[88:91], a[40:43], v[164:167], v[88:91]
    v_mfma_f32_16x16x32_bf16 v[92:95], a[44:47], v[164:167], v[92:95]
    v_mfma_f32_16x16x32_bf16 v[96:99], a[32:35], v[168:171], v[96:99]
    v_mfma_f32_16x16x32_bf16 v[100:103], a[36:39], v[168:171], v[100:103]
    v_mfma_f32_16x16x32_bf16 v[104:107], a[40:43], v[168:171], v[104:107]
    s_waitcnt vmcnt(6)
    v_mfma_f32_16x16x32_bf16 v[108:111], a[44:47], v[168:171], v[108:111]
    v_mfma_f32_16x16x32_bf16 v[112:115], a[32:35], v[172:175], v[112:115]
    v_mfma_f32_16x16x32_bf16 v[116:119], a[36:39], v[172:175], v[116:119]
    v_mfma_f32_16x16x32_bf16 v[120:123], a[40:43], v[172:175], v[120:123]
    v_mfma_f32_16x16x32_bf16 v[124:127], a[44:47], v[172:175], v[124:127]
    v_mfma_f32_16x16x32_bf16 v[80:83], a[48:51], v[180:183], v[80:83]
    v_mfma_f32_16x16x32_bf16 v[84:87], a[52:55], v[180:183], v[84:87]
    v_mfma_f32_16x16x32_bf16 v[88:91], a[56:59], v[180:183], v[88:91]
    v_mfma_f32_16x16x32_bf16 v[92:95], a[60:63], v[180:183], v[92:95]
    v_mfma_f32_16x16x32_bf16 v[96:99], a[48:51], v[184:187], v[96:99]
    v_mfma_f32_16x16x32_bf16 v[100:103], a[52:55], v[184:187], v[100:103]
    v_mfma_f32_16x16x32_bf16 v[104:107], a[56:59], v[184:187], v[104:107]
    v_mfma_f32_16x16x32_bf16 v[108:111], a[60:63], v[184:187], v[108:111]
    v_mfma_f32_16x16x32_bf16 v[112:115], a[48:51], v[188:191], v[112:115]
    v_mfma_f32_16x16x32_bf16 v[116:119], a[52:55], v[188:191], v[116:119]
    v_mfma_f32_16x16x32_bf16 v[120:123], a[56:59], v[188:191], v[120:123]
    v_mfma_f32_16x16x32_bf16 v[124:127], a[60:63], v[188:191], v[124:127]
    v_mfma_f32_16x16x32_bf16 v[64:67], a[48:51], v[176:179], v[64:67]
    v_mfma_f32_16x16x32_bf16 v[68:71], a[52:55], v[176:179], v[68:71]
    v_mfma_f32_16x16x32_bf16 v[72:75], a[56:59], v[176:179], v[72:75]
    v_mfma_f32_16x16x32_bf16 v[76:79], a[60:63], v[176:179], v[76:79]
    v_add_u32 v18, s33, v3
    ds_write_b128 v18, v[80:83] offset:0
    ds_write_b128 v18, v[84:87] offset:1024
    ds_write_b128 v18, v[88:91] offset:2048
    ds_write_b128 v18, v[92:95] offset:3072
    ds_write_b128 v18, v[96:99] offset:16768
    ds_write_b128 v18, v[100:103] offset:17792
    ds_write_b128 v18, v[104:107] offset:18816
    ds_write_b128 v18, v[108:111] offset:19840
    ds_write_b128 v18, v[112:115] offset:33536
    ds_write_b128 v18, v[116:119] offset:34560
    ds_write_b128 v18, v[120:123] offset:35584
    ds_write_b128 v18, v[124:127] offset:36608
    s_xor_b32 s36, s3, 1
    s_mul_i32 s36, s36, 4192
    v_add_u32 v8, s36, v3
    s_xor_b32 s36, s3, 2
    s_mul_i32 s36, s36, 4192
    v_add_u32 v9, s36, v3
    s_xor_b32 s36, s3, 3
    s_mul_i32 s36, s36, 4192
    v_add_u32 v10, s36, v3
    s_mov_b32 s12, s84
    s_mov_b32 s13, s85
    s_mov_b32 s14, 0x200000
    s_mov_b32 s15, 0x20000
    v_and_b32 v19, 1, v13
    v_lshrrev_b32 v20, 1, v13
    v_lshl_add_u32 v19, v19, 1, v20
    v_lshlrev_b32 v19, 4, v19
    v_lshl_add_u32 v19, v12, 10, v19
    s_waitcnt vmcnt(0)
    v_xor_b32 v131, s35, v131
    v_xor_b32 v135, s35, v135
    v_xor_b32 v139, s35, v139
    v_xor_b32 v143, s35, v143
    v_xor_b32 v147, s35, v147
    v_xor_b32 v151, s35, v151
    v_or3_b32 v131, v131, v135, v139
    v_or3_b32 v143, v143, v147, v151
    v_or_b32 v131, v131, v143
    v_cmp_ne_u32 vcc, 0, v131
    s_nop 0
    s_cmp_lg_u64 vcc, 0
    s_cbranch_scc1 L_xx
L_xx_ok:
    v_add_f32 v64, v64, v128
    v_add_f32 v65, v65, v129
    v_add_f32 v66, v66, v130
    v_add_f32 v67, v67, v132
    v_add_f32 v68, v68, v133
    v_add_f32 v69, v69, v134
    v_add_f32 v70, v70, v136
    v_add_f32 v71, v71, v137
    v_add_f32 v72, v72, v138
    v_add_f32 v73, v73, v140
    v_add_f32 v74, v74, v141
    v_add_f32 v75, v75, v142
    v_add_f32 v76, v76, v144
    v_add_f32 v77, v77, v145
    v_add_f32 v78, v78, v146
    v_add_f32 v79, v79, v148
    s_waitcnt lgkmcnt(0)
    s_barrier
    ds_read_b128 v[80:83], v8 offset:0
    ds_read_b128 v[84:87], v8 offset:1024
    ds_read_b128 v[88:91], v8 offset:2048
    ds_read_b128 v[92:95], v8 offset:3072
    ds_read_b128 v[96:99], v9 offset:16768
    ds_read_b128 v[100:103], v9 offset:17792
    ds_read_b128 v[104:107], v9 offset:18816
    ds_read_b128 v[108:111], v9 offset:19840
    ds_read_b128 v[112:115], v10 offset:33536
    ds_read_b128 v[116:119], v10 offset:34560
    ds_read_b128 v[120:123], v10 offset:35584
    ds_read_b128 v[124:127], v10 offset:36608
    s_waitcnt lgkmcnt(8)
    v_pk_add_f32 v[64:65], v[64:65], v[80:81]
    v_pk_add_f32 v[66:67], v[66:67], v[82:83]
    v_pk_add_f32 v[68:69], v[68:69], v[84:85]
    v_pk_add_f32 v[70:71], v[70:71], v[86:87]
    v_pk_add_f32 v[72:73], v[72:73], v[88:89]
    v_pk_add_f32 v[74:75], v[74:75], v[90:91]
    v_pk_add_f32 v[76:77], v[76:77], v[92:93]
    v_pk_add_f32 v[78:79], v[78:79], v[94:95]
    s_waitcnt lgkmcnt(0)
    v_pk_add_f32 v[96:97], v[96:97], v[112:113]
    v_pk_add_f32 v[98:99], v[98:99], v[114:115]
    v_pk_add_f32 v[100:101], v[100:101], v[116:117]
    v_pk_add_f32 v[102:103], v[102:103], v[118:119]
    v_pk_add_f32 v[104:105], v[104:105], v[120:121]
    v_pk_add_f32 v[106:107], v[106:107], v[122:123]
    v_pk_add_f32 v[108:109], v[108:109], v[124:125]
    v_pk_add_f32 v[110:111], v[110:111], v[126:127]
    v_pk_add_f32 v[64:65], v[64:65], v[96:97]
    v_pk_add_f32 v[66:67], v[66:67], v[98:99]
    v_pk_add_f32 v[68:69], v[68:69], v[100:101]
    v_pk_add_f32 v[70:71], v[70:71], v[102:103]
    v_pk_add_f32 v[72:73], v[72:73], v[104:105]
    v_pk_add_f32 v[74:75], v[74:75], v[106:107]
    v_pk_add_f32 v[76:77], v[76:77], v[108:109]
    v_pk_add_f32 v[78:79], v[78:79], v[110:111]
    v_cvt_pk_bf16_f32 v80, v64, v65
    v_cvt_pk_bf16_f32 v81, v66, v67
    v_cvt_pk_bf16_f32 v82, v68, v69
    v_cvt_pk_bf16_f32 v83, v70, v71
    v_cvt_pk_bf16_f32 v84, v72, v73
    v_cvt_pk_bf16_f32 v85, v74, v75
    v_cvt_pk_bf16_f32 v86, v76, v77
    v_cvt_pk_bf16_f32 v87, v78, v79
    v_lshlrev_b32 v64, 16, v80
    v_and_b32 v65, 0xffff0000, v80
    v_lshlrev_b32 v66, 16, v81
    v_and_b32 v67, 0xffff0000, v81
    v_lshlrev_b32 v68, 16, v82
    v_and_b32 v69, 0xffff0000, v82
    v_lshlrev_b32 v70, 16, v83
    v_and_b32 v71, 0xffff0000, v83
    v_lshlrev_b32 v72, 16, v84
    v_and_b32 v73, 0xffff0000, v84
    v_lshlrev_b32 v74, 16, v85
    v_and_b32 v75, 0xffff0000, v85
    v_lshlrev_b32 v76, 16, v86
    v_and_b32 v77, 0xffff0000, v86
    v_lshlrev_b32 v78, 16, v87
    v_and_b32 v79, 0xffff0000, v87
    v_pk_mul_f32 v[64:65], v[64:65], v[48:49]
    v_pk_mul_f32 v[66:67], v[66:67], v[50:51]
    v_pk_mul_f32 v[68:69], v[68:69], v[52:53]
    v_pk_mul_f32 v[70:71], v[70:71], v[54:55]
    v_pk_mul_f32 v[72:73], v[72:73], v[56:57]
    v_pk_mul_f32 v[74:75], v[74:75], v[58:59]
    v_pk_mul_f32 v[76:77], v[76:77], v[60:61]
    v_pk_mul_f32 v[78:79], v[78:79], v[62:63]
    v_cvt_pk_bf16_f32 v80, v64, v65
    v_cvt_pk_bf16_f32 v81, v66, v67
    v_cvt_pk_bf16_f32 v82, v68, v69
    v_cvt_pk_bf16_f32 v83, v70, v71
    v_cvt_pk_bf16_f32 v84, v72, v73
    v_cvt_pk_bf16_f32 v85, v74, v75
    v_cvt_pk_bf16_f32 v86, v76, v77
    v_cvt_pk_bf16_f32 v87, v78, v79
    v_lshlrev_b32 v64, 16, v80
    v_and_b32 v65, 0xffff0000, v80
    v_lshlrev_b32 v66, 16, v81
    v_and_b32 v67, 0xffff0000, v81
    v_lshlrev_b32 v68, 16, v82
    v_and_b32 v69, 0xffff0000, v82
    v_lshlrev_b32 v70, 16, v83
    v_and_b32 v71, 0xffff0000, v83
    v_lshlrev_b32 v72, 16, v84
    v_and_b32 v73, 0xffff0000, v84
    v_lshlrev_b32 v74, 16, v85
    v_and_b32 v75, 0xffff0000, v85
    v_lshlrev_b32 v76, 16, v86
    v_and_b32 v77, 0xffff0000, v86
    v_lshlrev_b32 v78, 16, v87
    v_and_b32 v79, 0xffff0000, v87
    v_pk_add_f32 v[64:65], v[64:65], v[240:241]
    v_pk_add_f32 v[66:67], v[66:67], v[242:243]
    v_pk_add_f32 v[68:69], v[68:69], v[244:245]
    v_pk_add_f32 v[70:71], v[70:71], v[246:247]
    v_pk_add_f32 v[72:73], v[72:73], v[248:249]
    v_pk_add_f32 v[74:75], v[74:75], v[250:251]
    v_pk_add_f32 v[76:77], v[76:77], v[252:253]
    v_pk_add_f32 v[78:79], v[78:79], v[254:255]
    v_cvt_pk_bf16_f32 v80, v64, v65
    v_cvt_pk_bf16_f32 v81, v66, v67
    v_cvt_pk_bf16_f32 v82, v68, v69
    v_cvt_pk_bf16_f32 v83, v70, v71
    v_cvt_pk_bf16_f32 v84, v72, v73
    v_cvt_pk_bf16_f32 v85, v74, v75
    v_cvt_pk_bf16_f32 v86, v76, v77
    v_cvt_pk_bf16_f32 v87, v78, v79
    v_permlane16_swap_b32 v80, v82
    v_permlane16_swap_b32 v81, v83
    v_permlane16_swap_b32 v84, v86
    v_permlane16_swap_b32 v85, v87
    buffer_store_dwordx4 v[80:83], v19, s[12:15], s46 offen offset:0
    buffer_store_dwordx4 v[84:87], v19, s[12:15], s46 offen offset:64
L_end:
    s_endpgm
L_sp1x:
    s_mov_b32 s55, 0
L_sp1x1:
    s_sleep 4
    buffer_load_dwordx2 v[48:49], v43, s[20:23], s48 offen offset:0 sc1
    buffer_load_dwordx2 v[50:51], v43, s[20:23], s48 offen offset:1024 sc1
    buffer_load_dwordx2 v[52:53], v43, s[20:23], s48 offen offset:2048 sc1
    buffer_load_dwordx2 v[54:55], v43, s[20:23], s48 offen offset:3072 sc1
    s_waitcnt vmcnt(0)
    v_xor_b32 v16, v49, v51
    v_xor_b32 v17, v53, v55
    v_xor_b32 v19, s35, v49
    v_or3_b32 v16, v16, v17, v19
    v_xor_b32 v17, s35, v53
    v_or_b32 v16, v16, v17
    v_cmp_ne_u32 vcc, 0, v16
    s_nop 0
    s_cmp_eq_u64 vcc, 0
    s_cbranch_scc1 L_sp1_ok
    s_add_u32 s55, s55, 1
    s_cmp_lt_u32 s55, 131072
    s_cbranch_scc1 L_sp1x1
    s_branch L_sp1_ok
L_fq:
    s_mov_b32 s55, 0
L_fq1:
    buffer_load_dword v19, v1, s[20:23], s51 offen sc1
    s_waitcnt vmcnt(0)
    v_cmp_ne_u32 vcc, s35, v19
    s_nop 0
    s_cmp_eq_u64 vcc, 0
    s_cbranch_scc1 L_fq_ok
    s_sleep 6
    s_add_u32 s55, s55, 1
    s_cmp_lt_u32 s55, 131072
    s_cbranch_scc1 L_fq1
    s_branch L_fq_ok
L_xx:
    s_mov_b32 s55, 0
L_xx1:
    s_sleep 4
    buffer_load_dwordx4 v[128:131], v3, s[20:23], s51 offen offset:0 sc1
    buffer_load_dwordx4 v[132:135], v3, s[20:23], s51 offen offset:1024 sc1
    buffer_load_dwordx4 v[136:139], v3, s[20:23], s51 offen offset:2048 sc1
    buffer_load_dwordx4 v[140:143], v3, s[20:23], s51 offen offset:3072 sc1
    buffer_load_dwordx4 v[144:147], v3, s[20:23], s25 offen offset:0 sc1
    buffer_load_dwordx4 v[148:151], v3, s[20:23], s25 offen offset:1024 sc1
    s_waitcnt vmcnt(0)
    v_xor_b32 v131, s35, v131
    v_xor_b32 v135, s35, v135
    v_xor_b32 v139, s35, v139
    v_xor_b32 v143, s35, v143
    v_xor_b32 v147, s35, v147
    v_xor_b32 v151, s35, v151
    v_or3_b32 v131, v131, v135, v139
    v_or3_b32 v143, v143, v147, v151
    v_or_b32 v131, v131, v143
    v_cmp_ne_u32 vcc, 0, v131
    s_nop 0
    s_cmp_eq_u64 vcc, 0
    s_cbranch_scc1 L_xx_ok
    s_add_u32 s55, s55, 1
    s_cmp_lt_u32 s55, 131072
    s_cbranch_scc1 L_xx1
    s_branch L_xx_ok
L_gx:
    s_mov_b32 s55, 0
L_gx1:
    s_sleep 4
    buffer_load_dwordx2 v[22:23], v14, s[20:23], s48 offen sc1
    s_waitcnt vmcnt(0)
    v_cmp_ne_u32 vcc, s35, v23
    s_nop 0
    s_cmp_eq_u64 vcc, 0
    s_cbranch_scc1 L_gx_ok
    s_add_u32 s55, s55, 1
    s_cmp_lt_u32 s55, 131072
    s_cbranch_scc1 L_gx1
    s_branch L_gx_ok
L_px:
    s_mov_b32 s55, 0
L_px1:
    s_sleep 4
    buffer_load_dwordx2 v[68:69], v66, s[20:23], s37 offen sc1
    s_waitcnt vmcnt(0)
    v_cmp_ne_u32 vcc, s35, v69
    s_nop 0
    s_cmp_eq_u64 vcc, 0
    s_cbranch_scc1 L_px_ok
    s_add_u32 s55, s55, 1
    s_cmp_lt_u32 s55, 131072
    s_cbranch_scc1 L_px1
    s_branch L_px_ok
L_slow:
    s_cmp_lg_u32 s49, 0
    s_cbranch_scc1 L_slow_back
    s_waitcnt vmcnt(0) lgkmcnt(0)
    v_and_b32 v20, 1, v13
    v_lshrrev_b32 v21, 1, v13
    v_lshl_add_u32 v20, v20, 1, v21
    v_lshlrev_b32 v20, 4, v20
    v_lshl_add_u32 v20, v12, 8, v20
    s_mov_b32 s36, 0
    v_mov_b32 v16, 0xff800000
    v_mov_b32 v17, 0xff800000
    v_mov_b32 v18, 0xff800000
    v_mov_b32 v19, 0xff800000
L_sl1:
    buffer_load_dwordx4 v[64:67], v20, s[12:15], s36 offen offset:0
    buffer_load_dwordx4 v[68:71], v20, s[12:15], s36 offen offset:64
    buffer_load_dwordx4 v[72:75], v20, s[12:15], s36 offen offset:128
    buffer_load_dwordx4 v[76:79], v20, s[12:15], s36 offen offset:192
    s_waitcnt vmcnt(0)
    v_mfma_f32_16x16x32_bf16 v[80:83], v[64:67], a[0:3], 0
    v_mfma_f32_16x16x32_bf16 v[80:83], v[68:71], a[4:7], v[80:83]
    v_mfma_f32_16x16x32_bf16 v[80:83], v[72:75], a[8:11], v[80:83]
    v_mfma_f32_16x16x32_bf16 v[80:83], v[76:79], a[12:15], v[80:83]
    v_mfma_f32_16x16x32_bf16 v[84:87], v[64:67], a[16:19], 0
    v_mfma_f32_16x16x32_bf16 v[84:87], v[68:71], a[20:23], v[84:87]
    v_mfma_f32_16x16x32_bf16 v[84:87], v[72:75], a[24:27], v[84:87]
    v_mfma_f32_16x16x32_bf16 v[84:87], v[76:79], a[28:31], v[84:87]
    v_mfma_f32_16x16x32_bf16 v[88:91], v[64:67], a[32:35], 0
    v_mfma_f32_16x16x32_bf16 v[88:91], v[68:71], a[36:39], v[88:91]
    v_mfma_f32_16x16x32_bf16 v[88:91], v[72:75], a[40:43], v[88:91]
    v_mfma_f32_16x16x32_bf16 v[88:91], v[76:79], a[44:47], v[88:91]
    v_mfma_f32_16x16x32_bf16 v[92:95], v[64:67], a[48:51], 0
    v_mfma_f32_16x16x32_bf16 v[92:95], v[68:71], a[52:55], v[92:95]
    v_mfma_f32_16x16x32_bf16 v[92:95], v[72:75], a[56:59], v[92:95]
    v_mfma_f32_16x16x32_bf16 v[92:95], v[76:79], a[60:63], v[92:95]
    s_nop 7
    v_max3_f32 v16, v16, v80, v81
    v_max3_f32 v16, v16, v82, v83
    v_max3_f32 v17, v17, v84, v85
    v_max3_f32 v17, v17, v86, v87
    v_max3_f32 v18, v18, v88, v89
    v_max3_f32 v18, v18, v90, v91
    v_max3_f32 v19, v19, v92, v93
    v_max3_f32 v19, v19, v94, v95
    s_add_u32 s36, s36, 4096
    s_cmp_lt_u32 s36, 0x20000
    s_cbranch_scc1 L_sl1
    v_mov_b32 v24, v16
    v_mov_b32 v25, v17
    v_mov_b32 v26, v18
    v_mov_b32 v27, v19
    v_permlane16_swap_b32 v16, v24
    v_permlane16_swap_b32 v17, v25
    v_permlane16_swap_b32 v18, v26
    v_permlane16_swap_b32 v19, v27
    v_max_f32 v16, v16, v24
    v_max_f32 v17, v17, v25
    v_max_f32 v18, v18, v26
    v_max_f32 v19, v19, v27
    v_mov_b32 v24, v16
    v_mov_b32 v25, v17
    v_mov_b32 v26, v18
    v_mov_b32 v27, v19
    v_permlane32_swap_b32 v16, v24
    v_permlane32_swap_b32 v17, v25
    v_permlane32_swap_b32 v18, v26
    v_permlane32_swap_b32 v19, v27
    v_max_f32 v16, v16, v24
    v_max_f32 v17, v17, v25
    v_max_f32 v18, v18, v26
    v_max_f32 v19, v19, v27
    v_lshlrev_b32 v20, 4, v12
    v_lshl_add_u32 v20, s3, 8, v20
    v_add_u32 v20, 159360, v20
    ds_write_b128 v20, v[16:19]
    v_lshl_add_u32 v0, s3, 6, v2
    s_mov_b32 s49, 1
    s_waitcnt lgkmcnt(0)
    s_barrier
    s_branch L_restart
L_fp:
    s_mov_b32 s55, 0
L_fp1:
    buffer_load_dword v19, v1, s[20:23], s51 offen sc1
    s_waitcnt vmcnt(0)
    v_cmp_ne_u32 vcc, s35, v19
    s_nop 0
    s_cmp_eq_u64 vcc, 0
    s_cbranch_scc1 L_fp2
    s_sleep 6
    s_add_u32 s55, s55, 1
    s_cmp_lt_u32 s55, 131072
    s_cbranch_scc1 L_fp1
L_fp2:
    s_branch L_fp_ok
L_keys:
    s_mov_b32 s55, 0
L_ky1:
    v_readlane_b32 s60, v2, 0
    v_readlane_b32 s61, v2, 1
    v_readlane_b32 s62, v2, 2
    v_readlane_b32 s63, v2, 3
    v_readlane_b32 s90, v2, 4
    v_readlane_b32 s91, v2, 5
    v_readlane_b32 s96, v2, 6
    v_readlane_b32 s97, v2, 7
    s_nop 0
    s_min_u32 s36, s61, s63
    s_min_u32 s37, s91, s97
    s_min_u32 s36, s36, s37
    s_max_u32 s61, s61, s63
    s_min_u32 s63, s60, s62
    s_max_u32 s60, s60, s62
    s_max_u32 s61, s61, s63
    s_max_u32 s91, s91, s97
    s_min_u32 s97, s90, s96
    s_max_u32 s90, s90, s96
    s_max_u32 s91, s91, s97
    s_max_u32 s61, s61, s91
    s_min_u32 s91, s60, s90
    s_max_u32 s42, s60, s90
    s_max_u32 s43, s61, s91
    s_cmp_lg_u32 s36, 0
    s_cbranch_scc1 L_ky2
    s_sleep 8
    global_load_dword v2, v11, s[86:87] offset:128 sc1
    s_waitcnt vmcnt(0)
    s_add_u32 s55, s55, 1
    s_cmp_lt_u32 s55, 131072
    s_cbranch_scc1 L_ky1
L_ky2:
    v_mov_b32 v64, s42
    v_mov_b32 v65, s43
    s_mov_b32 s4, s64
    s_mov_b32 s5, s65
    s_mov_b32 s6, 0x200000
    s_mov_b32 s7, 0x20000
    v_cmp_gt_u32 vcc, 512, v3
    s_nop 1
    v_cndmask_b32 v66, v65, v64, vcc
    v_not_b32 v66, v66
    v_and_b32 v66, 2047, v66
    v_and_b32 v67, 0x1f0, v3
    v_lshlrev_b32 v67, 1, v67
    v_lshl_add_u32 v67, v66, 10, v67
    v_lshlrev_b32 v66, 6, v66
    s_mov_b32 s60, 24117248
    buffer_load_dwordx4 v[80:83], v67, s[4:7], 0 offen
    buffer_load_dwordx4 v[84:87], v67, s[4:7], 0 offen offset:16
    buffer_load_dwordx2 v[68:69], v66, s[20:23], s60 offen sc1
    s_branch L_nokeys
L_hk2:
    v_accvgpr_write_b32 a225, v4
    v_mbcnt_lo_u32_b32 v4, -1, 0
    v_mbcnt_hi_u32_b32 v4, -1, v4
    v_lshlrev_b32 v4, 6, v4
    s_lshl_b32 s60, s3, 15
    s_add_u32 s60, s60, 24117304
    buffer_load_dword a192, v4, s[20:23], s60 offen sc1
    s_add_u32 s60, s60, 4096
    buffer_load_dword a193, v4, s[20:23], s60 offen sc1
    s_add_u32 s60, s60, 4096
    buffer_load_dword a194, v4, s[20:23], s60 offen sc1
    s_add_u32 s60, s60, 4096
    buffer_load_dword a195, v4, s[20:23], s60 offen sc1
    s_add_u32 s60, s60, 4096
    buffer_load_dword a196, v4, s[20:23], s60 offen sc1
    s_add_u32 s60, s60, 4096
    buffer_load_dword a197, v4, s[20:23], s60 offen sc1
    s_add_u32 s60, s60, 4096
    buffer_load_dword a198, v4, s[20:23], s60 offen sc1
    s_add_u32 s60, s60, 4096
    buffer_load_dword a199, v4, s[20:23], s60 offen sc1
    s_add_u32 s60, s60, 4096
    v_accvgpr_read_b32 v4, a225
    s_nop 1
    s_branch L_hk2b
L_hk3:
    s_waitcnt vmcnt(13)
    v_accvgpr_write_b32 a224, v3
    v_accvgpr_write_b32 a225, v4
    v_accvgpr_write_b32 a226, v7
    v_accvgpr_write_b32 a227, v8
    v_accvgpr_write_b32 a228, v9
    v_accvgpr_write_b32 a229, v10
    s_mov_b32 s55, 0
    s_mov_b32 s61, 0xffff
L_hk31:
    v_mbcnt_lo_u32_b32 v4, -1, 0
    v_mbcnt_hi_u32_b32 v4, -1, v4
    v_lshl_add_u32 v10, s3, 9, v4
    v_sub_u32 v10, 0xffff, v10
    v_mov_b32 v8, 0
    v_mov_b32 v9, 0
    v_mov_b32 v7, 0
    v_accvgpr_read_b32 v3, a192
    v_subrev_u32 v4, 0, v10
    v_xor_b32 v11, s35, v3
    v_bfi_b32 v3, s61, v4, v3
    v_or_b32 v7, v7, v11
    v_med3_u32 v9, v8, v9, v3
    v_max_u32 v8, v8, v3
    v_accvgpr_read_b32 v3, a193
    v_subrev_u32 v4, 64, v10
    v_xor_b32 v11, s35, v3
    v_bfi_b32 v3, s61, v4, v3
    v_or_b32 v7, v7, v11
    v_med3_u32 v9, v8, v9, v3
    v_max_u32 v8, v8, v3
    v_accvgpr_read_b32 v3, a194
    v_subrev_u32 v4, 128, v10
    v_xor_b32 v11, s35, v3
    v_bfi_b32 v3, s61, v4, v3
    v_or_b32 v7, v7, v11
    v_med3_u32 v9, v8, v9, v3
    v_max_u32 v8, v8, v3
    v_accvgpr_read_b32 v3, a195
    v_subrev_u32 v4, 192, v10
    v_xor_b32 v11, s35, v3
    v_bfi_b32 v3, s61, v4, v3
    v_or_b32 v7, v7, v11
    v_med3_u32 v9, v8, v9, v3
    v_max_u32 v8, v8, v3
    v_accvgpr_read_b32 v3, a196
    v_subrev_u32 v4, 256, v10
    v_xor_b32 v11, s35, v3
    v_bfi_b32 v3, s61, v4, v3
    v_or_b32 v7, v7, v11
    v_med3_u32 v9, v8, v9, v3
    v_max_u32 v8, v8, v3
    v_accvgpr_read_b32 v3, a197
    v_subrev_u32 v4, 320, v10
    v_xor_b32 v11, s35, v3
    v_bfi_b32 v3, s61, v4, v3
    v_or_b32 v7, v7, v11
    v_med3_u32 v9, v8, v9, v3
    v_max_u32 v8, v8, v3
    v_accvgpr_read_b32 v3, a198
    v_subrev_u32 v4, 384, v10
    v_xor_b32 v11, s35, v3
    v_bfi_b32 v3, s61, v4, v3
    v_or_b32 v7, v7, v11
    v_med3_u32 v9, v8, v9, v3
    v_max_u32 v8, v8, v3
    v_accvgpr_read_b32 v3, a199
    v_subrev_u32 v4, 448, v10
    v_xor_b32 v11, s35, v3
    v_bfi_b32 v3, s61, v4, v3
    v_or_b32 v7, v7, v11
    v_med3_u32 v9, v8, v9, v3
    v_max_u32 v8, v8, v3
    v_and_b32 v7, 0xffff, v7
    v_cmp_ne_u32 vcc, 0, v7
    s_nop 0
    s_cmp_eq_u64 vcc, 0
    s_cbranch_scc1 L_hk32
    s_sleep 8
    v_mbcnt_lo_u32_b32 v4, -1, 0
    v_mbcnt_hi_u32_b32 v4, -1, v4
    v_lshlrev_b32 v4, 6, v4
    s_lshl_b32 s60, s3, 15
    s_add_u32 s60, s60, 24117304
    buffer_load_dword a192, v4, s[20:23], s60 offen sc1
    s_add_u32 s60, s60, 4096
    buffer_load_dword a193, v4, s[20:23], s60 offen sc1
    s_add_u32 s60, s60, 4096
    buffer_load_dword a194, v4, s[20:23], s60 offen sc1
    s_add_u32 s60, s60, 4096
    buffer_load_dword a195, v4, s[20:23], s60 offen sc1
    s_add_u32 s60, s60, 4096
    buffer_load_dword a196, v4, s[20:23], s60 offen sc1
    s_add_u32 s60, s60, 4096
    buffer_load_dword a197, v4, s[20:23], s60 offen sc1
    s_add_u32 s60, s60, 4096
    buffer_load_dword a198, v4, s[20:23], s60 offen sc1
    s_add_u32 s60, s60, 4096
    buffer_load_dword a199, v4, s[20:23], s60 offen sc1
    s_add_u32 s60, s60, 4096
    s_waitcnt vmcnt(0)
    s_add_u32 s55, s55, 1
    s_cmp_lt_u32 s55, 131072
    s_cbranch_scc1 L_hk31
L_hk32:
    v_mov_b32_dpp v3, v8 quad_perm:[1,0,3,2] row_mask:0xf bank_mask:0xf
    v_mov_b32_dpp v4, v9 quad_perm:[1,0,3,2] row_mask:0xf bank_mask:0xf
    v_min_u32 v7, v8, v3
    v_max_u32 v8, v8, v3
    v_max3_u32 v9, v9, v4, v7
    s_nop 0
    v_mov_b32_dpp v3, v8 quad_perm:[2,3,0,1] row_mask:0xf bank_mask:0xf
    v_mov_b32_dpp v4, v9 quad_perm:[2,3,0,1] row_mask:0xf bank_mask:0xf
    v_min_u32 v7, v8, v3
    v_max_u32 v8, v8, v3
    v_max3_u32 v9, v9, v4, v7
    s_nop 0
    v_mov_b32_dpp v3, v8 row_half_mirror row_mask:0xf bank_mask:0xf
    v_mov_b32_dpp v4, v9 row_half_mirror row_mask:0xf bank_mask:0xf
    v_min_u32 v7, v8, v3
    v_max_u32 v8, v8, v3
    v_max3_u32 v9, v9, v4, v7
    s_nop 0
    v_mov_b32_dpp v3, v8 row_mirror row_mask:0xf bank_mask:0xf
    v_mov_b32_dpp v4, v9 row_mirror row_mask:0xf bank_mask:0xf
    v_min_u32 v7, v8, v3
    v_max_u32 v8, v8, v3
    v_max3_u32 v9, v9, v4, v7
    v_mov_b32 v3, v8
    v_mov_b32 v4, v9
    s_nop 0
    v_permlane16_swap_b32 v8, v3
    v_permlane16_swap_b32 v9, v4
    v_min_u32 v7, v8, v3
    v_max_u32 v8, v8, v3
    v_max3_u32 v9, v9, v4, v7
    v_mov_b32 v3, v8
    v_mov_b32 v4, v9
    s_nop 0
    v_permlane32_swap_b32 v8, v3
    v_permlane32_swap_b32 v9, v4
    v_min_u32 v7, v8, v3
    v_max_u32 v8, v8, v3
    v_max3_u32 v9, v9, v4, v7
    s_mov_b64 exec, 1
    s_lshl_b32 s60, s3, 3
    v_mov_b32 v10, s60
    global_store_dwordx2 v10, v[8:9], s[86:87] offset:128 sc1
    s_mov_b64 exec, -1
    s_nop 3
    v_accvgpr_read_b32 v3, a224
    v_accvgpr_read_b32 v4, a225
    v_accvgpr_read_b32 v7, a226
    v_accvgpr_read_b32 v8, a227
    v_accvgpr_read_b32 v9, a228
    v_accvgpr_read_b32 v10, a229
    s_nop 1
    s_branch L_hk3b
L_g3:
    s_mov_b32 s55, 0
L_g3c:
    v_readlane_b32 s60, v29, 0
    v_readlane_b32 s61, v29, 1
    v_readlane_b32 s62, v29, 2
    v_readlane_b32 s63, v29, 3
    v_readlane_b32 s90, v29, 4
    v_readlane_b32 s91, v29, 5
    v_readlane_b32 s96, v29, 6
    v_readlane_b32 s97, v29, 7
    s_nop 0
    s_min_u32 s36, s61, s63
    s_min_u32 s37, s91, s97
    s_min_u32 s36, s36, s37
    s_max_u32 s61, s61, s63
    s_min_u32 s63, s60, s62
    s_max_u32 s60, s60, s62
    s_max_u32 s61, s61, s63
    s_max_u32 s91, s91, s97
    s_min_u32 s97, s90, s96
    s_max_u32 s90, s90, s96
    s_max_u32 s91, s91, s97
    s_max_u32 s61, s61, s91
    s_min_u32 s91, s60, s90
    s_max_u32 s42, s60, s90
    s_max_u32 s43, s61, s91
    s_cmp_lg_u32 s36, 0
    s_cbranch_scc1 L_g3ok
    s_sleep 16
    global_load_dword v29, v18, s[86:87] offset:128 sc1
    s_waitcnt vmcnt(0)
    s_add_u32 s55, s55, 1
    s_cmp_lt_u32 s55, 131072
    s_cbranch_scc1 L_g3c
L_g3ok:
    s_not_b32 s44, s42
    s_and_b32 s44, s44, 2047
    s_not_b32 s45, s43
    s_and_b32 s45, s45, 2047
    s_lshl_b32 s36, s52, 2
    s_add_u32 s36, s36, s3
    s_lshr_b32 s37, s44, 4
    s_lshr_b32 s38, s45, 4
    s_cmp_eq_u32 s36, s37
    s_cselect_b32 s34, 1, 0
    s_cmp_eq_u32 s36, s38
    s_cselect_b32 s36, 2, 0
    s_or_b32 s34, s34, s36
    s_lshr_b32 s37, s37, 2
    s_lshr_b32 s38, s38, 2
    s_cmp_eq_u32 s52, s37
    s_cselect_b32 s39, 1, 0
    s_cmp_eq_u32 s52, s38
    s_cselect_b32 s37, 2, 0
    s_or_b32 s39, s39, s37
    s_branch L_gback
L_g3b:
    v_min_u32 v15, 42, v2
    v_lshlrev_b32 v15, 8, v15
    v_add_u32 v15, 24379392, v15
    buffer_load_dword v46, v15, s[20:23], 0 offen sc1
    buffer_load_dword v47, v15, s[20:23], 0 offen offset:128 sc1
    s_branch L_g3bk
L_g4:
    s_mov_b32 s55, 0
L_g4c:
    v_xor_b32 v46, s35, v46
    v_xor_b32 v47, s35, v47
    v_or_b32 v46, v46, v47
    v_cmp_ne_u32 vcc, 0, v46
    s_nop 0
    s_cmp_eq_u64 vcc, 0
    s_cbranch_scc1 L_g4ok
    s_sleep 4
    buffer_load_dword v46, v15, s[20:23], 0 offen sc1
    buffer_load_dword v47, v15, s[20:23], 0 offen offset:128 sc1
    s_waitcnt vmcnt(0)
    s_add_u32 s55, s55, 1
    s_cmp_lt_u32 s55, 131072
    s_cbranch_scc1 L_g4c
L_g4ok:
    s_add_u32 s16, s88, 16842752
    s_addc_u32 s17, s89, 0
    s_mov_b32 s18, 352256
    s_mov_b32 s19, 0x20000
    v_lshlrev_b32 v15, 12, v13
    v_lshl_add_u32 v15, v12, 4, v15
    s_lshl_b32 s36, s53, 8
    s_lshl_b32 s37, s3, 14
    s_add_u32 s36, s36, s37
    v_add_u32 v15, s36, v15
    s_bitcmp1_b32 s39, 0
    s_cbranch_scc0 L_pl0
    v_mov_b32 v20, v15
    buffer_load_dwordx4 v[192:195], v20, s[16:19], 0 offen offset:0 sc1
    v_add_u32 v20, 0x10000, v20
    buffer_load_dwordx4 v[196:199], v20, s[16:19], 0 offen offset:0 sc1
    v_add_u32 v20, 0x10000, v20
    buffer_load_dwordx4 v[200:203], v20, s[16:19], 0 offen offset:0 sc1
    v_add_u32 v20, 0x10000, v20
    buffer_load_dwordx4 v[204:207], v20, s[16:19], 0 offen offset:0 sc1
    v_add_u32 v20, 0x10000, v20
    buffer_load_dwordx4 v[208:211], v20, s[16:19], 0 offen offset:0 sc1
    v_add_u32 v20, 0x10000, v20
    buffer_load_dwordx4 v[212:215], v20, s[16:19], 0 offen offset:0 sc1
    v_add_u32 v20, 0x10000, v20
L_pl0:
    s_bitcmp1_b32 s39, 1
    s_cbranch_scc0 L_pl1
    v_mov_b32 v20, v15
    buffer_load_dwordx4 v[216:219], v20, s[16:19], 0 offen offset:2048 sc1
    v_add_u32 v20, 0x10000, v20
    buffer_load_dwordx4 v[220:223], v20, s[16:19], 0 offen offset:2048 sc1
    v_add_u32 v20, 0x10000, v20
    buffer_load_dwordx4 v[224:227], v20, s[16:19], 0 offen offset:2048 sc1
    v_add_u32 v20, 0x10000, v20
    buffer_load_dwordx4 v[228:231], v20, s[16:19], 0 offen offset:2048 sc1
    v_add_u32 v20, 0x10000, v20
    buffer_load_dwordx4 v[232:235], v20, s[16:19], 0 offen offset:2048 sc1
    v_add_u32 v20, 0x10000, v20
    buffer_load_dwordx4 v[236:239], v20, s[16:19], 0 offen offset:2048 sc1
    v_add_u32 v20, 0x10000, v20
L_pl1:
    s_branch L_g4back
L_c1:
    s_waitcnt vmcnt(16)
    s_lshl_b32 s36, s3, 8
    s_add_u32 s36, s36, 134144
    v_lshl_add_u32 v20, v12, 4, s36
    s_bitcmp1_b32 s39, 0
    s_cbranch_scc0 L_c10
    v_pk_add_f32 v[192:193], v[192:193], v[196:197]
    v_pk_add_f32 v[194:195], v[194:195], v[198:199]
    v_pk_add_f32 v[192:193], v[192:193], v[200:201]
    v_pk_add_f32 v[194:195], v[194:195], v[202:203]
    v_pk_add_f32 v[192:193], v[192:193], v[204:205]
    v_pk_add_f32 v[194:195], v[194:195], v[206:207]
    v_pk_add_f32 v[192:193], v[192:193], v[208:209]
    v_pk_add_f32 v[194:195], v[194:195], v[210:211]
    v_pk_add_f32 v[192:193], v[192:193], v[212:213]
    v_pk_add_f32 v[194:195], v[194:195], v[214:215]
    v_mov_b32 v196, v192
    v_mov_b32 v197, v193
    v_mov_b32 v198, v194
    v_mov_b32 v199, v195
    v_permlane16_swap_b32 v192, v196
    v_permlane16_swap_b32 v193, v197
    v_permlane16_swap_b32 v194, v198
    v_permlane16_swap_b32 v195, v199
    v_add_f32 v192, v192, v196
    v_add_f32 v193, v193, v197
    v_add_f32 v194, v194, v198
    v_add_f32 v195, v195, v199
    v_mov_b32 v196, v192
    v_mov_b32 v197, v193
    v_mov_b32 v198, v194
    v_mov_b32 v199, v195
    v_permlane32_swap_b32 v192, v196
    v_permlane32_swap_b32 v193, v197
    v_permlane32_swap_b32 v194, v198
    v_permlane32_swap_b32 v195, v199
    v_add_f32 v192, v192, v196
    v_add_f32 v193, v193, v197
    v_add_f32 v194, v194, v198
    v_add_f32 v195, v195, v199
    ds_write_b128 v20, v[192:195] offset:0
L_c10:
    s_bitcmp1_b32 s39, 1
    s_cbranch_scc0 L_c11
    v_pk_add_f32 v[216:217], v[216:217], v[220:221]
    v_pk_add_f32 v[218:219], v[218:219], v[222:223]
    v_pk_add_f32 v[216:217], v[216:217], v[224:225]
    v_pk_add_f32 v[218:219], v[218:219], v[226:227]
    v_pk_add_f32 v[216:217], v[216:217], v[228:229]
    v_pk_add_f32 v[218:219], v[218:219], v[230:231]
    v_pk_add_f32 v[216:217], v[216:217], v[232:233]
    v_pk_add_f32 v[218:219], v[218:219], v[234:235]
    v_pk_add_f32 v[216:217], v[216:217], v[236:237]
    v_pk_add_f32 v[218:219], v[218:219], v[238:239]
    v_mov_b32 v220, v216
    v_mov_b32 v221, v217
    v_mov_b32 v222, v218
    v_mov_b32 v223, v219
    v_permlane16_swap_b32 v216, v220
    v_permlane16_swap_b32 v217, v221
    v_permlane16_swap_b32 v218, v222
    v_permlane16_swap_b32 v219, v223
    v_add_f32 v216, v216, v220
    v_add_f32 v217, v217, v221
    v_add_f32 v218, v218, v222
    v_add_f32 v219, v219, v223
    v_mov_b32 v220, v216
    v_mov_b32 v221, v217
    v_mov_b32 v222, v218
    v_mov_b32 v223, v219
    v_permlane32_swap_b32 v216, v220
    v_permlane32_swap_b32 v217, v221
    v_permlane32_swap_b32 v218, v222
    v_permlane32_swap_b32 v219, v223
    v_add_f32 v216, v216, v220
    v_add_f32 v217, v217, v221
    v_add_f32 v218, v218, v222
    v_add_f32 v219, v219, v223
    ds_write_b128 v20, v[216:219] offset:1024
L_c11:
    s_lshl_b32 s36, s3, 2
    s_add_u32 s36, s36, 136192
    v_mov_b32 v20, s36
    s_waitcnt lgkmcnt(0)
    ds_write_b32 v20, v17
    s_branch L_c1_back
L_cons:
    s_mov_b32 s55, 0
    v_and_b32 v20, 12, v18
    v_add_u32 v20, 136192, v20
L_cw:
    ds_read_b32 v21, v20
    s_waitcnt lgkmcnt(0)
    v_cmp_ne_u32 vcc, s35, v21
    s_nop 0
    s_cmp_eq_u64 vcc, 0
    s_cbranch_scc1 L_cn
    s_sleep 1
    s_add_u32 s55, s55, 1
    s_cmp_lt_u32 s55, 1048576
    s_cbranch_scc1 L_cw
L_cn:
    s_bitcmp1_b32 s34, 0
    s_cselect_b32 s36, s42, s43
    s_cselect_b32 s60, s44, s45
    s_cselect_b32 s61, 0, 1024
    s_add_u32 s61, s61, 134144
    v_lshl_add_u32 v20, v12, 4, s61
    ds_read_b128 v[192:195], v20
    ds_read_b128 v[196:199], v20 offset:256
    ds_read_b128 v[200:203], v20 offset:512
    ds_read_b128 v[204:207], v20 offset:768
    s_and_b32 s60, s60, 15
    s_and_b32 s36, s36, 0xffff0000
    s_xor_b32 s37, s36, 0x80000000
    s_xor_b32 s38, s36, 0xffff0000
    s_bitcmp1_b32 s36, 31
    s_cselect_b32 s36, s37, s38
    v_mov_b32 v15, s36
    v_mul_f32 v21, 0xbfb8aa3b, v15
    v_exp_f32 v21, v21
    s_nop 0
    v_add_f32 v21, 1.0, v21
    v_rcp_f32 v15, v21
    s_nop 0
    v_cvt_pk_bf16_f32 v15, v15, v15
    v_and_b32 v15, 0xffff0000, v15
    v_lshl_add_u32 v21, v13, 4, s61
    s_waitcnt lgkmcnt(0)
    v_add_f32 v192, v192, v196
    v_add_f32 v193, v193, v197
    v_add_f32 v194, v194, v198
    v_add_f32 v195, v195, v199
    v_add_f32 v192, v192, v200
    v_add_f32 v193, v193, v201
    v_add_f32 v194, v194, v202
    v_add_f32 v195, v195, v203
    v_add_f32 v192, v192, v204
    v_add_f32 v193, v193, v205
    v_add_f32 v194, v194, v206
    v_add_f32 v195, v195, v207
    v_cvt_pk_bf16_f32 v192, v192, v192
    v_and_b32 v192, 0xffff0000, v192
    v_cvt_pk_bf16_f32 v193, v193, v193
    v_and_b32 v193, 0xffff0000, v193
    v_cvt_pk_bf16_f32 v194, v194, v194
    v_and_b32 v194, 0xffff0000, v194
    v_cvt_pk_bf16_f32 v195, v195, v195
    v_and_b32 v195, 0xffff0000, v195
    v_mul_f32 v192, v192, v15
    v_mul_f32 v193, v193, v15
    v_mul_f32 v194, v194, v15
    v_mul_f32 v195, v195, v15
    v_cvt_pk_bf16_f32 v192, v192, v192
    v_and_b32 v192, 0xffff0000, v192
    v_cvt_pk_bf16_f32 v193, v193, v193
    v_and_b32 v193, 0xffff0000, v193
    v_cvt_pk_bf16_f32 v194, v194, v194
    v_and_b32 v194, 0xffff0000, v194
    v_cvt_pk_bf16_f32 v195, v195, v195
    v_and_b32 v195, 0xffff0000, v195
    ds_write_b128 v20, v[192:195]
    s_waitcnt lgkmcnt(0)
    ds_read_b128 v[208:211], v21 offset:0
    ds_read_b128 v[212:215], v21 offset:64
    ds_read_b128 v[216:219], v21 offset:128
    ds_read_b128 v[220:223], v21 offset:192
    v_lshlrev_b32 v48, 16, v32
    v_and_b32 v49, 0xffff0000, v32
    v_lshlrev_b32 v50, 16, v33
    v_and_b32 v51, 0xffff0000, v33
    v_lshlrev_b32 v52, 16, v34
    v_and_b32 v53, 0xffff0000, v34
    v_lshlrev_b32 v54, 16, v35
    v_and_b32 v55, 0xffff0000, v35
    v_lshlrev_b32 v56, 16, v36
    v_and_b32 v57, 0xffff0000, v36
    v_lshlrev_b32 v58, 16, v37
    v_and_b32 v59, 0xffff0000, v37
    v_lshlrev_b32 v60, 16, v38
    v_and_b32 v61, 0xffff0000, v38
    v_lshlrev_b32 v62, 16, v39
    v_and_b32 v63, 0xffff0000, v39
    v_cmp_eq_u32 vcc, s60, v12
    s_waitcnt lgkmcnt(0)
    s_nop 0
    v_cndmask_b32 v208, 0, v208, vcc
    v_cndmask_b32 v209, 0, v209, vcc
    v_cndmask_b32 v210, 0, v210, vcc
    v_cndmask_b32 v211, 0, v211, vcc
    v_cndmask_b32 v212, 0, v212, vcc
    v_cndmask_b32 v213, 0, v213, vcc
    v_cndmask_b32 v214, 0, v214, vcc
    v_cndmask_b32 v215, 0, v215, vcc
    v_cndmask_b32 v216, 0, v216, vcc
    v_cndmask_b32 v217, 0, v217, vcc
    v_cndmask_b32 v218, 0, v218, vcc
    v_cndmask_b32 v219, 0, v219, vcc
    v_cndmask_b32 v220, 0, v220, vcc
    v_cndmask_b32 v221, 0, v221, vcc
    v_cndmask_b32 v222, 0, v222, vcc
    v_cndmask_b32 v223, 0, v223, vcc
    v_add_f32 v48, v48, v208
    v_add_f32 v49, v49, v209
    v_add_f32 v50, v50, v210
    v_add_f32 v51, v51, v211
    v_add_f32 v52, v52, v212
    v_add_f32 v53, v53, v213
    v_add_f32 v54, v54, v214
    v_add_f32 v55, v55, v215
    v_add_f32 v56, v56, v216
    v_add_f32 v57, v57, v217
    v_add_f32 v58, v58, v218
    v_add_f32 v59, v59, v219
    v_add_f32 v60, v60, v220
    v_add_f32 v61, v61, v221
    v_add_f32 v62, v62, v222
    v_add_f32 v63, v63, v223
    v_cvt_pk_bf16_f32 v32, v48, v49
    v_cvt_pk_bf16_f32 v33, v50, v51
    v_cvt_pk_bf16_f32 v34, v52, v53
    v_cvt_pk_bf16_f32 v35, v54, v55
    v_cvt_pk_bf16_f32 v36, v56, v57
    v_cvt_pk_bf16_f32 v37, v58, v59
    v_cvt_pk_bf16_f32 v38, v60, v61
    v_cvt_pk_bf16_f32 v39, v62, v63
    s_cmp_eq_u32 s34, 3
    s_mov_b32 s34, 2
    s_cbranch_scc1 L_cn
    v_lshlrev_b32 v48, 16, v32
    v_and_b32 v49, 0xffff0000, v32
    v_lshlrev_b32 v50, 16, v33
    v_and_b32 v51, 0xffff0000, v33
    v_lshlrev_b32 v52, 16, v34
    v_and_b32 v53, 0xffff0000, v34
    v_lshlrev_b32 v54, 16, v35
    v_and_b32 v55, 0xffff0000, v35
    v_lshlrev_b32 v56, 16, v36
    v_and_b32 v57, 0xffff0000, v36
    v_lshlrev_b32 v58, 16, v37
    v_and_b32 v59, 0xffff0000, v37
    v_lshlrev_b32 v60, 16, v38
    v_and_b32 v61, 0xffff0000, v38
    v_lshlrev_b32 v62, 16, v39
    v_and_b32 v63, 0xffff0000, v39
    v_mul_f32 v192, 0xbfb8aa3b, v48
    v_mul_f32 v193, 0xbfb8aa3b, v49
    v_mul_f32 v194, 0xbfb8aa3b, v50
    v_mul_f32 v195, 0xbfb8aa3b, v51
    v_mul_f32 v196, 0xbfb8aa3b, v52
    v_mul_f32 v197, 0xbfb8aa3b, v53
    v_mul_f32 v198, 0xbfb8aa3b, v54
    v_mul_f32 v199, 0xbfb8aa3b, v55
    v_mul_f32 v200, 0xbfb8aa3b, v56
    v_mul_f32 v201, 0xbfb8aa3b, v57
    v_mul_f32 v202, 0xbfb8aa3b, v58
    v_mul_f32 v203, 0xbfb8aa3b, v59
    v_mul_f32 v204, 0xbfb8aa3b, v60
    v_mul_f32 v205, 0xbfb8aa3b, v61
    v_mul_f32 v206, 0xbfb8aa3b, v62
    v_mul_f32 v207, 0xbfb8aa3b, v63
    v_exp_f32 v192, v192
    v_exp_f32 v193, v193
    v_exp_f32 v194, v194
    v_exp_f32 v195, v195
    v_exp_f32 v196, v196
    v_exp_f32 v197, v197
    v_exp_f32 v198, v198
    v_exp_f32 v199, v199
    v_exp_f32 v200, v200
    v_exp_f32 v201, v201
    v_exp_f32 v202, v202
    v_exp_f32 v203, v203
    v_exp_f32 v204, v204
    v_exp_f32 v205, v205
    v_exp_f32 v206, v206
    v_exp_f32 v207, v207
    v_add_f32 v192, 1.0, v192
    v_add_f32 v193, 1.0, v193
    v_add_f32 v194, 1.0, v194
    v_add_f32 v195, 1.0, v195
    v_add_f32 v196, 1.0, v196
    v_add_f32 v197, 1.0, v197
    v_add_f32 v198, 1.0, v198
    v_add_f32 v199, 1.0, v199
    v_add_f32 v200, 1.0, v200
    v_add_f32 v201, 1.0, v201
    v_add_f32 v202, 1.0, v202
    v_add_f32 v203, 1.0, v203
    v_add_f32 v204, 1.0, v204
    v_add_f32 v205, 1.0, v205
    v_add_f32 v206, 1.0, v206
    v_add_f32 v207, 1.0, v207
    v_rcp_f32 v192, v192
    v_rcp_f32 v193, v193
    v_rcp_f32 v194, v194
    v_rcp_f32 v195, v195
    v_rcp_f32 v196, v196
    v_rcp_f32 v197, v197
    v_rcp_f32 v198, v198
    v_rcp_f32 v199, v199
    v_rcp_f32 v200, v200
    v_rcp_f32 v201, v201
    v_rcp_f32 v202, v202
    v_rcp_f32 v203, v203
    v_rcp_f32 v204, v204
    v_rcp_f32 v205, v205
    v_rcp_f32 v206, v206
    v_rcp_f32 v207, v207
    v_mul_f32 v48, v48, v192
    v_mul_f32 v49, v49, v193
    v_mul_f32 v50, v50, v194
    v_mul_f32 v51, v51, v195
    v_mul_f32 v52, v52, v196
    v_mul_f32 v53, v53, v197
    v_mul_f32 v54, v54, v198
    v_mul_f32 v55, v55, v199
    v_mul_f32 v56, v56, v200
    v_mul_f32 v57, v57, v201
    v_mul_f32 v58, v58, v202
    v_mul_f32 v59, v59, v203
    v_mul_f32 v60, v60, v204
    v_mul_f32 v61, v61, v205
    v_mul_f32 v62, v62, v206
    v_mul_f32 v63, v63, v207
    v_cvt_pk_bf16_f32 v192, v48, v49
    v_cvt_pk_bf16_f32 v193, v50, v51
    v_cvt_pk_bf16_f32 v194, v52, v53
    v_cvt_pk_bf16_f32 v195, v54, v55
    v_cvt_pk_bf16_f32 v196, v56, v57
    v_cvt_pk_bf16_f32 v197, v58, v59
    v_cvt_pk_bf16_f32 v198, v60, v61
    v_cvt_pk_bf16_f32 v199, v62, v63
    v_lshlrev_b32 v48, 16, v192
    v_and_b32 v49, 0xffff0000, v192
    v_lshlrev_b32 v50, 16, v193
    v_and_b32 v51, 0xffff0000, v193
    v_lshlrev_b32 v52, 16, v194
    v_and_b32 v53, 0xffff0000, v194
    v_lshlrev_b32 v54, 16, v195
    v_and_b32 v55, 0xffff0000, v195
    v_lshlrev_b32 v56, 16, v196
    v_and_b32 v57, 0xffff0000, v196
    v_lshlrev_b32 v58, 16, v197
    v_and_b32 v59, 0xffff0000, v197
    v_lshlrev_b32 v60, 16, v198
    v_and_b32 v61, 0xffff0000, v198
    v_lshlrev_b32 v62, 16, v199
    v_and_b32 v63, 0xffff0000, v199
    s_branch L_cons_back
L_prod1:
    v_bfe_u32 v56, v2, 2, 2
    v_and_b32 v57, 3, v2
    v_lshl_add_u32 v52, v13, 3, v56
    v_lshlrev_b32 v52, 5, v52
    v_lshl_add_u32 v52, v57, 3, v52
    v_add_u32 v52, 67072, v52
    s_waitcnt vmcnt(8)
    s_mov_b32 s37, 24117248
    v_cmp_ne_u32 vcc, s35, v69
    s_nop 0
    s_cmp_lg_u64 vcc, 0
    s_cbranch_scc1 L_px
L_px_ok:
    v_and_b32 v69, 0xffff0000, v68
    v_lshlrev_b32 v68, 16, v68
    v_lshlrev_b32 v112, 16, v80
    v_and_b32 v113, 0xffff0000, v80
    v_lshlrev_b32 v114, 16, v81
    v_and_b32 v115, 0xffff0000, v81
    v_lshlrev_b32 v116, 16, v82
    v_and_b32 v117, 0xffff0000, v82
    v_lshlrev_b32 v118, 16, v83
    v_and_b32 v119, 0xffff0000, v83
    v_lshlrev_b32 v120, 16, v84
    v_and_b32 v121, 0xffff0000, v84
    v_lshlrev_b32 v122, 16, v85
    v_and_b32 v123, 0xffff0000, v85
    v_lshlrev_b32 v124, 16, v86
    v_and_b32 v125, 0xffff0000, v86
    v_lshlrev_b32 v126, 16, v87
    v_and_b32 v127, 0xffff0000, v87
    v_sub_f32 v112, v112, v68
    v_sub_f32 v113, v113, v68
    v_sub_f32 v114, v114, v68
    v_sub_f32 v115, v115, v68
    v_sub_f32 v116, v116, v68
    v_sub_f32 v117, v117, v68
    v_sub_f32 v118, v118, v68
    v_sub_f32 v119, v119, v68
    v_sub_f32 v120, v120, v68
    v_sub_f32 v121, v121, v68
    v_sub_f32 v122, v122, v68
    v_sub_f32 v123, v123, v68
    v_sub_f32 v124, v124, v68
    v_sub_f32 v125, v125, v68
    v_sub_f32 v126, v126, v68
    v_sub_f32 v127, v127, v68
    v_rcp_f32 v69, v69
    v_cvt_pk_bf16_f32 v96, v112, v113
    v_cvt_pk_bf16_f32 v97, v114, v115
    v_cvt_pk_bf16_f32 v98, v116, v117
    v_cvt_pk_bf16_f32 v99, v118, v119
    v_cvt_pk_bf16_f32 v100, v120, v121
    v_cvt_pk_bf16_f32 v101, v122, v123
    v_cvt_pk_bf16_f32 v102, v124, v125
    v_cvt_pk_bf16_f32 v103, v126, v127
    v_lshlrev_b32 v112, 16, v96
    v_and_b32 v113, 0xffff0000, v96
    v_lshlrev_b32 v114, 16, v97
    v_and_b32 v115, 0xffff0000, v97
    v_lshlrev_b32 v116, 16, v98
    v_and_b32 v117, 0xffff0000, v98
    v_lshlrev_b32 v118, 16, v99
    v_and_b32 v119, 0xffff0000, v99
    v_lshlrev_b32 v120, 16, v100
    v_and_b32 v121, 0xffff0000, v100
    v_lshlrev_b32 v122, 16, v101
    v_and_b32 v123, 0xffff0000, v101
    v_lshlrev_b32 v124, 16, v102
    v_and_b32 v125, 0xffff0000, v102
    v_lshlrev_b32 v126, 16, v103
    v_and_b32 v127, 0xffff0000, v103
    v_lshlrev_b32 v50, 5, v2
    v_mul_f32 v112, v112, v69
    v_mul_f32 v113, v113, v69
    v_mul_f32 v114, v114, v69
    v_mul_f32 v115, v115, v69
    v_mul_f32 v116, v116, v69
    v_mul_f32 v117, v117, v69
    v_mul_f32 v118, v118, v69
    v_mul_f32 v119, v119, v69
    v_mul_f32 v120, v120, v69
    v_mul_f32 v121, v121, v69
    v_mul_f32 v122, v122, v69
    v_mul_f32 v123, v123, v69
    v_mul_f32 v124, v124, v69
    v_mul_f32 v125, v125, v69
    v_mul_f32 v126, v126, v69
    v_mul_f32 v127, v127, v69
    v_add_u32 v50, 159360, v50
    v_cvt_pk_bf16_f32 v96, v112, v113
    v_cvt_pk_bf16_f32 v97, v114, v115
    v_cvt_pk_bf16_f32 v98, v116, v117
    v_cvt_pk_bf16_f32 v99, v118, v119
    v_cvt_pk_bf16_f32 v100, v120, v121
    v_cvt_pk_bf16_f32 v101, v122, v123
    v_cvt_pk_bf16_f32 v102, v124, v125
    v_cvt_pk_bf16_f32 v103, v126, v127
    ds_write_b128 v50, v[96:99]
    v_and_b32 v37, 1, v2
    ds_write_b128 v50, v[100:103] offset:16
    v_lshlrev_b32 v51, 10, v37
    v_lshl_add_u32 v51, v13, 4, v51
    v_add_u32 v51, 159360, v51
    ds_read_b64_tr_b16 v[128:129], v52 offset:0
    v_lshl_add_u32 v53, v13, 2, v56
    ds_read_b64_tr_b16 v[130:131], v52 offset:128
    ds_read_b64_tr_b16 v[132:133], v52 offset:16640
    ds_read_b64_tr_b16 v[134:135], v52 offset:16768
    ds_read_b64_tr_b16 v[136:137], v52 offset:1040
    v_mul_u32_u24 v53, 1040, v53
    ds_read_b64_tr_b16 v[138:139], v52 offset:1168
    ds_read_b64_tr_b16 v[140:141], v52 offset:17680
    ds_read_b64_tr_b16 v[142:143], v52 offset:17808
    ds_read_b64_tr_b16 v[144:145], v52 offset:2080
    v_lshlrev_b32 v54, 11, v37
    ds_read_b64_tr_b16 v[146:147], v52 offset:2208
    ds_read_b64_tr_b16 v[148:149], v52 offset:18720
    ds_read_b64_tr_b16 v[150:151], v52 offset:18848
    ds_read_b64_tr_b16 v[152:153], v52 offset:3120
    v_lshl_add_u32 v53, v57, 3, v53
    ds_read_b64_tr_b16 v[154:155], v52 offset:3248
    ds_read_b64_tr_b16 v[156:157], v52 offset:19760
    ds_read_b64_tr_b16 v[158:159], v52 offset:19888
    ds_read_b64_tr_b16 v[160:161], v52 offset:4160
    v_lshl_add_u32 v54, v13, 4, v54
    ds_read_b64_tr_b16 v[162:163], v52 offset:4288
    ds_read_b64_tr_b16 v[164:165], v52 offset:20800
    ds_read_b64_tr_b16 v[166:167], v52 offset:20928
    ds_read_b64_tr_b16 v[168:169], v52 offset:5200
    v_lshrrev_b32 v55, 1, v12
    ds_read_b64_tr_b16 v[170:171], v52 offset:5328
    s_waitcnt lgkmcnt(15)
    ds_read_b128 a[0:3], v51 offset:0
    v_add_u32 v53, 50304, v53
    ds_read_b128 a[4:7], v51 offset:64
    v_lshl_add_u32 v54, v55, 6, v54
    ds_read_b128 a[8:11], v51 offset:128
    s_lshl_b32 s36, s24, 12
    ds_read_b128 a[12:15], v51 offset:192
    v_add_u32 v54, s36, v54
    ds_read_b128 a[16:19], v51 offset:256
    ds_read_b128 a[20:23], v51 offset:320
    ds_read_b64_tr_b16 v[172:173], v52 offset:21840
    ds_read_b64_tr_b16 v[174:175], v52 offset:21968
    ds_read_b128 a[24:27], v51 offset:384
    ds_read_b64_tr_b16 v[176:177], v52 offset:6240
    ds_read_b64_tr_b16 v[178:179], v52 offset:6368
    ds_read_b64_tr_b16 v[180:181], v52 offset:22880
    ds_read_b64_tr_b16 v[182:183], v52 offset:23008
    ds_read_b128 a[28:31], v51 offset:448
    ds_read_b64_tr_b16 v[184:185], v52 offset:7280
    ds_read_b64_tr_b16 v[186:187], v52 offset:7408
    ds_read_b64_tr_b16 v[188:189], v52 offset:23920
    ds_read_b64_tr_b16 v[190:191], v52 offset:24048
    ds_read_b128 a[32:35], v51 offset:512
    ds_read_b64_tr_b16 v[192:193], v52 offset:8320
    s_waitcnt lgkmcnt(15)
    v_mfma_f32_16x16x32_bf16 v[40:43], v[128:131], a[0:3], 0
    ds_read_b64_tr_b16 v[194:195], v52 offset:8448
    ds_read_b64_tr_b16 v[196:197], v52 offset:24960
    v_mfma_f32_16x16x32_bf16 v[44:47], v[132:135], a[0:3], 0
    ds_read_b64_tr_b16 v[198:199], v52 offset:25088
    ds_read_b128 a[36:39], v51 offset:576
    v_mfma_f32_16x16x32_bf16 v[40:43], v[136:139], a[4:7], v[40:43]
    ds_read_b64_tr_b16 v[200:201], v52 offset:9360
    ds_read_b64_tr_b16 v[202:203], v52 offset:9488
    v_mfma_f32_16x16x32_bf16 v[44:47], v[140:143], a[4:7], v[44:47]
    ds_read_b64_tr_b16 v[204:205], v52 offset:26000
    ds_read_b64_tr_b16 v[206:207], v52 offset:26128
    v_mfma_f32_16x16x32_bf16 v[40:43], v[144:147], a[8:11], v[40:43]
    ds_read_b128 a[40:43], v51 offset:640
    ds_read_b64_tr_b16 v[208:209], v52 offset:10400
    v_mfma_f32_16x16x32_bf16 v[44:47], v[148:151], a[8:11], v[44:47]
    ds_read_b64_tr_b16 v[210:211], v52 offset:10528
    ds_read_b64_tr_b16 v[212:213], v52 offset:27040
    v_mfma_f32_16x16x32_bf16 v[40:43], v[152:155], a[12:15], v[40:43]
    ds_read_b64_tr_b16 v[214:215], v52 offset:27168
    ds_read_b128 a[44:47], v51 offset:704
    v_mfma_f32_16x16x32_bf16 v[44:47], v[156:159], a[12:15], v[44:47]
    ds_read_b64_tr_b16 v[216:217], v52 offset:11440
    ds_read_b64_tr_b16 v[218:219], v52 offset:11568
    v_mfma_f32_16x16x32_bf16 v[40:43], v[160:163], a[16:19], v[40:43]
    ds_read_b64_tr_b16 v[220:221], v52 offset:28080
    ds_read_b64_tr_b16 v[222:223], v52 offset:28208
    v_mfma_f32_16x16x32_bf16 v[44:47], v[164:167], a[16:19], v[44:47]
    ds_read_b128 a[48:51], v51 offset:768
    ds_read_b64_tr_b16 v[224:225], v52 offset:12480
    s_waitcnt lgkmcnt(15)
    v_mfma_f32_16x16x32_bf16 v[40:43], v[168:171], a[20:23], v[40:43]
    ds_read_b64_tr_b16 v[226:227], v52 offset:12608
    ds_read_b64_tr_b16 v[228:229], v52 offset:29120
    v_mfma_f32_16x16x32_bf16 v[44:47], v[172:175], a[20:23], v[44:47]
    ds_read_b64_tr_b16 v[230:231], v52 offset:29248
    ds_read_b128 a[52:55], v51 offset:832
    v_mfma_f32_16x16x32_bf16 v[40:43], v[176:179], a[24:27], v[40:43]
    ds_read_b64_tr_b16 v[232:233], v52 offset:13520
    ds_read_b64_tr_b16 v[234:235], v52 offset:13648
    v_mfma_f32_16x16x32_bf16 v[44:47], v[180:183], a[24:27], v[44:47]
    ds_read_b64_tr_b16 v[236:237], v52 offset:30160
    ds_read_b64_tr_b16 v[238:239], v52 offset:30288
    v_mfma_f32_16x16x32_bf16 v[40:43], v[184:187], a[28:31], v[40:43]
    ds_read_b128 a[56:59], v51 offset:896
    ds_read_b64_tr_b16 v[240:241], v52 offset:14560
    v_mfma_f32_16x16x32_bf16 v[44:47], v[188:191], a[28:31], v[44:47]
    ds_read_b64_tr_b16 v[242:243], v52 offset:14688
    ds_read_b64_tr_b16 v[244:245], v52 offset:31200
    v_mfma_f32_16x16x32_bf16 v[40:43], v[192:195], a[32:35], v[40:43]
    ds_read_b64_tr_b16 v[246:247], v52 offset:31328
    ds_read_b128 a[60:63], v51 offset:960
    v_mfma_f32_16x16x32_bf16 v[44:47], v[196:199], a[32:35], v[44:47]
    ds_read_b64_tr_b16 v[248:249], v52 offset:15600
    ds_read_b64_tr_b16 v[250:251], v52 offset:15728
    s_waitcnt lgkmcnt(15)
    v_mfma_f32_16x16x32_bf16 v[40:43], v[200:203], a[36:39], v[40:43]
    ds_read_b64_tr_b16 v[252:253], v52 offset:32240
    ds_read_b64_tr_b16 v[254:255], v52 offset:32368
    v_mfma_f32_16x16x32_bf16 v[44:47], v[204:207], a[36:39], v[44:47]
    ds_read_b64_tr_b16 v[128:129], v53 offset:0
    ds_read_b64_tr_b16 v[130:131], v53 offset:32
    v_mfma_f32_16x16x32_bf16 v[40:43], v[208:211], a[40:43], v[40:43]
    ds_read_b64_tr_b16 v[132:133], v53 offset:64
    ds_read_b64_tr_b16 v[134:135], v53 offset:96
    v_mfma_f32_16x16x32_bf16 v[44:47], v[212:215], a[40:43], v[44:47]
    ds_read_b64_tr_b16 v[136:137], v53 offset:128
    ds_read_b64_tr_b16 v[138:139], v53 offset:160
    v_mfma_f32_16x16x32_bf16 v[40:43], v[216:219], a[44:47], v[40:43]
    ds_read_b64_tr_b16 v[140:141], v53 offset:192
    ds_read_b64_tr_b16 v[142:143], v53 offset:224
    v_mfma_f32_16x16x32_bf16 v[44:47], v[220:223], a[44:47], v[44:47]
    ds_read_b64_tr_b16 v[144:145], v53 offset:256
    ds_read_b64_tr_b16 v[146:147], v53 offset:288
    v_mfma_f32_16x16x32_bf16 v[40:43], v[224:227], a[48:51], v[40:43]
    ds_read_b64_tr_b16 v[148:149], v53 offset:320
    ds_read_b64_tr_b16 v[150:151], v53 offset:352
    s_waitcnt lgkmcnt(15)
    v_mfma_f32_16x16x32_bf16 v[44:47], v[228:231], a[48:51], v[44:47]
    ds_read_b64_tr_b16 v[152:153], v53 offset:384
    ds_read_b64_tr_b16 v[154:155], v53 offset:416
    v_mfma_f32_16x16x32_bf16 v[40:43], v[232:235], a[52:55], v[40:43]
    ds_read_b64_tr_b16 v[156:157], v53 offset:448
    ds_read_b64_tr_b16 v[158:159], v53 offset:480
    v_mfma_f32_16x16x32_bf16 v[44:47], v[236:239], a[52:55], v[44:47]
    ds_read_b64_tr_b16 v[160:161], v53 offset:512
    ds_read_b64_tr_b16 v[162:163], v53 offset:544
    v_mfma_f32_16x16x32_bf16 v[40:43], v[240:243], a[56:59], v[40:43]
    ds_read_b64_tr_b16 v[164:165], v53 offset:576
    ds_read_b64_tr_b16 v[166:167], v53 offset:608
    v_mfma_f32_16x16x32_bf16 v[44:47], v[244:247], a[56:59], v[44:47]
    ds_read_b64_tr_b16 v[168:169], v53 offset:640
    ds_read_b64_tr_b16 v[170:171], v53 offset:672
    s_waitcnt lgkmcnt(15)
    v_mfma_f32_16x16x32_bf16 v[40:43], v[248:251], a[60:63], v[40:43]
    ds_read_b64_tr_b16 v[172:173], v53 offset:704
    ds_read_b64_tr_b16 v[174:175], v53 offset:736
    v_mfma_f32_16x16x32_bf16 v[44:47], v[252:255], a[60:63], v[44:47]
    ds_read_b64_tr_b16 v[176:177], v53 offset:768
    ds_read_b64_tr_b16 v[178:179], v53 offset:800
    ds_read_b64_tr_b16 v[180:181], v53 offset:832
    ds_read_b64_tr_b16 v[182:183], v53 offset:864
    ds_read_b64_tr_b16 v[184:185], v53 offset:896
    ds_read_b64_tr_b16 v[186:187], v53 offset:928
    ds_read_b64_tr_b16 v[188:189], v53 offset:960
    ds_read_b64_tr_b16 v[190:191], v53 offset:992
    s_waitcnt vmcnt(0)
    s_mov_b32 exec_lo, 0xffffffff
    s_mov_b32 exec_hi, 0
    buffer_store_dword v17, v16, s[20:23], s25 offen sc1
    s_mov_b64 exec, -1
    s_branch L_prod1b
L_prod:
    s_add_u32 s16, s88, 16842752
    s_addc_u32 s17, s89, 0
    s_mov_b32 s18, 352256
    s_mov_b32 s19, 0x20000
    s_waitcnt lgkmcnt(0)
    v_cvt_pk_bf16_f32 v40, v40, v40
    v_cvt_pk_bf16_f32 v41, v41, v41
    v_cvt_pk_bf16_f32 v42, v42, v42
    v_cvt_pk_bf16_f32 v43, v43, v43
    v_and_b32 v40, 0xffff0000, v40
    v_and_b32 v41, 0xffff0000, v41
    v_and_b32 v42, 0xffff0000, v42
    v_and_b32 v43, 0xffff0000, v43
    v_mul_f32 v58, 0xbfb8aa3b, v40
    v_mul_f32 v59, 0xbfb8aa3b, v41
    v_mul_f32 v60, 0xbfb8aa3b, v42
    v_mul_f32 v61, 0xbfb8aa3b, v43
    v_exp_f32 v58, v58
    v_exp_f32 v59, v59
    v_exp_f32 v60, v60
    v_exp_f32 v61, v61
    v_add_f32 v58, 1.0, v58
    v_add_f32 v59, 1.0, v59
    v_add_f32 v60, 1.0, v60
    v_add_f32 v61, 1.0, v61
    v_rcp_f32 v58, v58
    v_rcp_f32 v59, v59
    v_rcp_f32 v60, v60
    v_rcp_f32 v61, v61
    v_mul_f32 v40, v40, v58
    v_mul_f32 v41, v41, v59
    v_mul_f32 v42, v42, v60
    v_mul_f32 v43, v43, v61
    v_cvt_pk_bf16_f32 v44, v44, v44
    v_cvt_pk_bf16_f32 v45, v45, v45
    v_cvt_pk_bf16_f32 v46, v46, v46
    v_cvt_pk_bf16_f32 v47, v47, v47
    v_cvt_pk_bf16_f32 v40, v40, v40
    v_cvt_pk_bf16_f32 v41, v41, v41
    v_cvt_pk_bf16_f32 v42, v42, v42
    v_cvt_pk_bf16_f32 v43, v43, v43
    v_and_b32 v44, 0xffff0000, v44
    v_and_b32 v45, 0xffff0000, v45
    v_and_b32 v46, 0xffff0000, v46
    v_and_b32 v47, 0xffff0000, v47
    v_and_b32 v40, 0xffff0000, v40
    v_and_b32 v41, 0xffff0000, v41
    v_and_b32 v42, 0xffff0000, v42
    v_and_b32 v43, 0xffff0000, v43
    v_mul_f32 v40, v40, v44
    v_mul_f32 v41, v41, v45
    v_mul_f32 v42, v42, v46
    v_mul_f32 v43, v43, v47
    v_cmp_eq_u32 vcc, 0, v55
    v_cvt_pk_bf16_f32 v62, v40, v41
    v_cvt_pk_bf16_f32 v63, v42, v43
    v_cndmask_b32 v96, 0, v62, vcc
    v_cndmask_b32 v97, 0, v63, vcc
    v_cmp_eq_u32 vcc, 1, v55
    s_nop 1
    v_cndmask_b32 v98, 0, v62, vcc
    v_cndmask_b32 v99, 0, v63, vcc
    v_cmp_eq_u32 vcc, 2, v55
    s_nop 0
    v_mfma_f32_16x16x32_bf16 v[64:67], v[128:131], v[96:99], 0
    v_cndmask_b32 v100, 0, v62, vcc
    v_cndmask_b32 v101, 0, v63, vcc
    v_mfma_f32_16x16x32_bf16 v[68:71], v[144:147], v[96:99], 0
    v_cmp_eq_u32 vcc, 3, v55
    v_mfma_f32_16x16x32_bf16 v[72:75], v[160:163], v[96:99], 0
    s_nop 0
    v_cndmask_b32 v102, 0, v62, vcc
    v_cndmask_b32 v103, 0, v63, vcc
    v_mfma_f32_16x16x32_bf16 v[76:79], v[176:179], v[96:99], 0
    v_cmp_eq_u32 vcc, 4, v55
    v_mfma_f32_16x16x32_bf16 v[64:67], v[132:135], v[100:103], v[64:67]
    s_nop 0
    v_cndmask_b32 v104, 0, v62, vcc
    v_cndmask_b32 v105, 0, v63, vcc
    v_mfma_f32_16x16x32_bf16 v[68:71], v[148:151], v[100:103], v[68:71]
    v_cmp_eq_u32 vcc, 5, v55
    v_mfma_f32_16x16x32_bf16 v[72:75], v[164:167], v[100:103], v[72:75]
    s_nop 0
    v_cndmask_b32 v106, 0, v62, vcc
    v_cndmask_b32 v107, 0, v63, vcc
    v_mfma_f32_16x16x32_bf16 v[76:79], v[180:183], v[100:103], v[76:79]
    v_cmp_eq_u32 vcc, 6, v55
    v_mfma_f32_16x16x32_bf16 v[64:67], v[136:139], v[104:107], v[64:67]
    s_nop 0
    v_cndmask_b32 v108, 0, v62, vcc
    v_cndmask_b32 v109, 0, v63, vcc
    v_mfma_f32_16x16x32_bf16 v[68:71], v[152:155], v[104:107], v[68:71]
    v_cmp_eq_u32 vcc, 7, v55
    v_mfma_f32_16x16x32_bf16 v[72:75], v[168:171], v[104:107], v[72:75]
    s_nop 0
    v_cndmask_b32 v110, 0, v62, vcc
    v_cndmask_b32 v111, 0, v63, vcc
    v_mfma_f32_16x16x32_bf16 v[76:79], v[184:187], v[104:107], v[76:79]
    s_nop 0
    v_mfma_f32_16x16x32_bf16 v[64:67], v[140:143], v[108:111], v[64:67]
    v_mfma_f32_16x16x32_bf16 v[68:71], v[156:159], v[108:111], v[68:71]
    v_mfma_f32_16x16x32_bf16 v[72:75], v[172:175], v[108:111], v[72:75]
    v_mfma_f32_16x16x32_bf16 v[76:79], v[188:191], v[108:111], v[76:79]
    s_nop 4
    buffer_store_dwordx4 v[64:67], v54, s[16:19], 0 offen offset:0 sc1
    buffer_store_dwordx4 v[68:71], v54, s[16:19], 0 offen offset:512 sc1
    buffer_store_dwordx4 v[72:75], v54, s[16:19], 0 offen offset:1024 sc1
    buffer_store_dwordx4 v[76:79], v54, s[16:19], 0 offen offset:1536 sc1
    s_nop 1
    s_branch L_noprod
L_psig:
    s_mov_b32 exec_hi, 0
    s_lshl_b32 s36, s24, 7
    s_add_u32 s36, s36, 24379392
    buffer_store_dword v17, v16, s[20:23], s36 offen sc1
    s_cmp_eq_u32 s2, 0
    s_cselect_b32 s36, 17268736, s36
    buffer_store_dword v17, v16, s[20:23], s36 offen sc1
    s_mov_b64 exec, -1
    s_branch L_psigb
.fill 16, 4, 0xbf800000
L_code_end:
    s_endpgm
.section .rodata,"a"
.p2align 6
.amdhsa_kernel recurrent_scan__sliding_block_cached__moe_arch_mod__prompt_kernel
  .amdhsa_next_free_vgpr 512
  .amdhsa_next_free_sgpr 102
  .amdhsa_accum_offset 256
  .amdhsa_group_segment_fixed_size 0
  .amdhsa_kernarg_size 104
  .amdhsa_user_sgpr_count 2
  .amdhsa_user_sgpr_kernarg_segment_ptr 1
  .amdhsa_system_sgpr_workgroup_id_x 1
.end_amdhsa_kernel
```
